```python
import torch

def _softmax(x, axis=-1):
    return torch.softmax(x, dim=axis)
def _gelu(x):
    return torch.nn.functional.gelu(x, approximate="tanh")
def _silu(x):
    return torch.nn.functional.silu(x)
def _sigmoid(x):
    return torch.sigmoid(x)
def _layernorm(x, axis=-1, eps=1e-5):
    m = x.mean(dim=axis, keepdim=True)
    v = x.var(dim=axis, keepdim=True, unbiased=False)
    return (x - m) / torch.sqrt(v + eps)
def _scatter_add(tgt, idx, src, axis=0):
    return tgt.clone().index_add_(axis, idx, src)
def _segment_sum(src, seg, n):
    out = torch.zeros((n,) + src.shape[1:], dtype=src.dtype)
    return out.index_add_(0, seg, src)
def _pad(x, pw):
    flat = tuple(v for pair in reversed(pw) for v in pair)
    return torch.nn.functional.pad(x, flat)

kernel_name = 'interleave_layers__linear_kernel_hedgehog__mixer_s_mlp__prompt'

def setup_inputs():

    _w = (lambda a: (lambda t: t.to(torch.bfloat16) if t.is_floating_point() else t)(torch.as_tensor(a)))
    def _A_setup():
        B, S, D, H = 1, 2048, 448, 16
        Dh = D // H
        return {
            "x": _w((lambda *s: torch.randn(*s, dtype=torch.bfloat16) * 0.05)(B, S, D)),
            "wqkv": _w((lambda *s: torch.randn(*s, dtype=torch.bfloat16) * 0.4)(D, 3 * D)),
            "w_phi": _w((lambda *s: torch.randn(*s, dtype=torch.bfloat16) * 0.4)(H, Dh, Dh) * (Dh ** -0.5)),
            "wo": _w((lambda *s: torch.randn(*s, dtype=torch.bfloat16) * 0.05)(D, D)),
        }
    _A_in = _A_setup()

    def _B_setup():
        B, S, D, F = 1, 2048, 448, 1792
        return {
            "x":  _w((lambda *s: torch.randn(*s, dtype=torch.bfloat16) * 0.05)(B, S, D)),
            "w1": _w((lambda *s: torch.randn(*s, dtype=torch.bfloat16) * 3.2)(D, D) * (D ** -0.5)),
            "w2": _w((lambda *s: torch.randn(*s, dtype=torch.bfloat16) * 3.2)(D, D) * (D ** -0.5)),
            "w3": _w((lambda *s: torch.randn(*s, dtype=torch.bfloat16) * 3.2)(D, F) * (D ** -0.5)),
            "w4": _w((lambda *s: torch.randn(*s, dtype=torch.bfloat16) * 3.2)(F, D) * (F ** -0.5)),
        }
    _B_in = _B_setup()

    return {
        "A_x": _A_in["x"],
        "A_wqkv": _A_in["wqkv"],
        "A_w_phi": _A_in["w_phi"],
        "A_wo": _A_in["wo"],
        "B_x": _B_in["x"],
        "B_w1": _B_in["w1"],
        "B_w2": _B_in["w2"],
        "B_w3": _B_in["w3"],
        "B_w4": _B_in["w4"],
    }

def reference(A_x, A_wqkv, A_w_phi, A_wo, B_x, B_w1, B_w2, B_w3, B_w4):
    def _A_ref(x, wqkv, w_phi, wo):
        B, S, D = x.shape
        H = 16; Dh = D // H
        qkv = (lambda x, *d: x.permute(*d))((x @ wqkv).reshape(B, S, 3, H, Dh), 2, 0, 3, 1, 4)
        q, k, v = qkv[0], qkv[1], qkv[2]
        pq = torch.einsum("bhsd,hdf->bhsf", q, w_phi)
        pk = torch.einsum("bhsd,hdf->bhsf", k, w_phi)
        phi_q = torch.concatenate([_softmax(pq, axis=-1), _softmax(-pq, axis=-1)], axis=-1)
        phi_k = torch.concatenate([_softmax(pk, axis=-1), _softmax(-pk, axis=-1)], axis=-1)
        kv = torch.einsum("bhsf,bhsd->bhfd", phi_k, v)
        z  = torch.einsum("bhsf->bhf", phi_k)
        num = torch.einsum("bhqf,bhfd->bhqd", phi_q, kv)
        den = torch.einsum("bhqf,bhf->bhq", phi_q, z)[..., None] + 1e-6
        o = num / den
        return (lambda x, *d: x.permute(*d))(o, 0, 2, 1, 3).reshape(B, S, D) @ wo

    def _B_ref(x, w1, w2, w3, w4):
        B, S, D = x.shape
        h = _gelu(_layernorm(x, axis=-1) @ w1)
        c = D // 4
        g0 = _pad(h[:, :, 0*c:1*c], ((0, 0), (1, 0), (0, 0)))[:, :S, :]
        g1 = _pad(h[:, :, 1*c:2*c], ((0, 0), (0, 1), (0, 0)))[:, 1:, :]
        g2 = _pad(h[:, :, 2*c:3*c], ((0, 0), (2, 0), (0, 0)))[:, :S, :]
        g3 = _pad(h[:, :, 3*c:   ], ((0, 0), (0, 2), (0, 0)))[:, 2:, :]
        hs = torch.concatenate([g0, g1, g2, g3], axis=-1) @ w2
        x1 = x + hs
        h2 = _gelu(_layernorm(x1, axis=-1) @ w3) @ w4
        return x1 + h2

    x = A_x
    x = x + _A_ref(_layernorm(x, axis=-1), A_wqkv, A_w_phi, A_wo)
    x = x + _B_ref(_layernorm(x, axis=-1), B_w1, B_w2, B_w3, B_w4)
    x = x + _A_ref(_layernorm(x, axis=-1), A_wqkv, A_w_phi, A_wo)
    x = x + _B_ref(_layernorm(x, axis=-1), B_w1, B_w2, B_w3, B_w4)
    return x
```

```asm
; @launch grid=(256,1,1) block=(512,1,1) lds=163840
.amdgcn_target "amdgcn-amd-amdhsa--gfx950"
.text
.globl interleave_layers__linear_kernel_hedgehog__mixer_s_mlp__prompt_kernel
.p2align 8
.type interleave_layers__linear_kernel_hedgehog__mixer_s_mlp__prompt_kernel,@function
interleave_layers__linear_kernel_hedgehog__mixer_s_mlp__prompt_kernel:
    s_cmp_ge_u32 s2, 256
    s_cbranch_scc1 L_done
    s_load_dwordx2 s[96:97], s[0:1], 0
    s_load_dwordx2 s[98:99], s[0:1], 72
    s_load_dwordx2 s[92:93], s[0:1], 80
    s_load_dwordx2 s[94:95], s[0:1], 88
    v_and_b32 v1, 63, v0
    v_lshrrev_b32 v2, 6, v0
    s_nop 0
    v_readfirstlane_b32 s3, v2
    v_lshlrev_b32 v2, 4, v1
    v_and_b32 v3, 15, v1
    v_lshrrev_b32 v4, 4, v1
    v_add_u32 v5, 0x10000, v2
    v_cmp_eq_u32 s[52:53], 3, v4
    v_cmp_le_u32 s[54:55], 12, v3
    v_cmp_eq_u32 s[56:57], 12, v3
    v_cmp_gt_u32 s[58:59], 2, v4
    s_mov_b32 s60, 0x3f803f80
    s_mov_b32 s61, 0x3fb8aa3b
    s_mov_b32 s90, 0x3d372713
    s_mov_b32 s91, 0xc0135761
    s_waitcnt lgkmcnt(0)
    s_or_b32 s44, s2, s3
    s_cmp_lg_u32 s44, 0
    s_cbranch_scc1 L_ntok_1
    s_memrealtime s[44:45]
    s_waitcnt lgkmcnt(0)
    s_or_b32 s44, s44, 1
    s_lshl_b32 s45, s45, 8
    s_xor_b32 s45, s45, 0x5a3c9600
    s_mov_b32 s28, s92
    s_mov_b32 s29, s93
    s_mov_b32 s30, 256
    s_mov_b32 s31, 0x00020000
    v_mov_b32 v6, s44
    v_mov_b32 v7, s45
    v_mov_b32 v8, 0
    s_mov_b64 exec, 1
    buffer_store_dwordx2 v[6:7], v8, s[28:31], 0 offen sc1
    s_mov_b64 exec, -1
    s_nop 0
L_ntok_1:
    s_add_u32 s8, s94, 7659520
    s_addc_u32 s9, s95, 0
    s_mov_b32 s10, 278528
    s_mov_b32 s11, 0x00020000
    s_lshl_b32 s50, s2, 9
    v_add_u32 v6, s50, v0
    v_lshlrev_b32 v6, 2, v6
    v_mov_b32 v7, 0
    buffer_store_dword v7, v6, s[8:11], 0 offen sc1
    s_lshl_b32 s49, s2, 3
    s_add_u32 s49, s49, s3
    s_load_dwordx4 s[4:7], s[0:1], 8
    s_load_dwordx2 s[36:37], s[0:1], 24
    s_load_dwordx4 s[40:43], s[0:1], 40
    s_load_dwordx4 s[44:47], s[0:1], 56
    s_mov_b32 s8, s94
    s_mov_b32 s9, s95
    s_mov_b32 s10, 7659520
    s_mov_b32 s11, 0x00020000
    v_lshrrev_b32 v6, 2, v3
    v_and_b32 v7, 3, v3
    v_lshl_add_u32 v8, v6, 3, v7
    v_mov_b32 v15, 0x40000000
    s_waitcnt lgkmcnt(0)
    s_add_u32 s50, s49, 0
    s_mov_b32 s32, s50
    s_cmp_ge_u32 s50, 7480
    s_cbranch_scc1 L_k0nxt_4
    s_cmp_ge_u32 s50, 5688
    s_cbranch_scc1 L_k0t_11
    s_cmp_ge_u32 s50, 4120
    s_cbranch_scc1 L_k0t_9
    s_cmp_ge_u32 s50, 2552
    s_cbranch_scc1 L_k0t_8
    s_cmp_ge_u32 s50, 2160
    s_cbranch_scc1 L_k0t_7
    s_cmp_ge_u32 s50, 1768
    s_cbranch_scc1 L_k0t_6
    s_cmp_ge_u32 s50, 1376
    s_cbranch_scc1 L_k0t_5
    s_cmp_ge_u32 s50, 1344
    s_cbranch_scc1 L_k0t_10
    s_mov_b32 s62, 44739243
    s_mul_hi_u32 s66, s50, s62
    s_mul_i32 s64, s66, 96
    s_sub_u32 s64, s50, s64
    s_lshr_b32 s67, s64, 5
    s_bfe_u32 s63, s64, 0x40001
    s_and_b32 s68, s64, 1
    s_lshl_b32 s65, s67, 1
    s_add_u32 s65, s65, s68
    s_mul_i32 s65, s65, 14
    s_add_u32 s65, s65, s66
    s_mul_i32 s76, s63, 86
    s_add_u32 s76, s76, s65
    s_mul_i32 s67, s67, 448
    s_mul_i32 s69, s63, 28
    s_add_u32 s67, s67, s69
    s_lshl_b32 s69, s68, 4
    s_add_u32 s67, s67, s69
    s_mov_b32 s12, s4
    s_mov_b32 s13, s5
    s_mov_b32 s14, 1204224
    s_mov_b32 s15, 0x00020000
    s_mov_b32 s70, 2688
    s_mul_i32 s71, s66, 32*2688
    v_add_u32 v10, s67, v3
    v_lshlrev_b32 v10, 1, v10
    v_mul_u32_u24 v11, 8*2688, v4
    v_add_u32 v10, v10, v11
    s_cmp_eq_u32 s68, 0
    s_nop 0
    s_cbranch_scc1 L_k0std_2
    v_cndmask_b32 v10, v10, v15, s[54:55]
    s_nop 1
    s_branch L_k0std_2
L_k0t_10:
    s_sub_u32 s64, s50, 1344
    s_lshr_b32 s63, s64, 1
    s_and_b32 s68, s64, 1
    s_mul_i32 s76, s63, 86
    s_add_u32 s76, s76, s68
    s_add_u32 s76, s76, 84
    s_mov_b32 s12, s6
    s_mov_b32 s13, s7
    s_mov_b32 s14, 25088
    s_mov_b32 s15, 0x00020000
    s_mov_b32 s70, 56
    s_mul_i32 s71, s63, 1568
    s_lshl_b32 s69, s68, 4
    v_add_u32 v10, s69, v3
    v_lshlrev_b32 v10, 1, v10
    v_mul_u32_u24 v11, 4*56, v4
    v_add_u32 v10, v10, v11
    s_cmp_eq_u32 s68, 0
    s_nop 0
    s_cbranch_scc1 L_k0perm_3
    v_cndmask_b32 v10, v10, v15, s[54:55]
    s_nop 1
    s_branch L_k0perm_3
L_k0t_5:
    s_sub_u32 s64, s50, 1376
    s_mov_b32 s62, 153391690
    s_mul_hi_u32 s66, s64, s62
    s_mul_i32 s65, s66, 28
    s_sub_u32 s65, s64, s65
    s_mul_i32 s76, s65, 14
    s_add_u32 s76, s76, s66
    s_add_u32 s76, s76, 1376
    s_mov_b32 s12, s36
    s_mov_b32 s13, s37
    s_mov_b32 s14, 401408
    s_mov_b32 s15, 0x00020000
    s_branch L_k0t_12
L_k0t_6:
    s_sub_u32 s64, s50, 1768
    s_mov_b32 s62, 153391690
    s_mul_hi_u32 s66, s64, s62
    s_mul_i32 s65, s66, 28
    s_sub_u32 s65, s64, s65
    s_mul_i32 s76, s65, 14
    s_add_u32 s76, s76, s66
    s_add_u32 s76, s76, 1768
    s_mov_b32 s12, s40
    s_mov_b32 s13, s41
    s_mov_b32 s14, 401408
    s_mov_b32 s15, 0x00020000
    s_branch L_k0t_12
L_k0t_7:
    s_sub_u32 s64, s50, 2160
    s_mov_b32 s62, 153391690
    s_mul_hi_u32 s66, s64, s62
    s_mul_i32 s65, s66, 28
    s_sub_u32 s65, s64, s65
    s_mul_i32 s76, s65, 14
    s_add_u32 s76, s76, s66
    s_add_u32 s76, s76, 2160
    s_mov_b32 s12, s42
    s_mov_b32 s13, s43
    s_mov_b32 s14, 401408
    s_mov_b32 s15, 0x00020000
    s_branch L_k0t_12
L_k0t_9:
    s_sub_u32 s64, s50, 4120
    s_mov_b32 s62, 153391690
    s_mul_hi_u32 s66, s64, s62
    s_mul_i32 s65, s66, 28
    s_sub_u32 s65, s64, s65
    s_mul_i32 s76, s65, 56
    s_add_u32 s76, s76, s66
    s_add_u32 s76, s76, 4120
    s_mov_b32 s12, s46
    s_mov_b32 s13, s47
    s_mov_b32 s14, 1605632
    s_mov_b32 s15, 0x00020000
    s_branch L_k0t_12
L_k0t_12:
    s_mov_b32 s70, 896
    s_mul_i32 s71, s66, 32*896
    s_lshr_b32 s67, s65, 1
    s_lshl_b32 s67, s67, 5
    s_and_b32 s68, s65, 1
    s_lshl_b32 s68, s68, 2
    s_add_u32 s67, s67, s68
    v_add_u32 v10, s67, v8
    v_lshlrev_b32 v10, 1, v10
    v_mul_u32_u24 v11, 8*896, v4
    v_add_u32 v10, v10, v11
    s_nop 1
    s_branch L_k0std_2
L_k0t_11:
    s_mov_b32 s76, s50
    s_sub_u32 s64, s50, 5688
    s_mov_b32 s62, 306783379
    s_mul_hi_u32 s65, s64, s62
    s_mul_i32 s66, s65, 14
    s_sub_u32 s66, s64, s66
    s_mov_b32 s12, s96
    s_mov_b32 s13, s97
    s_mov_b32 s14, 1835008
    s_mov_b32 s15, 0x00020000
    s_mul_i32 s71, s65, 16*896
    s_lshl_b32 s66, s66, 6
    s_add_u32 s71, s71, s66
    v_mul_u32_u24 v10, 896, v3
    v_lshl_add_u32 v10, v4, 4, v10
    buffer_load_dwordx4 v[32:35], v10, s[12:15], s71 offen
    s_nop 0
    s_branch L_k0nxt_4
L_k0t_8:
    s_sub_u32 s64, s50, 2552
    s_mov_b32 s62, 38347923
    s_mul_hi_u32 s66, s64, s62
    s_mul_i32 s65, s66, 112
    s_sub_u32 s65, s64, s65
    s_mul_i32 s76, s65, 14
    s_add_u32 s76, s76, s66
    s_add_u32 s76, s76, 2552
    s_mov_b32 s12, s44
    s_mov_b32 s13, s45
    s_mov_b32 s14, 1605632
    s_mov_b32 s15, 0x00020000
    s_mov_b32 s70, 3584
    s_mul_i32 s71, s66, 32*3584
    s_lshr_b32 s67, s65, 1
    s_lshl_b32 s67, s67, 5
    s_and_b32 s68, s65, 1
    s_lshl_b32 s68, s68, 2
    s_add_u32 s67, s67, s68
    v_add_u32 v10, s67, v8
    v_lshlrev_b32 v10, 1, v10
    v_mul_u32_u24 v11, 8*3584, v4
    v_add_u32 v10, v10, v11
    s_nop 1
L_k0std_2:
    buffer_load_ushort v32, v10, s[12:15], s71 offen
    s_add_u32 s71, s71, s70
    buffer_load_ushort v33, v10, s[12:15], s71 offen
    s_add_u32 s71, s71, s70
    buffer_load_ushort v34, v10, s[12:15], s71 offen
    s_add_u32 s71, s71, s70
    buffer_load_ushort v35, v10, s[12:15], s71 offen
    s_add_u32 s71, s71, s70
    buffer_load_ushort v36, v10, s[12:15], s71 offen
    s_add_u32 s71, s71, s70
    buffer_load_ushort v37, v10, s[12:15], s71 offen
    s_add_u32 s71, s71, s70
    buffer_load_ushort v38, v10, s[12:15], s71 offen
    s_add_u32 s71, s71, s70
    buffer_load_ushort v39, v10, s[12:15], s71 offen
    s_branch L_k0nxt_4
L_k0perm_3:
    v_cndmask_b32 v11, v10, v15, s[52:53]
    s_mul_i32 s72, s70, 13
    buffer_load_ushort v32, v10, s[12:15], s71 offen
    s_add_u32 s71, s71, s70
    buffer_load_ushort v33, v10, s[12:15], s71 offen
    s_add_u32 s71, s71, s70
    buffer_load_ushort v34, v10, s[12:15], s71 offen
    s_add_u32 s71, s71, s70
    buffer_load_ushort v35, v10, s[12:15], s71 offen
    s_add_u32 s71, s71, s72
    buffer_load_ushort v36, v11, s[12:15], s71 offen
    s_add_u32 s71, s71, s70
    buffer_load_ushort v37, v11, s[12:15], s71 offen
    s_add_u32 s71, s71, s70
    buffer_load_ushort v38, v11, s[12:15], s71 offen
    s_add_u32 s71, s71, s70
    buffer_load_ushort v39, v11, s[12:15], s71 offen
L_k0nxt_4:
    s_add_u32 s50, s49, 2048
    s_mov_b32 s33, s50
    s_cmp_ge_u32 s50, 7480
    s_cbranch_scc1 L_k0nxt_15
    s_cmp_ge_u32 s50, 5688
    s_cbranch_scc1 L_k0t_22
    s_cmp_ge_u32 s50, 4120
    s_cbranch_scc1 L_k0t_20
    s_cmp_ge_u32 s50, 2552
    s_cbranch_scc1 L_k0t_19
    s_cmp_ge_u32 s50, 2160
    s_cbranch_scc1 L_k0t_18
    s_cmp_ge_u32 s50, 1768
    s_cbranch_scc1 L_k0t_17
    s_cmp_ge_u32 s50, 1376
    s_cbranch_scc1 L_k0t_16
    s_cmp_ge_u32 s50, 1344
    s_cbranch_scc1 L_k0t_21
    s_mov_b32 s62, 44739243
    s_mul_hi_u32 s66, s50, s62
    s_mul_i32 s64, s66, 96
    s_sub_u32 s64, s50, s64
    s_lshr_b32 s67, s64, 5
    s_bfe_u32 s63, s64, 0x40001
    s_and_b32 s68, s64, 1
    s_lshl_b32 s65, s67, 1
    s_add_u32 s65, s65, s68
    s_mul_i32 s65, s65, 14
    s_add_u32 s65, s65, s66
    s_mul_i32 s77, s63, 86
    s_add_u32 s77, s77, s65
    s_mul_i32 s67, s67, 448
    s_mul_i32 s69, s63, 28
    s_add_u32 s67, s67, s69
    s_lshl_b32 s69, s68, 4
    s_add_u32 s67, s67, s69
    s_mov_b32 s12, s4
    s_mov_b32 s13, s5
    s_mov_b32 s14, 1204224
    s_mov_b32 s15, 0x00020000
    s_mov_b32 s70, 2688
    s_mul_i32 s71, s66, 32*2688
    v_add_u32 v10, s67, v3
    v_lshlrev_b32 v10, 1, v10
    v_mul_u32_u24 v11, 8*2688, v4
    v_add_u32 v10, v10, v11
    s_cmp_eq_u32 s68, 0
    s_nop 0
    s_cbranch_scc1 L_k0std_13
    v_cndmask_b32 v10, v10, v15, s[54:55]
    s_nop 1
    s_branch L_k0std_13
L_k0t_21:
    s_sub_u32 s64, s50, 1344
    s_lshr_b32 s63, s64, 1
    s_and_b32 s68, s64, 1
    s_mul_i32 s77, s63, 86
    s_add_u32 s77, s77, s68
    s_add_u32 s77, s77, 84
    s_mov_b32 s12, s6
    s_mov_b32 s13, s7
    s_mov_b32 s14, 25088
    s_mov_b32 s15, 0x00020000
    s_mov_b32 s70, 56
    s_mul_i32 s71, s63, 1568
    s_lshl_b32 s69, s68, 4
    v_add_u32 v10, s69, v3
    v_lshlrev_b32 v10, 1, v10
    v_mul_u32_u24 v11, 4*56, v4
    v_add_u32 v10, v10, v11
    s_cmp_eq_u32 s68, 0
    s_nop 0
    s_cbranch_scc1 L_k0perm_14
    v_cndmask_b32 v10, v10, v15, s[54:55]
    s_nop 1
    s_branch L_k0perm_14
L_k0t_16:
    s_sub_u32 s64, s50, 1376
    s_mov_b32 s62, 153391690
    s_mul_hi_u32 s66, s64, s62
    s_mul_i32 s65, s66, 28
    s_sub_u32 s65, s64, s65
    s_mul_i32 s77, s65, 14
    s_add_u32 s77, s77, s66
    s_add_u32 s77, s77, 1376
    s_mov_b32 s12, s36
    s_mov_b32 s13, s37
    s_mov_b32 s14, 401408
    s_mov_b32 s15, 0x00020000
    s_branch L_k0t_23
L_k0t_17:
    s_sub_u32 s64, s50, 1768
    s_mov_b32 s62, 153391690
    s_mul_hi_u32 s66, s64, s62
    s_mul_i32 s65, s66, 28
    s_sub_u32 s65, s64, s65
    s_mul_i32 s77, s65, 14
    s_add_u32 s77, s77, s66
    s_add_u32 s77, s77, 1768
    s_mov_b32 s12, s40
    s_mov_b32 s13, s41
    s_mov_b32 s14, 401408
    s_mov_b32 s15, 0x00020000
    s_branch L_k0t_23
L_k0t_18:
    s_sub_u32 s64, s50, 2160
    s_mov_b32 s62, 153391690
    s_mul_hi_u32 s66, s64, s62
    s_mul_i32 s65, s66, 28
    s_sub_u32 s65, s64, s65
    s_mul_i32 s77, s65, 14
    s_add_u32 s77, s77, s66
    s_add_u32 s77, s77, 2160
    s_mov_b32 s12, s42
    s_mov_b32 s13, s43
    s_mov_b32 s14, 401408
    s_mov_b32 s15, 0x00020000
    s_branch L_k0t_23
L_k0t_20:
    s_sub_u32 s64, s50, 4120
    s_mov_b32 s62, 153391690
    s_mul_hi_u32 s66, s64, s62
    s_mul_i32 s65, s66, 28
    s_sub_u32 s65, s64, s65
    s_mul_i32 s77, s65, 56
    s_add_u32 s77, s77, s66
    s_add_u32 s77, s77, 4120
    s_mov_b32 s12, s46
    s_mov_b32 s13, s47
    s_mov_b32 s14, 1605632
    s_mov_b32 s15, 0x00020000
    s_branch L_k0t_23
L_k0t_23:
    s_mov_b32 s70, 896
    s_mul_i32 s71, s66, 32*896
    s_lshr_b32 s67, s65, 1
    s_lshl_b32 s67, s67, 5
    s_and_b32 s68, s65, 1
    s_lshl_b32 s68, s68, 2
    s_add_u32 s67, s67, s68
    v_add_u32 v10, s67, v8
    v_lshlrev_b32 v10, 1, v10
    v_mul_u32_u24 v11, 8*896, v4
    v_add_u32 v10, v10, v11
    s_nop 1
    s_branch L_k0std_13
L_k0t_22:
    s_mov_b32 s77, s50
    s_sub_u32 s64, s50, 5688
    s_mov_b32 s62, 306783379
    s_mul_hi_u32 s65, s64, s62
    s_mul_i32 s66, s65, 14
    s_sub_u32 s66, s64, s66
    s_mov_b32 s12, s96
    s_mov_b32 s13, s97
    s_mov_b32 s14, 1835008
    s_mov_b32 s15, 0x00020000
    s_mul_i32 s71, s65, 16*896
    s_lshl_b32 s66, s66, 6
    s_add_u32 s71, s71, s66
    v_mul_u32_u24 v10, 896, v3
    v_lshl_add_u32 v10, v4, 4, v10
    buffer_load_dwordx4 v[40:43], v10, s[12:15], s71 offen
    s_nop 0
    s_branch L_k0nxt_15
L_k0t_19:
    s_sub_u32 s64, s50, 2552
    s_mov_b32 s62, 38347923
    s_mul_hi_u32 s66, s64, s62
    s_mul_i32 s65, s66, 112
    s_sub_u32 s65, s64, s65
    s_mul_i32 s77, s65, 14
    s_add_u32 s77, s77, s66
    s_add_u32 s77, s77, 2552
    s_mov_b32 s12, s44
    s_mov_b32 s13, s45
    s_mov_b32 s14, 1605632
    s_mov_b32 s15, 0x00020000
    s_mov_b32 s70, 3584
    s_mul_i32 s71, s66, 32*3584
    s_lshr_b32 s67, s65, 1
    s_lshl_b32 s67, s67, 5
    s_and_b32 s68, s65, 1
    s_lshl_b32 s68, s68, 2
    s_add_u32 s67, s67, s68
    v_add_u32 v10, s67, v8
    v_lshlrev_b32 v10, 1, v10
    v_mul_u32_u24 v11, 8*3584, v4
    v_add_u32 v10, v10, v11
    s_nop 1
L_k0std_13:
    buffer_load_ushort v40, v10, s[12:15], s71 offen
    s_add_u32 s71, s71, s70
    buffer_load_ushort v41, v10, s[12:15], s71 offen
    s_add_u32 s71, s71, s70
    buffer_load_ushort v42, v10, s[12:15], s71 offen
    s_add_u32 s71, s71, s70
    buffer_load_ushort v43, v10, s[12:15], s71 offen
    s_add_u32 s71, s71, s70
    buffer_load_ushort v44, v10, s[12:15], s71 offen
    s_add_u32 s71, s71, s70
    buffer_load_ushort v45, v10, s[12:15], s71 offen
    s_add_u32 s71, s71, s70
    buffer_load_ushort v46, v10, s[12:15], s71 offen
    s_add_u32 s71, s71, s70
    buffer_load_ushort v47, v10, s[12:15], s71 offen
    s_branch L_k0nxt_15
L_k0perm_14:
    v_cndmask_b32 v11, v10, v15, s[52:53]
    s_mul_i32 s72, s70, 13
    buffer_load_ushort v40, v10, s[12:15], s71 offen
    s_add_u32 s71, s71, s70
    buffer_load_ushort v41, v10, s[12:15], s71 offen
    s_add_u32 s71, s71, s70
    buffer_load_ushort v42, v10, s[12:15], s71 offen
    s_add_u32 s71, s71, s70
    buffer_load_ushort v43, v10, s[12:15], s71 offen
    s_add_u32 s71, s71, s72
    buffer_load_ushort v44, v11, s[12:15], s71 offen
    s_add_u32 s71, s71, s70
    buffer_load_ushort v45, v11, s[12:15], s71 offen
    s_add_u32 s71, s71, s70
    buffer_load_ushort v46, v11, s[12:15], s71 offen
    s_add_u32 s71, s71, s70
    buffer_load_ushort v47, v11, s[12:15], s71 offen
L_k0nxt_15:
    s_add_u32 s50, s49, 4096
    s_mov_b32 s34, s50
    s_cmp_ge_u32 s50, 7480
    s_cbranch_scc1 L_k0nxt_26
    s_cmp_ge_u32 s50, 5688
    s_cbranch_scc1 L_k0t_33
    s_cmp_ge_u32 s50, 4120
    s_cbranch_scc1 L_k0t_31
    s_cmp_ge_u32 s50, 2552
    s_cbranch_scc1 L_k0t_30
    s_cmp_ge_u32 s50, 2160
    s_cbranch_scc1 L_k0t_29
    s_cmp_ge_u32 s50, 1768
    s_cbranch_scc1 L_k0t_28
    s_cmp_ge_u32 s50, 1376
    s_cbranch_scc1 L_k0t_27
    s_cmp_ge_u32 s50, 1344
    s_cbranch_scc1 L_k0t_32
    s_mov_b32 s62, 44739243
    s_mul_hi_u32 s66, s50, s62
    s_mul_i32 s64, s66, 96
    s_sub_u32 s64, s50, s64
    s_lshr_b32 s67, s64, 5
    s_bfe_u32 s63, s64, 0x40001
    s_and_b32 s68, s64, 1
    s_lshl_b32 s65, s67, 1
    s_add_u32 s65, s65, s68
    s_mul_i32 s65, s65, 14
    s_add_u32 s65, s65, s66
    s_mul_i32 s78, s63, 86
    s_add_u32 s78, s78, s65
    s_mul_i32 s67, s67, 448
    s_mul_i32 s69, s63, 28
    s_add_u32 s67, s67, s69
    s_lshl_b32 s69, s68, 4
    s_add_u32 s67, s67, s69
    s_mov_b32 s12, s4
    s_mov_b32 s13, s5
    s_mov_b32 s14, 1204224
    s_mov_b32 s15, 0x00020000
    s_mov_b32 s70, 2688
    s_mul_i32 s71, s66, 32*2688
    v_add_u32 v10, s67, v3
    v_lshlrev_b32 v10, 1, v10
    v_mul_u32_u24 v11, 8*2688, v4
    v_add_u32 v10, v10, v11
    s_cmp_eq_u32 s68, 0
    s_nop 0
    s_cbranch_scc1 L_k0std_24
    v_cndmask_b32 v10, v10, v15, s[54:55]
    s_nop 1
    s_branch L_k0std_24
L_k0t_32:
    s_sub_u32 s64, s50, 1344
    s_lshr_b32 s63, s64, 1
    s_and_b32 s68, s64, 1
    s_mul_i32 s78, s63, 86
    s_add_u32 s78, s78, s68
    s_add_u32 s78, s78, 84
    s_mov_b32 s12, s6
    s_mov_b32 s13, s7
    s_mov_b32 s14, 25088
    s_mov_b32 s15, 0x00020000
    s_mov_b32 s70, 56
    s_mul_i32 s71, s63, 1568
    s_lshl_b32 s69, s68, 4
    v_add_u32 v10, s69, v3
    v_lshlrev_b32 v10, 1, v10
    v_mul_u32_u24 v11, 4*56, v4
    v_add_u32 v10, v10, v11
    s_cmp_eq_u32 s68, 0
    s_nop 0
    s_cbranch_scc1 L_k0perm_25
    v_cndmask_b32 v10, v10, v15, s[54:55]
    s_nop 1
    s_branch L_k0perm_25
L_k0t_27:
    s_sub_u32 s64, s50, 1376
    s_mov_b32 s62, 153391690
    s_mul_hi_u32 s66, s64, s62
    s_mul_i32 s65, s66, 28
    s_sub_u32 s65, s64, s65
    s_mul_i32 s78, s65, 14
    s_add_u32 s78, s78, s66
    s_add_u32 s78, s78, 1376
    s_mov_b32 s12, s36
    s_mov_b32 s13, s37
    s_mov_b32 s14, 401408
    s_mov_b32 s15, 0x00020000
    s_branch L_k0t_34
L_k0t_28:
    s_sub_u32 s64, s50, 1768
    s_mov_b32 s62, 153391690
    s_mul_hi_u32 s66, s64, s62
    s_mul_i32 s65, s66, 28
    s_sub_u32 s65, s64, s65
    s_mul_i32 s78, s65, 14
    s_add_u32 s78, s78, s66
    s_add_u32 s78, s78, 1768
    s_mov_b32 s12, s40
    s_mov_b32 s13, s41
    s_mov_b32 s14, 401408
    s_mov_b32 s15, 0x00020000
    s_branch L_k0t_34
L_k0t_29:
    s_sub_u32 s64, s50, 2160
    s_mov_b32 s62, 153391690
    s_mul_hi_u32 s66, s64, s62
    s_mul_i32 s65, s66, 28
    s_sub_u32 s65, s64, s65
    s_mul_i32 s78, s65, 14
    s_add_u32 s78, s78, s66
    s_add_u32 s78, s78, 2160
    s_mov_b32 s12, s42
    s_mov_b32 s13, s43
    s_mov_b32 s14, 401408
    s_mov_b32 s15, 0x00020000
    s_branch L_k0t_34
L_k0t_31:
    s_sub_u32 s64, s50, 4120
    s_mov_b32 s62, 153391690
    s_mul_hi_u32 s66, s64, s62
    s_mul_i32 s65, s66, 28
    s_sub_u32 s65, s64, s65
    s_mul_i32 s78, s65, 56
    s_add_u32 s78, s78, s66
    s_add_u32 s78, s78, 4120
    s_mov_b32 s12, s46
    s_mov_b32 s13, s47
    s_mov_b32 s14, 1605632
    s_mov_b32 s15, 0x00020000
    s_branch L_k0t_34
L_k0t_34:
    s_mov_b32 s70, 896
    s_mul_i32 s71, s66, 32*896
    s_lshr_b32 s67, s65, 1
    s_lshl_b32 s67, s67, 5
    s_and_b32 s68, s65, 1
    s_lshl_b32 s68, s68, 2
    s_add_u32 s67, s67, s68
    v_add_u32 v10, s67, v8
    v_lshlrev_b32 v10, 1, v10
    v_mul_u32_u24 v11, 8*896, v4
    v_add_u32 v10, v10, v11
    s_nop 1
    s_branch L_k0std_24
L_k0t_33:
    s_mov_b32 s78, s50
    s_sub_u32 s64, s50, 5688
    s_mov_b32 s62, 306783379
    s_mul_hi_u32 s65, s64, s62
    s_mul_i32 s66, s65, 14
    s_sub_u32 s66, s64, s66
    s_mov_b32 s12, s96
    s_mov_b32 s13, s97
    s_mov_b32 s14, 1835008
    s_mov_b32 s15, 0x00020000
    s_mul_i32 s71, s65, 16*896
    s_lshl_b32 s66, s66, 6
    s_add_u32 s71, s71, s66
    v_mul_u32_u24 v10, 896, v3
    v_lshl_add_u32 v10, v4, 4, v10
    buffer_load_dwordx4 v[48:51], v10, s[12:15], s71 offen
    s_nop 0
    s_branch L_k0nxt_26
L_k0t_30:
    s_sub_u32 s64, s50, 2552
    s_mov_b32 s62, 38347923
    s_mul_hi_u32 s66, s64, s62
    s_mul_i32 s65, s66, 112
    s_sub_u32 s65, s64, s65
    s_mul_i32 s78, s65, 14
    s_add_u32 s78, s78, s66
    s_add_u32 s78, s78, 2552
    s_mov_b32 s12, s44
    s_mov_b32 s13, s45
    s_mov_b32 s14, 1605632
    s_mov_b32 s15, 0x00020000
    s_mov_b32 s70, 3584
    s_mul_i32 s71, s66, 32*3584
    s_lshr_b32 s67, s65, 1
    s_lshl_b32 s67, s67, 5
    s_and_b32 s68, s65, 1
    s_lshl_b32 s68, s68, 2
    s_add_u32 s67, s67, s68
    v_add_u32 v10, s67, v8
    v_lshlrev_b32 v10, 1, v10
    v_mul_u32_u24 v11, 8*3584, v4
    v_add_u32 v10, v10, v11
    s_nop 1
L_k0std_24:
    buffer_load_ushort v48, v10, s[12:15], s71 offen
    s_add_u32 s71, s71, s70
    buffer_load_ushort v49, v10, s[12:15], s71 offen
    s_add_u32 s71, s71, s70
    buffer_load_ushort v50, v10, s[12:15], s71 offen
    s_add_u32 s71, s71, s70
    buffer_load_ushort v51, v10, s[12:15], s71 offen
    s_add_u32 s71, s71, s70
    buffer_load_ushort v52, v10, s[12:15], s71 offen
    s_add_u32 s71, s71, s70
    buffer_load_ushort v53, v10, s[12:15], s71 offen
    s_add_u32 s71, s71, s70
    buffer_load_ushort v54, v10, s[12:15], s71 offen
    s_add_u32 s71, s71, s70
    buffer_load_ushort v55, v10, s[12:15], s71 offen
    s_branch L_k0nxt_26
L_k0perm_25:
    v_cndmask_b32 v11, v10, v15, s[52:53]
    s_mul_i32 s72, s70, 13
    buffer_load_ushort v48, v10, s[12:15], s71 offen
    s_add_u32 s71, s71, s70
    buffer_load_ushort v49, v10, s[12:15], s71 offen
    s_add_u32 s71, s71, s70
    buffer_load_ushort v50, v10, s[12:15], s71 offen
    s_add_u32 s71, s71, s70
    buffer_load_ushort v51, v10, s[12:15], s71 offen
    s_add_u32 s71, s71, s72
    buffer_load_ushort v52, v11, s[12:15], s71 offen
    s_add_u32 s71, s71, s70
    buffer_load_ushort v53, v11, s[12:15], s71 offen
    s_add_u32 s71, s71, s70
    buffer_load_ushort v54, v11, s[12:15], s71 offen
    s_add_u32 s71, s71, s70
    buffer_load_ushort v55, v11, s[12:15], s71 offen
L_k0nxt_26:
    s_add_u32 s50, s49, 6144
    s_mov_b32 s35, s50
    s_cmp_ge_u32 s50, 7480
    s_cbranch_scc1 L_k0nxt_37
    s_cmp_ge_u32 s50, 5688
    s_cbranch_scc1 L_k0t_44
    s_cmp_ge_u32 s50, 4120
    s_cbranch_scc1 L_k0t_42
    s_cmp_ge_u32 s50, 2552
    s_cbranch_scc1 L_k0t_41
    s_cmp_ge_u32 s50, 2160
    s_cbranch_scc1 L_k0t_40
    s_cmp_ge_u32 s50, 1768
    s_cbranch_scc1 L_k0t_39
    s_cmp_ge_u32 s50, 1376
    s_cbranch_scc1 L_k0t_38
    s_cmp_ge_u32 s50, 1344
    s_cbranch_scc1 L_k0t_43
    s_mov_b32 s62, 44739243
    s_mul_hi_u32 s66, s50, s62
    s_mul_i32 s64, s66, 96
    s_sub_u32 s64, s50, s64
    s_lshr_b32 s67, s64, 5
    s_bfe_u32 s63, s64, 0x40001
    s_and_b32 s68, s64, 1
    s_lshl_b32 s65, s67, 1
    s_add_u32 s65, s65, s68
    s_mul_i32 s65, s65, 14
    s_add_u32 s65, s65, s66
    s_mul_i32 s79, s63, 86
    s_add_u32 s79, s79, s65
    s_mul_i32 s67, s67, 448
    s_mul_i32 s69, s63, 28
    s_add_u32 s67, s67, s69
    s_lshl_b32 s69, s68, 4
    s_add_u32 s67, s67, s69
    s_mov_b32 s12, s4
    s_mov_b32 s13, s5
    s_mov_b32 s14, 1204224
    s_mov_b32 s15, 0x00020000
    s_mov_b32 s70, 2688
    s_mul_i32 s71, s66, 32*2688
    v_add_u32 v10, s67, v3
    v_lshlrev_b32 v10, 1, v10
    v_mul_u32_u24 v11, 8*2688, v4
    v_add_u32 v10, v10, v11
    s_cmp_eq_u32 s68, 0
    s_nop 0
    s_cbranch_scc1 L_k0std_35
    v_cndmask_b32 v10, v10, v15, s[54:55]
    s_nop 1
    s_branch L_k0std_35
L_k0t_43:
    s_sub_u32 s64, s50, 1344
    s_lshr_b32 s63, s64, 1
    s_and_b32 s68, s64, 1
    s_mul_i32 s79, s63, 86
    s_add_u32 s79, s79, s68
    s_add_u32 s79, s79, 84
    s_mov_b32 s12, s6
    s_mov_b32 s13, s7
    s_mov_b32 s14, 25088
    s_mov_b32 s15, 0x00020000
    s_mov_b32 s70, 56
    s_mul_i32 s71, s63, 1568
    s_lshl_b32 s69, s68, 4
    v_add_u32 v10, s69, v3
    v_lshlrev_b32 v10, 1, v10
    v_mul_u32_u24 v11, 4*56, v4
    v_add_u32 v10, v10, v11
    s_cmp_eq_u32 s68, 0
    s_nop 0
    s_cbranch_scc1 L_k0perm_36
    v_cndmask_b32 v10, v10, v15, s[54:55]
    s_nop 1
    s_branch L_k0perm_36
L_k0t_38:
    s_sub_u32 s64, s50, 1376
    s_mov_b32 s62, 153391690
    s_mul_hi_u32 s66, s64, s62
    s_mul_i32 s65, s66, 28
    s_sub_u32 s65, s64, s65
    s_mul_i32 s79, s65, 14
    s_add_u32 s79, s79, s66
    s_add_u32 s79, s79, 1376
    s_mov_b32 s12, s36
    s_mov_b32 s13, s37
    s_mov_b32 s14, 401408
    s_mov_b32 s15, 0x00020000
    s_branch L_k0t_45
L_k0t_39:
    s_sub_u32 s64, s50, 1768
    s_mov_b32 s62, 153391690
    s_mul_hi_u32 s66, s64, s62
    s_mul_i32 s65, s66, 28
    s_sub_u32 s65, s64, s65
    s_mul_i32 s79, s65, 14
    s_add_u32 s79, s79, s66
    s_add_u32 s79, s79, 1768
    s_mov_b32 s12, s40
    s_mov_b32 s13, s41
    s_mov_b32 s14, 401408
    s_mov_b32 s15, 0x00020000
    s_branch L_k0t_45
L_k0t_40:
    s_sub_u32 s64, s50, 2160
    s_mov_b32 s62, 153391690
    s_mul_hi_u32 s66, s64, s62
    s_mul_i32 s65, s66, 28
    s_sub_u32 s65, s64, s65
    s_mul_i32 s79, s65, 14
    s_add_u32 s79, s79, s66
    s_add_u32 s79, s79, 2160
    s_mov_b32 s12, s42
    s_mov_b32 s13, s43
    s_mov_b32 s14, 401408
    s_mov_b32 s15, 0x00020000
    s_branch L_k0t_45
L_k0t_42:
    s_sub_u32 s64, s50, 4120
    s_mov_b32 s62, 153391690
    s_mul_hi_u32 s66, s64, s62
    s_mul_i32 s65, s66, 28
    s_sub_u32 s65, s64, s65
    s_mul_i32 s79, s65, 56
    s_add_u32 s79, s79, s66
    s_add_u32 s79, s79, 4120
    s_mov_b32 s12, s46
    s_mov_b32 s13, s47
    s_mov_b32 s14, 1605632
    s_mov_b32 s15, 0x00020000
    s_branch L_k0t_45
L_k0t_45:
    s_mov_b32 s70, 896
    s_mul_i32 s71, s66, 32*896
    s_lshr_b32 s67, s65, 1
    s_lshl_b32 s67, s67, 5
    s_and_b32 s68, s65, 1
    s_lshl_b32 s68, s68, 2
    s_add_u32 s67, s67, s68
    v_add_u32 v10, s67, v8
    v_lshlrev_b32 v10, 1, v10
    v_mul_u32_u24 v11, 8*896, v4
    v_add_u32 v10, v10, v11
    s_nop 1
    s_branch L_k0std_35
L_k0t_44:
    s_mov_b32 s79, s50
    s_sub_u32 s64, s50, 5688
    s_mov_b32 s62, 306783379
    s_mul_hi_u32 s65, s64, s62
    s_mul_i32 s66, s65, 14
    s_sub_u32 s66, s64, s66
    s_mov_b32 s12, s96
    s_mov_b32 s13, s97
    s_mov_b32 s14, 1835008
    s_mov_b32 s15, 0x00020000
    s_mul_i32 s71, s65, 16*896
    s_lshl_b32 s66, s66, 6
    s_add_u32 s71, s71, s66
    v_mul_u32_u24 v10, 896, v3
    v_lshl_add_u32 v10, v4, 4, v10
    buffer_load_dwordx4 v[56:59], v10, s[12:15], s71 offen
    s_nop 0
    s_branch L_k0nxt_37
L_k0t_41:
    s_sub_u32 s64, s50, 2552
    s_mov_b32 s62, 38347923
    s_mul_hi_u32 s66, s64, s62
    s_mul_i32 s65, s66, 112
    s_sub_u32 s65, s64, s65
    s_mul_i32 s79, s65, 14
    s_add_u32 s79, s79, s66
    s_add_u32 s79, s79, 2552
    s_mov_b32 s12, s44
    s_mov_b32 s13, s45
    s_mov_b32 s14, 1605632
    s_mov_b32 s15, 0x00020000
    s_mov_b32 s70, 3584
    s_mul_i32 s71, s66, 32*3584
    s_lshr_b32 s67, s65, 1
    s_lshl_b32 s67, s67, 5
    s_and_b32 s68, s65, 1
    s_lshl_b32 s68, s68, 2
    s_add_u32 s67, s67, s68
    v_add_u32 v10, s67, v8
    v_lshlrev_b32 v10, 1, v10
    v_mul_u32_u24 v11, 8*3584, v4
    v_add_u32 v10, v10, v11
    s_nop 1
L_k0std_35:
    buffer_load_ushort v56, v10, s[12:15], s71 offen
    s_add_u32 s71, s71, s70
    buffer_load_ushort v57, v10, s[12:15], s71 offen
    s_add_u32 s71, s71, s70
    buffer_load_ushort v58, v10, s[12:15], s71 offen
    s_add_u32 s71, s71, s70
    buffer_load_ushort v59, v10, s[12:15], s71 offen
    s_add_u32 s71, s71, s70
    buffer_load_ushort v60, v10, s[12:15], s71 offen
    s_add_u32 s71, s71, s70
    buffer_load_ushort v61, v10, s[12:15], s71 offen
    s_add_u32 s71, s71, s70
    buffer_load_ushort v62, v10, s[12:15], s71 offen
    s_add_u32 s71, s71, s70
    buffer_load_ushort v63, v10, s[12:15], s71 offen
    s_branch L_k0nxt_37
L_k0perm_36:
    v_cndmask_b32 v11, v10, v15, s[52:53]
    s_mul_i32 s72, s70, 13
    buffer_load_ushort v56, v10, s[12:15], s71 offen
    s_add_u32 s71, s71, s70
    buffer_load_ushort v57, v10, s[12:15], s71 offen
    s_add_u32 s71, s71, s70
    buffer_load_ushort v58, v10, s[12:15], s71 offen
    s_add_u32 s71, s71, s70
    buffer_load_ushort v59, v10, s[12:15], s71 offen
    s_add_u32 s71, s71, s72
    buffer_load_ushort v60, v11, s[12:15], s71 offen
    s_add_u32 s71, s71, s70
    buffer_load_ushort v61, v11, s[12:15], s71 offen
    s_add_u32 s71, s71, s70
    buffer_load_ushort v62, v11, s[12:15], s71 offen
    s_add_u32 s71, s71, s70
    buffer_load_ushort v63, v11, s[12:15], s71 offen
L_k0nxt_37:
    s_waitcnt vmcnt(0)
    s_mov_b32 s50, s32
    s_cmp_ge_u32 s50, 7480
    s_cbranch_scc1 L_k0sx_46
    s_cmp_ge_u32 s50, 5688
    s_cbranch_scc1 L_k0st_47
    v_lshl_or_b32 v32, v33, 16, v32
    v_lshl_or_b32 v33, v35, 16, v34
    v_lshl_or_b32 v34, v37, 16, v36
    v_lshl_or_b32 v35, v39, 16, v38
    s_nop 1
L_k0st_47:
    s_lshl_b32 s71, s76, 10
    buffer_store_dwordx4 v[32:35], v2, s[8:11], s71 offen sc1
    s_nop 1
L_k0sx_46:
    s_mov_b32 s50, s33
    s_cmp_ge_u32 s50, 7480
    s_cbranch_scc1 L_k0sx_48
    s_cmp_ge_u32 s50, 5688
    s_cbranch_scc1 L_k0st_49
    v_lshl_or_b32 v40, v41, 16, v40
    v_lshl_or_b32 v41, v43, 16, v42
    v_lshl_or_b32 v42, v45, 16, v44
    v_lshl_or_b32 v43, v47, 16, v46
    s_nop 1
L_k0st_49:
    s_lshl_b32 s71, s77, 10
    buffer_store_dwordx4 v[40:43], v2, s[8:11], s71 offen sc1
    s_nop 1
L_k0sx_48:
    s_mov_b32 s50, s34
    s_cmp_ge_u32 s50, 7480
    s_cbranch_scc1 L_k0sx_50
    s_cmp_ge_u32 s50, 5688
    s_cbranch_scc1 L_k0st_51
    v_lshl_or_b32 v48, v49, 16, v48
    v_lshl_or_b32 v49, v51, 16, v50
    v_lshl_or_b32 v50, v53, 16, v52
    v_lshl_or_b32 v51, v55, 16, v54
    s_nop 1
L_k0st_51:
    s_lshl_b32 s71, s78, 10
    buffer_store_dwordx4 v[48:51], v2, s[8:11], s71 offen sc1
    s_nop 1
L_k0sx_50:
    s_mov_b32 s50, s35
    s_cmp_ge_u32 s50, 7480
    s_cbranch_scc1 L_k0sx_52
    s_cmp_ge_u32 s50, 5688
    s_cbranch_scc1 L_k0st_53
    v_lshl_or_b32 v56, v57, 16, v56
    v_lshl_or_b32 v57, v59, 16, v58
    v_lshl_or_b32 v58, v61, 16, v60
    v_lshl_or_b32 v59, v63, 16, v62
    s_nop 1
L_k0st_53:
    s_lshl_b32 s71, s79, 10
    buffer_store_dwordx4 v[56:59], v2, s[8:11], s71 offen sc1
    s_nop 1
L_k0sx_52:
    s_waitcnt vmcnt(0)
    s_barrier
    s_cmp_lg_u32 s3, 0
    s_cbranch_scc1 L_pbsk_54
    s_mov_b32 s28, s92
    s_mov_b32 s29, s93
    s_mov_b32 s30, 256
    s_mov_b32 s31, 0x00020000
    v_mov_b32 v6, 0
    s_mov_b32 s50, 0
    s_nop 0
L_tklp_55:
    buffer_load_dwordx2 v[8:9], v6, s[28:31], 0 offen sc1
    s_waitcnt vmcnt(0)
    v_readfirstlane_b32 s100, v8
    v_readfirstlane_b32 s101, v9
    s_cmp_lg_u32 s100, 0
    s_nop 3
    s_cbranch_scc1 L_tkdn_56
    s_sleep 1
    s_add_u32 s50, s50, 1
    s_cmp_lt_u32 s50, 65536
    s_cbranch_scc1 L_tklp_55
L_tkdn_56:
    s_add_u32 s28, s94, 42803200
    s_addc_u32 s29, s95, 0
    s_mov_b32 s30, 2048
    s_mov_b32 s31, 0x00020000
    s_getreg_b32 s51, hwreg(HW_REG_XCC_ID, 0, 4)
    s_and_b32 s51, s51, 7
    s_add_u32 s44, s51, 1
    s_or_b32 s45, s44, s101
    s_or_b32 s45, s45, 0
    v_mov_b32 v6, s100
    v_mov_b32 v7, s45
    s_lshl_b32 s45, s2, 3
    v_mov_b32 v8, s45
    s_mov_b64 exec, 1
    buffer_store_dwordx2 v[6:7], v8, s[28:31], 0 offen sc1
    s_mov_b64 exec, -1
    s_add_u32 s28, s94, 42803200
    s_addc_u32 s29, s95, 0
    s_mov_b32 s30, 2048
    s_mov_b32 s31, 0x00020000
    v_lshlrev_b32 v6, 5, v1
    s_mov_b32 s50, 0
    s_or_b32 s48, s101, 0
    s_mov_b32 s49, 0xffffff00
L_pblp_57:
    buffer_load_dwordx4 v[16:19], v6, s[28:31], 0 offen sc1
    buffer_load_dwordx4 v[20:23], v6, s[28:31], 0 offen offset:16 sc1
    s_waitcnt vmcnt(0)
    v_cmp_eq_u32 vcc, s100, v16
    v_cmp_eq_u32 s[62:63], s100, v18
    s_nop 0
    s_and_b64 vcc, vcc, s[62:63]
    v_cmp_eq_u32 s[62:63], s100, v20
    s_nop 0
    s_and_b64 vcc, vcc, s[62:63]
    v_cmp_eq_u32 s[62:63], s100, v22
    s_nop 0
    s_and_b64 vcc, vcc, s[62:63]
    v_and_b32 v8, s49, v17
    v_cmp_eq_u32 s[62:63], s48, v8
    s_nop 0
    s_and_b64 vcc, vcc, s[62:63]
    v_and_b32 v8, s49, v19
    v_cmp_eq_u32 s[62:63], s48, v8
    s_nop 0
    s_and_b64 vcc, vcc, s[62:63]
    v_and_b32 v8, s49, v21
    v_cmp_eq_u32 s[62:63], s48, v8
    s_nop 0
    s_and_b64 vcc, vcc, s[62:63]
    v_and_b32 v8, s49, v23
    v_cmp_eq_u32 s[62:63], s48, v8
    s_nop 0
    s_and_b64 vcc, vcc, s[62:63]
    s_cmp_eq_u64 vcc, -1
    s_nop 1
    s_cbranch_scc1 L_pbdn_58
    s_sleep 1
    s_add_u32 s50, s50, 1
    s_cmp_lt_u32 s50, 65536
    s_cbranch_scc1 L_pblp_57
L_pbdn_58:
    v_and_b32 v10, 15, v17
    v_and_b32 v11, 15, v19
    v_and_b32 v12, 15, v21
    v_and_b32 v13, 15, v23
    s_lshr_b32 s45, s2, 2
    s_and_b32 s46, s2, 3
    s_bfm_b64 s[62:63], s45, 0
    s_mov_b32 s47, 0
    v_cmp_eq_u32 vcc, s44, v10
    s_nop 0
    s_bcnt1_i32_b64 s64, vcc
    s_and_b64 vcc, vcc, s[62:63]
    s_bcnt1_i32_b64 s65, vcc
    s_cmp_gt_u32 s46, 0
    s_cselect_b32 s64, s64, 0
    s_cmp_eq_u32 s46, 0
    s_cselect_b32 s65, s65, 0
    s_add_u32 s47, s47, s64
    s_add_u32 s47, s47, s65
    v_cmp_eq_u32 vcc, s44, v11
    s_nop 0
    s_bcnt1_i32_b64 s64, vcc
    s_and_b64 vcc, vcc, s[62:63]
    s_bcnt1_i32_b64 s65, vcc
    s_cmp_gt_u32 s46, 1
    s_cselect_b32 s64, s64, 0
    s_cmp_eq_u32 s46, 1
    s_cselect_b32 s65, s65, 0
    s_add_u32 s47, s47, s64
    s_add_u32 s47, s47, s65
    v_cmp_eq_u32 vcc, s44, v12
    s_nop 0
    s_bcnt1_i32_b64 s64, vcc
    s_and_b64 vcc, vcc, s[62:63]
    s_bcnt1_i32_b64 s65, vcc
    s_cmp_gt_u32 s46, 2
    s_cselect_b32 s64, s64, 0
    s_cmp_eq_u32 s46, 2
    s_cselect_b32 s65, s65, 0
    s_add_u32 s47, s47, s64
    s_add_u32 s47, s47, s65
    v_cmp_eq_u32 vcc, s44, v13
    s_nop 0
    s_bcnt1_i32_b64 s64, vcc
    s_and_b64 vcc, vcc, s[62:63]
    s_bcnt1_i32_b64 s65, vcc
    s_cmp_gt_u32 s46, 3
    s_cselect_b32 s64, s64, 0
    s_cmp_eq_u32 s46, 3
    s_cselect_b32 s65, s65, 0
    s_add_u32 s47, s47, s64
    s_add_u32 s47, s47, s65
    s_mov_b32 s80, 0
    s_mov_b32 s66, 0
    v_cmp_eq_u32 vcc, 1, v10
    s_nop 0
    s_bcnt1_i32_b64 s64, vcc
    s_add_u32 s66, s66, s64
    v_cmp_eq_u32 vcc, 1, v11
    s_nop 0
    s_bcnt1_i32_b64 s64, vcc
    s_add_u32 s66, s66, s64
    v_cmp_eq_u32 vcc, 1, v12
    s_nop 0
    s_bcnt1_i32_b64 s64, vcc
    s_add_u32 s66, s66, s64
    v_cmp_eq_u32 vcc, 1, v13
    s_nop 0
    s_bcnt1_i32_b64 s64, vcc
    s_add_u32 s66, s66, s64
    s_cmp_lg_u32 s66, 32
    s_cselect_b32 s80, 1, s80
    s_mov_b32 s66, 0
    v_cmp_eq_u32 vcc, 2, v10
    s_nop 0
    s_bcnt1_i32_b64 s64, vcc
    s_add_u32 s66, s66, s64
    v_cmp_eq_u32 vcc, 2, v11
    s_nop 0
    s_bcnt1_i32_b64 s64, vcc
    s_add_u32 s66, s66, s64
    v_cmp_eq_u32 vcc, 2, v12
    s_nop 0
    s_bcnt1_i32_b64 s64, vcc
    s_add_u32 s66, s66, s64
    v_cmp_eq_u32 vcc, 2, v13
    s_nop 0
    s_bcnt1_i32_b64 s64, vcc
    s_add_u32 s66, s66, s64
    s_cmp_lg_u32 s66, 32
    s_cselect_b32 s80, 1, s80
    s_mov_b32 s66, 0
    v_cmp_eq_u32 vcc, 3, v10
    s_nop 0
    s_bcnt1_i32_b64 s64, vcc
    s_add_u32 s66, s66, s64
    v_cmp_eq_u32 vcc, 3, v11
    s_nop 0
    s_bcnt1_i32_b64 s64, vcc
    s_add_u32 s66, s66, s64
    v_cmp_eq_u32 vcc, 3, v12
    s_nop 0
    s_bcnt1_i32_b64 s64, vcc
    s_add_u32 s66, s66, s64
    v_cmp_eq_u32 vcc, 3, v13
    s_nop 0
    s_bcnt1_i32_b64 s64, vcc
    s_add_u32 s66, s66, s64
    s_cmp_lg_u32 s66, 32
    s_cselect_b32 s80, 1, s80
    s_mov_b32 s66, 0
    v_cmp_eq_u32 vcc, 4, v10
    s_nop 0
    s_bcnt1_i32_b64 s64, vcc
    s_add_u32 s66, s66, s64
    v_cmp_eq_u32 vcc, 4, v11
    s_nop 0
    s_bcnt1_i32_b64 s64, vcc
    s_add_u32 s66, s66, s64
    v_cmp_eq_u32 vcc, 4, v12
    s_nop 0
    s_bcnt1_i32_b64 s64, vcc
    s_add_u32 s66, s66, s64
    v_cmp_eq_u32 vcc, 4, v13
    s_nop 0
    s_bcnt1_i32_b64 s64, vcc
    s_add_u32 s66, s66, s64
    s_cmp_lg_u32 s66, 32
    s_cselect_b32 s80, 1, s80
    s_mov_b32 s66, 0
    v_cmp_eq_u32 vcc, 5, v10
    s_nop 0
    s_bcnt1_i32_b64 s64, vcc
    s_add_u32 s66, s66, s64
    v_cmp_eq_u32 vcc, 5, v11
    s_nop 0
    s_bcnt1_i32_b64 s64, vcc
    s_add_u32 s66, s66, s64
    v_cmp_eq_u32 vcc, 5, v12
    s_nop 0
    s_bcnt1_i32_b64 s64, vcc
    s_add_u32 s66, s66, s64
    v_cmp_eq_u32 vcc, 5, v13
    s_nop 0
    s_bcnt1_i32_b64 s64, vcc
    s_add_u32 s66, s66, s64
    s_cmp_lg_u32 s66, 32
    s_cselect_b32 s80, 1, s80
    s_mov_b32 s66, 0
    v_cmp_eq_u32 vcc, 6, v10
    s_nop 0
    s_bcnt1_i32_b64 s64, vcc
    s_add_u32 s66, s66, s64
    v_cmp_eq_u32 vcc, 6, v11
    s_nop 0
    s_bcnt1_i32_b64 s64, vcc
    s_add_u32 s66, s66, s64
    v_cmp_eq_u32 vcc, 6, v12
    s_nop 0
    s_bcnt1_i32_b64 s64, vcc
    s_add_u32 s66, s66, s64
    v_cmp_eq_u32 vcc, 6, v13
    s_nop 0
    s_bcnt1_i32_b64 s64, vcc
    s_add_u32 s66, s66, s64
    s_cmp_lg_u32 s66, 32
    s_cselect_b32 s80, 1, s80
    s_mov_b32 s66, 0
    v_cmp_eq_u32 vcc, 7, v10
    s_nop 0
    s_bcnt1_i32_b64 s64, vcc
    s_add_u32 s66, s66, s64
    v_cmp_eq_u32 vcc, 7, v11
    s_nop 0
    s_bcnt1_i32_b64 s64, vcc
    s_add_u32 s66, s66, s64
    v_cmp_eq_u32 vcc, 7, v12
    s_nop 0
    s_bcnt1_i32_b64 s64, vcc
    s_add_u32 s66, s66, s64
    v_cmp_eq_u32 vcc, 7, v13
    s_nop 0
    s_bcnt1_i32_b64 s64, vcc
    s_add_u32 s66, s66, s64
    s_cmp_lg_u32 s66, 32
    s_cselect_b32 s80, 1, s80
    s_mov_b32 s66, 0
    v_cmp_eq_u32 vcc, 8, v10
    s_nop 0
    s_bcnt1_i32_b64 s64, vcc
    s_add_u32 s66, s66, s64
    v_cmp_eq_u32 vcc, 8, v11
    s_nop 0
    s_bcnt1_i32_b64 s64, vcc
    s_add_u32 s66, s66, s64
    v_cmp_eq_u32 vcc, 8, v12
    s_nop 0
    s_bcnt1_i32_b64 s64, vcc
    s_add_u32 s66, s66, s64
    v_cmp_eq_u32 vcc, 8, v13
    s_nop 0
    s_bcnt1_i32_b64 s64, vcc
    s_add_u32 s66, s66, s64
    s_cmp_lg_u32 s66, 32
    s_cselect_b32 s80, 1, s80
    s_lshl_b32 s47, s47, 3
    s_add_u32 s47, s47, s51
    s_cmp_lg_u32 s80, 0
    s_cselect_b32 s47, s2, s47
    v_mov_b32 v8, s47
    v_mov_b32 v9, s80
    v_mov_b32 v6, 163832
    ds_write_b64 v6, v[8:9]
    s_waitcnt lgkmcnt(0)
L_pbsk_54:
    s_barrier
    v_mov_b32 v6, 163832
    ds_read_b64 v[8:9], v6
    s_waitcnt lgkmcnt(0)
    v_readfirstlane_b32 s81, v8
    v_readfirstlane_b32 s80, v9
    s_mov_b32 s44, 613566757
    s_lshr_b32 s45, s81, 3
    s_mul_hi_u32 s84, s45, s44
    s_mul_i32 s85, s84, 7
    s_sub_u32 s85, s45, s85
    s_and_b32 s45, s81, 7
    s_lshl_b32 s45, s45, 2
    s_add_u32 s84, s84, s45
    s_and_b32 s86, s81, 7
    s_lshl_b32 s86, s86, 1
    s_lshr_b32 s45, s81, 7
    s_add_u32 s86, s86, s45
    s_lshr_b32 s87, s81, 3
    s_and_b32 s87, s87, 15
    s_and_b32 s88, s3, 3
    s_lshr_b32 s89, s3, 2
    s_mov_b32 s44, 306783379
    s_lshr_b32 s45, s81, 3
    s_mul_hi_u32 s82, s45, s44
    s_mul_i32 s83, s82, 14
    s_sub_u32 s83, s45, s83
    s_and_b32 s45, s81, 7
    s_lshl_b32 s45, s45, 1
    s_add_u32 s82, s82, s45
    s_mul_i32 s42, s87, 88064
    s_add_u32 s12, s94, s42
    s_addc_u32 s13, s95, 0
    s_mov_b32 s14, 88064
    s_mov_b32 s15, 0x00020000
    s_mul_i32 s43, s3, 11
    s_lshl_b32 s44, s43, 10
    s_add_u32 s45, s44, 0
    s_mov_b32 m0, s45
    s_nop 0
    buffer_load_dwordx4 v2, s[12:15], s44 offen offset:0 lds
    buffer_load_dwordx4 v2, s[12:15], s44 offen offset:1024 lds
    buffer_load_dwordx4 v2, s[12:15], s44 offen offset:2048 lds
    buffer_load_dwordx4 v2, s[12:15], s44 offen offset:3072 lds
    s_add_u32 s44, s44, 4096
    s_add_u32 s45, s45, 4096
    s_mov_b32 m0, s45
    s_nop 0
    buffer_load_dwordx4 v2, s[12:15], s44 offen offset:0 lds
    buffer_load_dwordx4 v2, s[12:15], s44 offen offset:1024 lds
    buffer_load_dwordx4 v2, s[12:15], s44 offen offset:2048 lds
    buffer_load_dwordx4 v2, s[12:15], s44 offen offset:3072 lds
    s_add_u32 s44, s44, 4096
    s_add_u32 s45, s45, 4096
    s_mov_b32 m0, s45
    s_nop 0
    buffer_load_dwordx4 v2, s[12:15], s44 offen offset:0 lds
    s_cmp_eq_u32 s3, 7
    s_cbranch_scc1 L_k1skip_59
    s_add_u32 s43, s43, 9
    s_lshl_b32 s44, s43, 10
    s_add_u32 s45, s44, 0
    s_mov_b32 m0, s45
    s_nop 0
    buffer_load_dwordx4 v2, s[12:15], s44 offen offset:0 lds
    buffer_load_dwordx4 v2, s[12:15], s44 offen offset:1024 lds
L_k1skip_59:
    s_add_u32 s8, s94, 5824512
    s_addc_u32 s9, s95, 0
    s_mov_b32 s10, 1835008
    s_mov_b32 s11, 0x00020000
    s_lshl_b32 s47, s86, 3
    s_add_u32 s47, s47, s3
    s_mul_i32 s44, s47, 14336
    buffer_load_dwordx4 v[16:19], v2, s[8:11], s44 offen offset:0
    buffer_load_dwordx4 v[20:23], v2, s[8:11], s44 offen offset:1024
    buffer_load_dwordx4 v[24:27], v2, s[8:11], s44 offen offset:2048
    buffer_load_dwordx4 v[28:31], v2, s[8:11], s44 offen offset:3072
    s_add_u32 s44, s44, 4096
    buffer_load_dwordx4 v[32:35], v2, s[8:11], s44 offen offset:0
    buffer_load_dwordx4 v[36:39], v2, s[8:11], s44 offen offset:1024
    buffer_load_dwordx4 v[40:43], v2, s[8:11], s44 offen offset:2048
    buffer_load_dwordx4 v[44:47], v2, s[8:11], s44 offen offset:3072
    s_add_u32 s44, s44, 4096
    buffer_load_dwordx4 v[48:51], v2, s[8:11], s44 offen offset:0
    buffer_load_dwordx4 v[52:55], v2, s[8:11], s44 offen offset:1024
    buffer_load_dwordx4 v[56:59], v2, s[8:11], s44 offen offset:2048
    buffer_load_dwordx4 v[60:63], v2, s[8:11], s44 offen offset:3072
    s_add_u32 s44, s44, 4096
    buffer_load_dwordx4 v[64:67], v2, s[8:11], s44 offen offset:0
    buffer_load_dwordx4 v[68:71], v2, s[8:11], s44 offen offset:1024
    s_waitcnt vmcnt(0)
    v_mov_b32 v8, 0
    v_mov_b32 v9, 0
    v_mov_b32 v10, 0
    v_mov_b32 v11, 0
    v_dot2_f32_bf16 v8, v16, s60, v8
    v_dot2_f32_bf16 v9, v16, v16, v9
    v_dot2_f32_bf16 v10, v17, s60, v10
    v_dot2_f32_bf16 v11, v17, v17, v11
    v_dot2_f32_bf16 v8, v18, s60, v8
    v_dot2_f32_bf16 v9, v18, v18, v9
    v_dot2_f32_bf16 v10, v19, s60, v10
    v_dot2_f32_bf16 v11, v19, v19, v11
    v_dot2_f32_bf16 v8, v20, s60, v8
    v_dot2_f32_bf16 v9, v20, v20, v9
    v_dot2_f32_bf16 v10, v21, s60, v10
    v_dot2_f32_bf16 v11, v21, v21, v11
    v_dot2_f32_bf16 v8, v22, s60, v8
    v_dot2_f32_bf16 v9, v22, v22, v9
    v_dot2_f32_bf16 v10, v23, s60, v10
    v_dot2_f32_bf16 v11, v23, v23, v11
    v_dot2_f32_bf16 v8, v24, s60, v8
    v_dot2_f32_bf16 v9, v24, v24, v9
    v_dot2_f32_bf16 v10, v25, s60, v10
    v_dot2_f32_bf16 v11, v25, v25, v11
    v_dot2_f32_bf16 v8, v26, s60, v8
    v_dot2_f32_bf16 v9, v26, v26, v9
    v_dot2_f32_bf16 v10, v27, s60, v10
    v_dot2_f32_bf16 v11, v27, v27, v11
    v_dot2_f32_bf16 v8, v28, s60, v8
    v_dot2_f32_bf16 v9, v28, v28, v9
    v_dot2_f32_bf16 v10, v29, s60, v10
    v_dot2_f32_bf16 v11, v29, v29, v11
    v_dot2_f32_bf16 v8, v30, s60, v8
    v_dot2_f32_bf16 v9, v30, v30, v9
    v_dot2_f32_bf16 v10, v31, s60, v10
    v_dot2_f32_bf16 v11, v31, v31, v11
    v_dot2_f32_bf16 v8, v32, s60, v8
    v_dot2_f32_bf16 v9, v32, v32, v9
    v_dot2_f32_bf16 v10, v33, s60, v10
    v_dot2_f32_bf16 v11, v33, v33, v11
    v_dot2_f32_bf16 v8, v34, s60, v8
    v_dot2_f32_bf16 v9, v34, v34, v9
    v_dot2_f32_bf16 v10, v35, s60, v10
    v_dot2_f32_bf16 v11, v35, v35, v11
    v_dot2_f32_bf16 v8, v36, s60, v8
    v_dot2_f32_bf16 v9, v36, v36, v9
    v_dot2_f32_bf16 v10, v37, s60, v10
    v_dot2_f32_bf16 v11, v37, v37, v11
    v_dot2_f32_bf16 v8, v38, s60, v8
    v_dot2_f32_bf16 v9, v38, v38, v9
    v_dot2_f32_bf16 v10, v39, s60, v10
    v_dot2_f32_bf16 v11, v39, v39, v11
    v_dot2_f32_bf16 v8, v40, s60, v8
    v_dot2_f32_bf16 v9, v40, v40, v9
    v_dot2_f32_bf16 v10, v41, s60, v10
    v_dot2_f32_bf16 v11, v41, v41, v11
    v_dot2_f32_bf16 v8, v42, s60, v8
    v_dot2_f32_bf16 v9, v42, v42, v9
    v_dot2_f32_bf16 v10, v43, s60, v10
    v_dot2_f32_bf16 v11, v43, v43, v11
    v_dot2_f32_bf16 v8, v44, s60, v8
    v_dot2_f32_bf16 v9, v44, v44, v9
    v_dot2_f32_bf16 v10, v45, s60, v10
    v_dot2_f32_bf16 v11, v45, v45, v11
    v_dot2_f32_bf16 v8, v46, s60, v8
    v_dot2_f32_bf16 v9, v46, v46, v9
    v_dot2_f32_bf16 v10, v47, s60, v10
    v_dot2_f32_bf16 v11, v47, v47, v11
    v_dot2_f32_bf16 v8, v48, s60, v8
    v_dot2_f32_bf16 v9, v48, v48, v9
    v_dot2_f32_bf16 v10, v49, s60, v10
    v_dot2_f32_bf16 v11, v49, v49, v11
    v_dot2_f32_bf16 v8, v50, s60, v8
    v_dot2_f32_bf16 v9, v50, v50, v9
    v_dot2_f32_bf16 v10, v51, s60, v10
    v_dot2_f32_bf16 v11, v51, v51, v11
    v_dot2_f32_bf16 v8, v52, s60, v8
    v_dot2_f32_bf16 v9, v52, v52, v9
    v_dot2_f32_bf16 v10, v53, s60, v10
    v_dot2_f32_bf16 v11, v53, v53, v11
    v_dot2_f32_bf16 v8, v54, s60, v8
    v_dot2_f32_bf16 v9, v54, v54, v9
    v_dot2_f32_bf16 v10, v55, s60, v10
    v_dot2_f32_bf16 v11, v55, v55, v11
    v_dot2_f32_bf16 v8, v56, s60, v8
    v_dot2_f32_bf16 v9, v56, v56, v9
    v_dot2_f32_bf16 v10, v57, s60, v10
    v_dot2_f32_bf16 v11, v57, v57, v11
    v_dot2_f32_bf16 v8, v58, s60, v8
    v_dot2_f32_bf16 v9, v58, v58, v9
    v_dot2_f32_bf16 v10, v59, s60, v10
    v_dot2_f32_bf16 v11, v59, v59, v11
    v_dot2_f32_bf16 v8, v60, s60, v8
    v_dot2_f32_bf16 v9, v60, v60, v9
    v_dot2_f32_bf16 v10, v61, s60, v10
    v_dot2_f32_bf16 v11, v61, v61, v11
    v_dot2_f32_bf16 v8, v62, s60, v8
    v_dot2_f32_bf16 v9, v62, v62, v9
    v_dot2_f32_bf16 v10, v63, s60, v10
    v_dot2_f32_bf16 v11, v63, v63, v11
    v_dot2_f32_bf16 v8, v64, s60, v8
    v_dot2_f32_bf16 v9, v64, v64, v9
    v_dot2_f32_bf16 v10, v65, s60, v10
    v_dot2_f32_bf16 v11, v65, v65, v11
    v_dot2_f32_bf16 v8, v66, s60, v8
    v_dot2_f32_bf16 v9, v66, v66, v9
    v_dot2_f32_bf16 v10, v67, s60, v10
    v_dot2_f32_bf16 v11, v67, v67, v11
    v_dot2_f32_bf16 v8, v68, s60, v8
    v_dot2_f32_bf16 v9, v68, v68, v9
    v_dot2_f32_bf16 v10, v69, s60, v10
    v_dot2_f32_bf16 v11, v69, v69, v11
    v_dot2_f32_bf16 v8, v70, s60, v8
    v_dot2_f32_bf16 v9, v70, v70, v9
    v_dot2_f32_bf16 v10, v71, s60, v10
    v_dot2_f32_bf16 v11, v71, v71, v11
    s_nop 1
    v_add_f32 v8, v8, v10
    v_add_f32 v9, v9, v11
    v_mov_b32 v10, v8
    s_nop 1
    v_permlane32_swap_b32 v8, v10
    v_add_f32 v8, v8, v10
    v_mov_b32 v10, v8
    s_nop 1
    v_permlane16_swap_b32 v8, v10
    v_add_f32 v8, v8, v10
    v_mov_b32 v11, v9
    s_nop 1
    v_permlane32_swap_b32 v9, v11
    v_add_f32 v9, v9, v11
    v_mov_b32 v11, v9
    s_nop 1
    v_permlane16_swap_b32 v9, v11
    v_add_f32 v9, v9, v11
    v_mul_f32 v8, 0x3b124925, v8
    v_mul_f32 v9, 0x3b124925, v9
    v_fma_f32 v9, -v8, v8, v9
    v_max_f32 v9, 0, v9
    v_cvt_pk_bf16_f32 v8, v8, v8
    v_and_b32 v8, 0xffff0000, v8
    v_cvt_pk_bf16_f32 v9, v9, v9
    v_and_b32 v9, 0xffff0000, v9
    v_add_f32 v9, 0x3727c5ac, v9
    v_cvt_pk_bf16_f32 v9, v9, v9
    v_and_b32 v9, 0xffff0000, v9
    v_sqrt_f32 v9, v9
    s_nop 0
    v_cvt_pk_bf16_f32 v9, v9, v9
    v_and_b32 v9, 0xffff0000, v9
    v_rcp_f32 v72, v9
    s_nop 0
    v_mul_f32 v74, v8, v72
    v_sub_f32 v74, 0, v74
    v_lshlrev_b32 v76, 16, v16
    v_and_b32 v77, 0xffff0000, v16
    v_pk_fma_f32 v[76:77], v[76:77], v[72:73], v[74:75] op_sel_hi:[1,0,0]
    v_cvt_pk_bf16_f32 v16, v76, v77
    v_lshlrev_b32 v78, 16, v17
    v_and_b32 v79, 0xffff0000, v17
    v_pk_fma_f32 v[78:79], v[78:79], v[72:73], v[74:75] op_sel_hi:[1,0,0]
    v_cvt_pk_bf16_f32 v17, v78, v79
    v_lshlrev_b32 v80, 16, v18
    v_and_b32 v81, 0xffff0000, v18
    v_pk_fma_f32 v[80:81], v[80:81], v[72:73], v[74:75] op_sel_hi:[1,0,0]
    v_cvt_pk_bf16_f32 v18, v80, v81
    v_lshlrev_b32 v82, 16, v19
    v_and_b32 v83, 0xffff0000, v19
    v_pk_fma_f32 v[82:83], v[82:83], v[72:73], v[74:75] op_sel_hi:[1,0,0]
    v_cvt_pk_bf16_f32 v19, v82, v83
    v_lshlrev_b32 v76, 16, v20
    v_and_b32 v77, 0xffff0000, v20
    v_pk_fma_f32 v[76:77], v[76:77], v[72:73], v[74:75] op_sel_hi:[1,0,0]
    v_cvt_pk_bf16_f32 v20, v76, v77
    v_lshlrev_b32 v78, 16, v21
    v_and_b32 v79, 0xffff0000, v21
    v_pk_fma_f32 v[78:79], v[78:79], v[72:73], v[74:75] op_sel_hi:[1,0,0]
    v_cvt_pk_bf16_f32 v21, v78, v79
    v_lshlrev_b32 v80, 16, v22
    v_and_b32 v81, 0xffff0000, v22
    v_pk_fma_f32 v[80:81], v[80:81], v[72:73], v[74:75] op_sel_hi:[1,0,0]
    v_cvt_pk_bf16_f32 v22, v80, v81
    v_lshlrev_b32 v82, 16, v23
    v_and_b32 v83, 0xffff0000, v23
    v_pk_fma_f32 v[82:83], v[82:83], v[72:73], v[74:75] op_sel_hi:[1,0,0]
    v_cvt_pk_bf16_f32 v23, v82, v83
    v_lshlrev_b32 v76, 16, v24
    v_and_b32 v77, 0xffff0000, v24
    v_pk_fma_f32 v[76:77], v[76:77], v[72:73], v[74:75] op_sel_hi:[1,0,0]
    v_cvt_pk_bf16_f32 v24, v76, v77
    v_lshlrev_b32 v78, 16, v25
    v_and_b32 v79, 0xffff0000, v25
    v_pk_fma_f32 v[78:79], v[78:79], v[72:73], v[74:75] op_sel_hi:[1,0,0]
    v_cvt_pk_bf16_f32 v25, v78, v79
    v_lshlrev_b32 v80, 16, v26
    v_and_b32 v81, 0xffff0000, v26
    v_pk_fma_f32 v[80:81], v[80:81], v[72:73], v[74:75] op_sel_hi:[1,0,0]
    v_cvt_pk_bf16_f32 v26, v80, v81
    v_lshlrev_b32 v82, 16, v27
    v_and_b32 v83, 0xffff0000, v27
    v_pk_fma_f32 v[82:83], v[82:83], v[72:73], v[74:75] op_sel_hi:[1,0,0]
    v_cvt_pk_bf16_f32 v27, v82, v83
    v_lshlrev_b32 v76, 16, v28
    v_and_b32 v77, 0xffff0000, v28
    v_pk_fma_f32 v[76:77], v[76:77], v[72:73], v[74:75] op_sel_hi:[1,0,0]
    v_cvt_pk_bf16_f32 v28, v76, v77
    v_lshlrev_b32 v78, 16, v29
    v_and_b32 v79, 0xffff0000, v29
    v_pk_fma_f32 v[78:79], v[78:79], v[72:73], v[74:75] op_sel_hi:[1,0,0]
    v_cvt_pk_bf16_f32 v29, v78, v79
    v_lshlrev_b32 v80, 16, v30
    v_and_b32 v81, 0xffff0000, v30
    v_pk_fma_f32 v[80:81], v[80:81], v[72:73], v[74:75] op_sel_hi:[1,0,0]
    v_cvt_pk_bf16_f32 v30, v80, v81
    v_lshlrev_b32 v82, 16, v31
    v_and_b32 v83, 0xffff0000, v31
    v_pk_fma_f32 v[82:83], v[82:83], v[72:73], v[74:75] op_sel_hi:[1,0,0]
    v_cvt_pk_bf16_f32 v31, v82, v83
    v_lshlrev_b32 v76, 16, v32
    v_and_b32 v77, 0xffff0000, v32
    v_pk_fma_f32 v[76:77], v[76:77], v[72:73], v[74:75] op_sel_hi:[1,0,0]
    v_cvt_pk_bf16_f32 v32, v76, v77
    v_lshlrev_b32 v78, 16, v33
    v_and_b32 v79, 0xffff0000, v33
    v_pk_fma_f32 v[78:79], v[78:79], v[72:73], v[74:75] op_sel_hi:[1,0,0]
    v_cvt_pk_bf16_f32 v33, v78, v79
    v_lshlrev_b32 v80, 16, v34
    v_and_b32 v81, 0xffff0000, v34
    v_pk_fma_f32 v[80:81], v[80:81], v[72:73], v[74:75] op_sel_hi:[1,0,0]
    v_cvt_pk_bf16_f32 v34, v80, v81
    v_lshlrev_b32 v82, 16, v35
    v_and_b32 v83, 0xffff0000, v35
    v_pk_fma_f32 v[82:83], v[82:83], v[72:73], v[74:75] op_sel_hi:[1,0,0]
    v_cvt_pk_bf16_f32 v35, v82, v83
    v_lshlrev_b32 v76, 16, v36
    v_and_b32 v77, 0xffff0000, v36
    v_pk_fma_f32 v[76:77], v[76:77], v[72:73], v[74:75] op_sel_hi:[1,0,0]
    v_cvt_pk_bf16_f32 v36, v76, v77
    v_lshlrev_b32 v78, 16, v37
    v_and_b32 v79, 0xffff0000, v37
    v_pk_fma_f32 v[78:79], v[78:79], v[72:73], v[74:75] op_sel_hi:[1,0,0]
    v_cvt_pk_bf16_f32 v37, v78, v79
    v_lshlrev_b32 v80, 16, v38
    v_and_b32 v81, 0xffff0000, v38
    v_pk_fma_f32 v[80:81], v[80:81], v[72:73], v[74:75] op_sel_hi:[1,0,0]
    v_cvt_pk_bf16_f32 v38, v80, v81
    v_lshlrev_b32 v82, 16, v39
    v_and_b32 v83, 0xffff0000, v39
    v_pk_fma_f32 v[82:83], v[82:83], v[72:73], v[74:75] op_sel_hi:[1,0,0]
    v_cvt_pk_bf16_f32 v39, v82, v83
    v_lshlrev_b32 v76, 16, v40
    v_and_b32 v77, 0xffff0000, v40
    v_pk_fma_f32 v[76:77], v[76:77], v[72:73], v[74:75] op_sel_hi:[1,0,0]
    v_cvt_pk_bf16_f32 v40, v76, v77
    v_lshlrev_b32 v78, 16, v41
    v_and_b32 v79, 0xffff0000, v41
    v_pk_fma_f32 v[78:79], v[78:79], v[72:73], v[74:75] op_sel_hi:[1,0,0]
    v_cvt_pk_bf16_f32 v41, v78, v79
    v_lshlrev_b32 v80, 16, v42
    v_and_b32 v81, 0xffff0000, v42
    v_pk_fma_f32 v[80:81], v[80:81], v[72:73], v[74:75] op_sel_hi:[1,0,0]
    v_cvt_pk_bf16_f32 v42, v80, v81
    v_lshlrev_b32 v82, 16, v43
    v_and_b32 v83, 0xffff0000, v43
    v_pk_fma_f32 v[82:83], v[82:83], v[72:73], v[74:75] op_sel_hi:[1,0,0]
    v_cvt_pk_bf16_f32 v43, v82, v83
    v_lshlrev_b32 v76, 16, v44
    v_and_b32 v77, 0xffff0000, v44
    v_pk_fma_f32 v[76:77], v[76:77], v[72:73], v[74:75] op_sel_hi:[1,0,0]
    v_cvt_pk_bf16_f32 v44, v76, v77
    v_lshlrev_b32 v78, 16, v45
    v_and_b32 v79, 0xffff0000, v45
    v_pk_fma_f32 v[78:79], v[78:79], v[72:73], v[74:75] op_sel_hi:[1,0,0]
    v_cvt_pk_bf16_f32 v45, v78, v79
    v_lshlrev_b32 v80, 16, v46
    v_and_b32 v81, 0xffff0000, v46
    v_pk_fma_f32 v[80:81], v[80:81], v[72:73], v[74:75] op_sel_hi:[1,0,0]
    v_cvt_pk_bf16_f32 v46, v80, v81
    v_lshlrev_b32 v82, 16, v47
    v_and_b32 v83, 0xffff0000, v47
    v_pk_fma_f32 v[82:83], v[82:83], v[72:73], v[74:75] op_sel_hi:[1,0,0]
    v_cvt_pk_bf16_f32 v47, v82, v83
    v_lshlrev_b32 v76, 16, v48
    v_and_b32 v77, 0xffff0000, v48
    v_pk_fma_f32 v[76:77], v[76:77], v[72:73], v[74:75] op_sel_hi:[1,0,0]
    v_cvt_pk_bf16_f32 v48, v76, v77
    v_lshlrev_b32 v78, 16, v49
    v_and_b32 v79, 0xffff0000, v49
    v_pk_fma_f32 v[78:79], v[78:79], v[72:73], v[74:75] op_sel_hi:[1,0,0]
    v_cvt_pk_bf16_f32 v49, v78, v79
    v_lshlrev_b32 v80, 16, v50
    v_and_b32 v81, 0xffff0000, v50
    v_pk_fma_f32 v[80:81], v[80:81], v[72:73], v[74:75] op_sel_hi:[1,0,0]
    v_cvt_pk_bf16_f32 v50, v80, v81
    v_lshlrev_b32 v82, 16, v51
    v_and_b32 v83, 0xffff0000, v51
    v_pk_fma_f32 v[82:83], v[82:83], v[72:73], v[74:75] op_sel_hi:[1,0,0]
    v_cvt_pk_bf16_f32 v51, v82, v83
    v_lshlrev_b32 v76, 16, v52
    v_and_b32 v77, 0xffff0000, v52
    v_pk_fma_f32 v[76:77], v[76:77], v[72:73], v[74:75] op_sel_hi:[1,0,0]
    v_cvt_pk_bf16_f32 v52, v76, v77
    v_lshlrev_b32 v78, 16, v53
    v_and_b32 v79, 0xffff0000, v53
    v_pk_fma_f32 v[78:79], v[78:79], v[72:73], v[74:75] op_sel_hi:[1,0,0]
    v_cvt_pk_bf16_f32 v53, v78, v79
    v_lshlrev_b32 v80, 16, v54
    v_and_b32 v81, 0xffff0000, v54
    v_pk_fma_f32 v[80:81], v[80:81], v[72:73], v[74:75] op_sel_hi:[1,0,0]
    v_cvt_pk_bf16_f32 v54, v80, v81
    v_lshlrev_b32 v82, 16, v55
    v_and_b32 v83, 0xffff0000, v55
    v_pk_fma_f32 v[82:83], v[82:83], v[72:73], v[74:75] op_sel_hi:[1,0,0]
    v_cvt_pk_bf16_f32 v55, v82, v83
    v_lshlrev_b32 v76, 16, v56
    v_and_b32 v77, 0xffff0000, v56
    v_pk_fma_f32 v[76:77], v[76:77], v[72:73], v[74:75] op_sel_hi:[1,0,0]
    v_cvt_pk_bf16_f32 v56, v76, v77
    v_lshlrev_b32 v78, 16, v57
    v_and_b32 v79, 0xffff0000, v57
    v_pk_fma_f32 v[78:79], v[78:79], v[72:73], v[74:75] op_sel_hi:[1,0,0]
    v_cvt_pk_bf16_f32 v57, v78, v79
    v_lshlrev_b32 v80, 16, v58
    v_and_b32 v81, 0xffff0000, v58
    v_pk_fma_f32 v[80:81], v[80:81], v[72:73], v[74:75] op_sel_hi:[1,0,0]
    v_cvt_pk_bf16_f32 v58, v80, v81
    v_lshlrev_b32 v82, 16, v59
    v_and_b32 v83, 0xffff0000, v59
    v_pk_fma_f32 v[82:83], v[82:83], v[72:73], v[74:75] op_sel_hi:[1,0,0]
    v_cvt_pk_bf16_f32 v59, v82, v83
    v_lshlrev_b32 v76, 16, v60
    v_and_b32 v77, 0xffff0000, v60
    v_pk_fma_f32 v[76:77], v[76:77], v[72:73], v[74:75] op_sel_hi:[1,0,0]
    v_cvt_pk_bf16_f32 v60, v76, v77
    v_lshlrev_b32 v78, 16, v61
    v_and_b32 v79, 0xffff0000, v61
    v_pk_fma_f32 v[78:79], v[78:79], v[72:73], v[74:75] op_sel_hi:[1,0,0]
    v_cvt_pk_bf16_f32 v61, v78, v79
    v_lshlrev_b32 v80, 16, v62
    v_and_b32 v81, 0xffff0000, v62
    v_pk_fma_f32 v[80:81], v[80:81], v[72:73], v[74:75] op_sel_hi:[1,0,0]
    v_cvt_pk_bf16_f32 v62, v80, v81
    v_lshlrev_b32 v82, 16, v63
    v_and_b32 v83, 0xffff0000, v63
    v_pk_fma_f32 v[82:83], v[82:83], v[72:73], v[74:75] op_sel_hi:[1,0,0]
    v_cvt_pk_bf16_f32 v63, v82, v83
    v_lshlrev_b32 v76, 16, v64
    v_and_b32 v77, 0xffff0000, v64
    v_pk_fma_f32 v[76:77], v[76:77], v[72:73], v[74:75] op_sel_hi:[1,0,0]
    v_cvt_pk_bf16_f32 v64, v76, v77
    v_lshlrev_b32 v78, 16, v65
    v_and_b32 v79, 0xffff0000, v65
    v_pk_fma_f32 v[78:79], v[78:79], v[72:73], v[74:75] op_sel_hi:[1,0,0]
    v_cvt_pk_bf16_f32 v65, v78, v79
    v_lshlrev_b32 v80, 16, v66
    v_and_b32 v81, 0xffff0000, v66
    v_pk_fma_f32 v[80:81], v[80:81], v[72:73], v[74:75] op_sel_hi:[1,0,0]
    v_cvt_pk_bf16_f32 v66, v80, v81
    v_lshlrev_b32 v82, 16, v67
    v_and_b32 v83, 0xffff0000, v67
    v_pk_fma_f32 v[82:83], v[82:83], v[72:73], v[74:75] op_sel_hi:[1,0,0]
    v_cvt_pk_bf16_f32 v67, v82, v83
    v_lshlrev_b32 v76, 16, v68
    v_and_b32 v77, 0xffff0000, v68
    v_pk_fma_f32 v[76:77], v[76:77], v[72:73], v[74:75] op_sel_hi:[1,0,0]
    v_cvt_pk_bf16_f32 v68, v76, v77
    v_lshlrev_b32 v78, 16, v69
    v_and_b32 v79, 0xffff0000, v69
    v_pk_fma_f32 v[78:79], v[78:79], v[72:73], v[74:75] op_sel_hi:[1,0,0]
    v_cvt_pk_bf16_f32 v69, v78, v79
    v_lshlrev_b32 v80, 16, v70
    v_and_b32 v81, 0xffff0000, v70
    v_pk_fma_f32 v[80:81], v[80:81], v[72:73], v[74:75] op_sel_hi:[1,0,0]
    v_cvt_pk_bf16_f32 v70, v80, v81
    v_lshlrev_b32 v82, 16, v71
    v_and_b32 v83, 0xffff0000, v71
    v_pk_fma_f32 v[82:83], v[82:83], v[72:73], v[74:75] op_sel_hi:[1,0,0]
    v_cvt_pk_bf16_f32 v71, v82, v83
    s_barrier
    ds_read_b128 v[80:83], v2 offset:28672
    ds_read_b128 v[84:87], v2 offset:43008
    ds_read_b128 v[88:91], v2 offset:57344
    ds_read_b128 v[92:95], v5 offset:6144
    ds_read_b128 v[104:107], v2 offset:29696
    ds_read_b128 v[108:111], v2 offset:44032
    ds_read_b128 v[112:115], v2 offset:58368
    ds_read_b128 v[116:119], v5 offset:7168
    s_waitcnt lgkmcnt(4)
    v_mfma_f32_16x16x32_bf16 v[136:139], v[80:83], v[16:19], 0
    v_mfma_f32_16x16x32_bf16 v[140:143], v[84:87], v[16:19], 0
    v_mfma_f32_16x16x32_bf16 v[144:147], v[16:19], v[88:91], 0
    v_mfma_f32_16x16x32_bf16 v[148:151], v[16:19], v[92:95], 0
    ds_read_b128 v[80:83], v2 offset:30720
    ds_read_b128 v[84:87], v2 offset:45056
    ds_read_b128 v[88:91], v2 offset:59392
    ds_read_b128 v[92:95], v5 offset:8192
    s_waitcnt lgkmcnt(4)
    v_mfma_f32_16x16x32_bf16 v[136:139], v[104:107], v[20:23], v[136:139]
    v_mfma_f32_16x16x32_bf16 v[140:143], v[108:111], v[20:23], v[140:143]
    v_mfma_f32_16x16x32_bf16 v[144:147], v[20:23], v[112:115], v[144:147]
    v_mfma_f32_16x16x32_bf16 v[148:151], v[20:23], v[116:119], v[148:151]
    ds_read_b128 v[104:107], v2 offset:31744
    ds_read_b128 v[108:111], v2 offset:46080
    ds_read_b128 v[112:115], v2 offset:60416
    ds_read_b128 v[116:119], v5 offset:9216
    s_waitcnt lgkmcnt(4)
    v_mfma_f32_16x16x32_bf16 v[136:139], v[80:83], v[24:27], v[136:139]
    v_mfma_f32_16x16x32_bf16 v[140:143], v[84:87], v[24:27], v[140:143]
    v_mfma_f32_16x16x32_bf16 v[144:147], v[24:27], v[88:91], v[144:147]
    v_mfma_f32_16x16x32_bf16 v[148:151], v[24:27], v[92:95], v[148:151]
    ds_read_b128 v[80:83], v2 offset:32768
    ds_read_b128 v[84:87], v2 offset:47104
    ds_read_b128 v[88:91], v2 offset:61440
    ds_read_b128 v[92:95], v5 offset:10240
    s_waitcnt lgkmcnt(4)
    v_mfma_f32_16x16x32_bf16 v[136:139], v[104:107], v[28:31], v[136:139]
    v_mfma_f32_16x16x32_bf16 v[140:143], v[108:111], v[28:31], v[140:143]
    v_mfma_f32_16x16x32_bf16 v[144:147], v[28:31], v[112:115], v[144:147]
    v_mfma_f32_16x16x32_bf16 v[148:151], v[28:31], v[116:119], v[148:151]
    ds_read_b128 v[104:107], v2 offset:33792
    ds_read_b128 v[108:111], v2 offset:48128
    ds_read_b128 v[112:115], v2 offset:62464
    ds_read_b128 v[116:119], v5 offset:11264
    s_waitcnt lgkmcnt(4)
    v_mfma_f32_16x16x32_bf16 v[136:139], v[80:83], v[32:35], v[136:139]
    v_mfma_f32_16x16x32_bf16 v[140:143], v[84:87], v[32:35], v[140:143]
    v_mfma_f32_16x16x32_bf16 v[144:147], v[32:35], v[88:91], v[144:147]
    v_mfma_f32_16x16x32_bf16 v[148:151], v[32:35], v[92:95], v[148:151]
    ds_read_b128 v[80:83], v2 offset:34816
    ds_read_b128 v[84:87], v2 offset:49152
    ds_read_b128 v[88:91], v2 offset:63488
    ds_read_b128 v[92:95], v5 offset:12288
    s_waitcnt lgkmcnt(4)
    v_mfma_f32_16x16x32_bf16 v[136:139], v[104:107], v[36:39], v[136:139]
    v_mfma_f32_16x16x32_bf16 v[140:143], v[108:111], v[36:39], v[140:143]
    v_mfma_f32_16x16x32_bf16 v[144:147], v[36:39], v[112:115], v[144:147]
    v_mfma_f32_16x16x32_bf16 v[148:151], v[36:39], v[116:119], v[148:151]
    ds_read_b128 v[104:107], v2 offset:35840
    ds_read_b128 v[108:111], v2 offset:50176
    ds_read_b128 v[112:115], v2 offset:64512
    ds_read_b128 v[116:119], v5 offset:13312
    s_waitcnt lgkmcnt(4)
    v_mfma_f32_16x16x32_bf16 v[136:139], v[80:83], v[40:43], v[136:139]
    v_mfma_f32_16x16x32_bf16 v[140:143], v[84:87], v[40:43], v[140:143]
    v_mfma_f32_16x16x32_bf16 v[144:147], v[40:43], v[88:91], v[144:147]
    v_mfma_f32_16x16x32_bf16 v[148:151], v[40:43], v[92:95], v[148:151]
    ds_read_b128 v[80:83], v2 offset:36864
    ds_read_b128 v[84:87], v2 offset:51200
    ds_read_b128 v[88:91], v5 offset:0
    ds_read_b128 v[92:95], v5 offset:14336
    s_waitcnt lgkmcnt(4)
    v_mfma_f32_16x16x32_bf16 v[136:139], v[104:107], v[44:47], v[136:139]
    v_mfma_f32_16x16x32_bf16 v[140:143], v[108:111], v[44:47], v[140:143]
    v_mfma_f32_16x16x32_bf16 v[144:147], v[44:47], v[112:115], v[144:147]
    v_mfma_f32_16x16x32_bf16 v[148:151], v[44:47], v[116:119], v[148:151]
    ds_read_b128 v[104:107], v2 offset:37888
    ds_read_b128 v[108:111], v2 offset:52224
    ds_read_b128 v[112:115], v5 offset:1024
    ds_read_b128 v[116:119], v5 offset:15360
    s_waitcnt lgkmcnt(4)
    v_mfma_f32_16x16x32_bf16 v[136:139], v[80:83], v[48:51], v[136:139]
    v_mfma_f32_16x16x32_bf16 v[140:143], v[84:87], v[48:51], v[140:143]
    v_mfma_f32_16x16x32_bf16 v[144:147], v[48:51], v[88:91], v[144:147]
    v_mfma_f32_16x16x32_bf16 v[148:151], v[48:51], v[92:95], v[148:151]
    ds_read_b128 v[80:83], v2 offset:38912
    ds_read_b128 v[84:87], v2 offset:53248
    ds_read_b128 v[88:91], v5 offset:2048
    ds_read_b128 v[92:95], v5 offset:16384
    s_waitcnt lgkmcnt(4)
    v_mfma_f32_16x16x32_bf16 v[136:139], v[104:107], v[52:55], v[136:139]
    v_mfma_f32_16x16x32_bf16 v[140:143], v[108:111], v[52:55], v[140:143]
    v_mfma_f32_16x16x32_bf16 v[144:147], v[52:55], v[112:115], v[144:147]
    v_mfma_f32_16x16x32_bf16 v[148:151], v[52:55], v[116:119], v[148:151]
    ds_read_b128 v[104:107], v2 offset:39936
    ds_read_b128 v[108:111], v2 offset:54272
    ds_read_b128 v[112:115], v5 offset:3072
    ds_read_b128 v[116:119], v5 offset:17408
    s_waitcnt lgkmcnt(4)
    v_mfma_f32_16x16x32_bf16 v[136:139], v[80:83], v[56:59], v[136:139]
    v_mfma_f32_16x16x32_bf16 v[140:143], v[84:87], v[56:59], v[140:143]
    v_mfma_f32_16x16x32_bf16 v[144:147], v[56:59], v[88:91], v[144:147]
    v_mfma_f32_16x16x32_bf16 v[148:151], v[56:59], v[92:95], v[148:151]
    ds_read_b128 v[80:83], v2 offset:40960
    ds_read_b128 v[84:87], v2 offset:55296
    ds_read_b128 v[88:91], v5 offset:4096
    ds_read_b128 v[92:95], v5 offset:18432
    s_waitcnt lgkmcnt(4)
    v_mfma_f32_16x16x32_bf16 v[136:139], v[104:107], v[60:63], v[136:139]
    v_mfma_f32_16x16x32_bf16 v[140:143], v[108:111], v[60:63], v[140:143]
    v_mfma_f32_16x16x32_bf16 v[144:147], v[60:63], v[112:115], v[144:147]
    v_mfma_f32_16x16x32_bf16 v[148:151], v[60:63], v[116:119], v[148:151]
    ds_read_b128 v[104:107], v2 offset:41984
    ds_read_b128 v[108:111], v2 offset:56320
    ds_read_b128 v[112:115], v5 offset:5120
    ds_read_b128 v[116:119], v5 offset:19456
    s_waitcnt lgkmcnt(4)
    v_mfma_f32_16x16x32_bf16 v[136:139], v[80:83], v[64:67], v[136:139]
    v_mfma_f32_16x16x32_bf16 v[140:143], v[84:87], v[64:67], v[140:143]
    v_mfma_f32_16x16x32_bf16 v[144:147], v[64:67], v[88:91], v[144:147]
    v_mfma_f32_16x16x32_bf16 v[148:151], v[64:67], v[92:95], v[148:151]
    s_waitcnt lgkmcnt(0)
    v_mfma_f32_16x16x32_bf16 v[136:139], v[104:107], v[68:71], v[136:139]
    v_mfma_f32_16x16x32_bf16 v[140:143], v[108:111], v[68:71], v[140:143]
    v_mfma_f32_16x16x32_bf16 v[144:147], v[68:71], v[112:115], v[144:147]
    v_mfma_f32_16x16x32_bf16 v[148:151], v[68:71], v[116:119], v[148:151]
    ds_read_b128 v[80:83], v5 offset:20480
    ds_read_b128 v[84:87], v5 offset:21504
    s_nop 2
    v_cvt_pk_bf16_f32 v92, v136, v137
    v_cvt_pk_bf16_f32 v93, v138, v139
    v_cvt_pk_bf16_f32 v94, v140, v141
    v_cvt_pk_bf16_f32 v95, v142, v143
    s_waitcnt lgkmcnt(0)
    s_nop 0
    v_mfma_f32_16x16x32_bf16 v[104:107], v[92:95], v[80:83], 0
    v_mfma_f32_16x16x32_bf16 v[108:111], v[92:95], v[84:87], 0
    v_cndmask_b32 v148, v148, 1.0, s[56:57]
    v_cndmask_b32 v149, v149, 1.0, s[56:57]
    v_cndmask_b32 v150, v150, 1.0, s[56:57]
    v_cndmask_b32 v151, v151, 1.0, s[56:57]
    v_cvt_pk_bf16_f32 v112, v144, v145
    v_cvt_pk_bf16_f32 v113, v146, v147
    v_cvt_pk_bf16_f32 v114, v148, v149
    v_cvt_pk_bf16_f32 v115, v150, v151
    v_cvt_pk_bf16_f32 v105, v104, v105
    v_lshlrev_b32 v104, 16, v105
    v_and_b32 v105, 0xffff0000, v105
    v_cvt_pk_bf16_f32 v107, v106, v107
    v_lshlrev_b32 v106, 16, v107
    v_and_b32 v107, 0xffff0000, v107
    v_cvt_pk_bf16_f32 v109, v108, v109
    v_lshlrev_b32 v108, 16, v109
    v_and_b32 v109, 0xffff0000, v109
    v_cvt_pk_bf16_f32 v111, v110, v111
    v_lshlrev_b32 v110, 16, v111
    v_and_b32 v111, 0xffff0000, v111
    v_max_f32 v184, v104, v108
    v_min_f32 v188, v104, v108
    v_max_f32 v185, v105, v109
    v_min_f32 v189, v105, v109
    v_max_f32 v186, v106, v110
    v_min_f32 v190, v106, v110
    v_max_f32 v187, v107, v111
    v_min_f32 v191, v107, v111
    v_cndmask_b32 v184, v184, v104, s[54:55]
    v_cndmask_b32 v188, v188, v104, s[54:55]
    v_cndmask_b32 v185, v185, v105, s[54:55]
    v_cndmask_b32 v189, v189, v105, s[54:55]
    v_cndmask_b32 v186, v186, v106, s[54:55]
    v_cndmask_b32 v190, v190, v106, s[54:55]
    v_cndmask_b32 v187, v187, v107, s[54:55]
    v_cndmask_b32 v191, v191, v107, s[54:55]
    v_max_f32_dpp v184, v184, v184 row_ror:8 row_mask:0xf bank_mask:0xf
    v_min_f32_dpp v188, v188, v188 row_ror:8 row_mask:0xf bank_mask:0xf
    v_max_f32_dpp v185, v185, v185 row_ror:8 row_mask:0xf bank_mask:0xf
    v_min_f32_dpp v189, v189, v189 row_ror:8 row_mask:0xf bank_mask:0xf
    v_max_f32_dpp v186, v186, v186 row_ror:8 row_mask:0xf bank_mask:0xf
    v_min_f32_dpp v190, v190, v190 row_ror:8 row_mask:0xf bank_mask:0xf
    v_max_f32_dpp v187, v187, v187 row_ror:8 row_mask:0xf bank_mask:0xf
    v_min_f32_dpp v191, v191, v191 row_ror:8 row_mask:0xf bank_mask:0xf
    v_max_f32_dpp v184, v184, v184 row_ror:4 row_mask:0xf bank_mask:0xf
    v_min_f32_dpp v188, v188, v188 row_ror:4 row_mask:0xf bank_mask:0xf
    v_max_f32_dpp v185, v185, v185 row_ror:4 row_mask:0xf bank_mask:0xf
    v_min_f32_dpp v189, v189, v189 row_ror:4 row_mask:0xf bank_mask:0xf
    v_max_f32_dpp v186, v186, v186 row_ror:4 row_mask:0xf bank_mask:0xf
    v_min_f32_dpp v190, v190, v190 row_ror:4 row_mask:0xf bank_mask:0xf
    v_max_f32_dpp v187, v187, v187 row_ror:4 row_mask:0xf bank_mask:0xf
    v_min_f32_dpp v191, v191, v191 row_ror:4 row_mask:0xf bank_mask:0xf
    v_max_f32_dpp v184, v184, v184 row_ror:2 row_mask:0xf bank_mask:0xf
    v_min_f32_dpp v188, v188, v188 row_ror:2 row_mask:0xf bank_mask:0xf
    v_max_f32_dpp v185, v185, v185 row_ror:2 row_mask:0xf bank_mask:0xf
    v_min_f32_dpp v189, v189, v189 row_ror:2 row_mask:0xf bank_mask:0xf
    v_max_f32_dpp v186, v186, v186 row_ror:2 row_mask:0xf bank_mask:0xf
    v_min_f32_dpp v190, v190, v190 row_ror:2 row_mask:0xf bank_mask:0xf
    v_max_f32_dpp v187, v187, v187 row_ror:2 row_mask:0xf bank_mask:0xf
    v_min_f32_dpp v191, v191, v191 row_ror:2 row_mask:0xf bank_mask:0xf
    v_max_f32_dpp v184, v184, v184 row_ror:1 row_mask:0xf bank_mask:0xf
    v_min_f32_dpp v188, v188, v188 row_ror:1 row_mask:0xf bank_mask:0xf
    v_max_f32_dpp v185, v185, v185 row_ror:1 row_mask:0xf bank_mask:0xf
    v_min_f32_dpp v189, v189, v189 row_ror:1 row_mask:0xf bank_mask:0xf
    v_max_f32_dpp v186, v186, v186 row_ror:1 row_mask:0xf bank_mask:0xf
    v_min_f32_dpp v190, v190, v190 row_ror:1 row_mask:0xf bank_mask:0xf
    v_max_f32_dpp v187, v187, v187 row_ror:1 row_mask:0xf bank_mask:0xf
    v_min_f32_dpp v191, v191, v191 row_ror:1 row_mask:0xf bank_mask:0xf
    v_mul_f32 v184, s61, v184
    v_mul_f32 v188, s61, v188
    v_mul_f32 v185, s61, v185
    v_mul_f32 v189, s61, v189
    v_mul_f32 v186, s61, v186
    v_mul_f32 v190, s61, v190
    v_mul_f32 v187, s61, v187
    v_mul_f32 v191, s61, v191
    v_fma_f32 v192, v104, s61, -v184
    v_fma_f32 v200, -v104, s61, v188
    v_fma_f32 v193, v105, s61, -v185
    v_fma_f32 v201, -v105, s61, v189
    v_fma_f32 v194, v106, s61, -v186
    v_fma_f32 v202, -v106, s61, v190
    v_fma_f32 v195, v107, s61, -v187
    v_fma_f32 v203, -v107, s61, v191
    v_fma_f32 v196, v108, s61, -v184
    v_fma_f32 v204, -v108, s61, v188
    v_fma_f32 v197, v109, s61, -v185
    v_fma_f32 v205, -v109, s61, v189
    v_fma_f32 v198, v110, s61, -v186
    v_fma_f32 v206, -v110, s61, v190
    v_fma_f32 v199, v111, s61, -v187
    v_fma_f32 v207, -v111, s61, v191
    v_exp_f32 v192, v192
    v_exp_f32 v200, v200
    v_exp_f32 v193, v193
    v_exp_f32 v201, v201
    v_exp_f32 v194, v194
    v_exp_f32 v202, v202
    v_exp_f32 v195, v195
    v_exp_f32 v203, v203
    v_exp_f32 v196, v196
    v_exp_f32 v204, v204
    v_exp_f32 v197, v197
    v_exp_f32 v205, v205
    v_exp_f32 v198, v198
    v_exp_f32 v206, v206
    v_exp_f32 v199, v199
    v_exp_f32 v207, v207
    v_cndmask_b32 v196, v196, 0, s[54:55]
    v_cndmask_b32 v204, v204, 0, s[54:55]
    v_cndmask_b32 v197, v197, 0, s[54:55]
    v_cndmask_b32 v205, v205, 0, s[54:55]
    v_cndmask_b32 v198, v198, 0, s[54:55]
    v_cndmask_b32 v206, v206, 0, s[54:55]
    v_cndmask_b32 v199, v199, 0, s[54:55]
    v_cndmask_b32 v207, v207, 0, s[54:55]
    v_add_f32 v184, v192, v196
    v_add_f32 v188, v200, v204
    v_add_f32 v185, v193, v197
    v_add_f32 v189, v201, v205
    v_add_f32 v186, v194, v198
    v_add_f32 v190, v202, v206
    v_add_f32 v187, v195, v199
    v_add_f32 v191, v203, v207
    v_add_f32_dpp v184, v184, v184 row_ror:8 row_mask:0xf bank_mask:0xf
    v_add_f32_dpp v185, v185, v185 row_ror:8 row_mask:0xf bank_mask:0xf
    v_add_f32_dpp v186, v186, v186 row_ror:8 row_mask:0xf bank_mask:0xf
    v_add_f32_dpp v187, v187, v187 row_ror:8 row_mask:0xf bank_mask:0xf
    v_add_f32_dpp v188, v188, v188 row_ror:8 row_mask:0xf bank_mask:0xf
    v_add_f32_dpp v189, v189, v189 row_ror:8 row_mask:0xf bank_mask:0xf
    v_add_f32_dpp v190, v190, v190 row_ror:8 row_mask:0xf bank_mask:0xf
    v_add_f32_dpp v191, v191, v191 row_ror:8 row_mask:0xf bank_mask:0xf
    v_add_f32_dpp v184, v184, v184 row_ror:4 row_mask:0xf bank_mask:0xf
    v_add_f32_dpp v185, v185, v185 row_ror:4 row_mask:0xf bank_mask:0xf
    v_add_f32_dpp v186, v186, v186 row_ror:4 row_mask:0xf bank_mask:0xf
    v_add_f32_dpp v187, v187, v187 row_ror:4 row_mask:0xf bank_mask:0xf
    v_add_f32_dpp v188, v188, v188 row_ror:4 row_mask:0xf bank_mask:0xf
    v_add_f32_dpp v189, v189, v189 row_ror:4 row_mask:0xf bank_mask:0xf
    v_add_f32_dpp v190, v190, v190 row_ror:4 row_mask:0xf bank_mask:0xf
    v_add_f32_dpp v191, v191, v191 row_ror:4 row_mask:0xf bank_mask:0xf
    v_add_f32_dpp v184, v184, v184 row_ror:2 row_mask:0xf bank_mask:0xf
    v_add_f32_dpp v185, v185, v185 row_ror:2 row_mask:0xf bank_mask:0xf
    v_add_f32_dpp v186, v186, v186 row_ror:2 row_mask:0xf bank_mask:0xf
    v_add_f32_dpp v187, v187, v187 row_ror:2 row_mask:0xf bank_mask:0xf
    v_add_f32_dpp v188, v188, v188 row_ror:2 row_mask:0xf bank_mask:0xf
    v_add_f32_dpp v189, v189, v189 row_ror:2 row_mask:0xf bank_mask:0xf
    v_add_f32_dpp v190, v190, v190 row_ror:2 row_mask:0xf bank_mask:0xf
    v_add_f32_dpp v191, v191, v191 row_ror:2 row_mask:0xf bank_mask:0xf
    v_add_f32_dpp v184, v184, v184 row_ror:1 row_mask:0xf bank_mask:0xf
    v_add_f32_dpp v185, v185, v185 row_ror:1 row_mask:0xf bank_mask:0xf
    v_add_f32_dpp v186, v186, v186 row_ror:1 row_mask:0xf bank_mask:0xf
    v_add_f32_dpp v187, v187, v187 row_ror:1 row_mask:0xf bank_mask:0xf
    v_add_f32_dpp v188, v188, v188 row_ror:1 row_mask:0xf bank_mask:0xf
    v_add_f32_dpp v189, v189, v189 row_ror:1 row_mask:0xf bank_mask:0xf
    v_add_f32_dpp v190, v190, v190 row_ror:1 row_mask:0xf bank_mask:0xf
    v_add_f32_dpp v191, v191, v191 row_ror:1 row_mask:0xf bank_mask:0xf
    v_rcp_f32 v184, v184
    v_rcp_f32 v188, v188
    v_rcp_f32 v185, v185
    v_rcp_f32 v189, v189
    v_rcp_f32 v186, v186
    v_rcp_f32 v190, v190
    v_rcp_f32 v187, v187
    v_rcp_f32 v191, v191
    v_mul_f32 v192, v192, v184
    v_mul_f32 v200, v200, v188
    v_mul_f32 v193, v193, v185
    v_mul_f32 v201, v201, v189
    v_mul_f32 v194, v194, v186
    v_mul_f32 v202, v202, v190
    v_mul_f32 v195, v195, v187
    v_mul_f32 v203, v203, v191
    v_mul_f32 v196, v196, v184
    v_mul_f32 v204, v204, v188
    v_mul_f32 v197, v197, v185
    v_mul_f32 v205, v205, v189
    v_mul_f32 v198, v198, v186
    v_mul_f32 v206, v206, v190
    v_mul_f32 v199, v199, v187
    v_mul_f32 v207, v207, v191
    v_cvt_pk_bf16_f32 v208, v192, v193
    v_cvt_pk_bf16_f32 v209, v194, v195
    v_cvt_pk_bf16_f32 v210, v196, v197
    v_cvt_pk_bf16_f32 v211, v198, v199
    v_cvt_pk_bf16_f32 v212, v200, v201
    v_cvt_pk_bf16_f32 v213, v202, v203
    v_cvt_pk_bf16_f32 v214, v204, v205
    v_cvt_pk_bf16_f32 v215, v206, v207
    v_mfma_f32_16x16x16_bf16 v[216:219], v[208:209], v[112:113], 0
    v_mfma_f32_16x16x16_bf16 v[220:223], v[210:211], v[112:113], 0
    v_mfma_f32_16x16x16_bf16 v[224:227], v[208:209], v[114:115], 0
    v_mfma_f32_16x16x16_bf16 v[228:231], v[210:211], v[114:115], 0
    v_mfma_f32_16x16x16_bf16 v[232:235], v[212:213], v[112:113], 0
    v_mfma_f32_16x16x16_bf16 v[236:239], v[214:215], v[112:113], 0
    v_mfma_f32_16x16x16_bf16 v[240:243], v[212:213], v[114:115], 0
    v_mfma_f32_16x16x16_bf16 v[244:247], v[214:215], v[114:115], 0
    v_lshlrev_b32 v6, 2, v1
    s_lshl_b32 s44, s3, 13
    s_add_u32 s44, s44, 88064
    v_add_u32 v7, s44, v6
    ds_write_b32 v7, v216 offset:0
    ds_write_b32 v7, v217 offset:256
    ds_write_b32 v7, v218 offset:512
    ds_write_b32 v7, v219 offset:768
    ds_write_b32 v7, v220 offset:1024
    ds_write_b32 v7, v221 offset:1280
    ds_write_b32 v7, v222 offset:1536
    ds_write_b32 v7, v223 offset:1792
    ds_write_b32 v7, v224 offset:2048
    ds_write_b32 v7, v225 offset:2304
    ds_write_b32 v7, v226 offset:2560
    ds_write_b32 v7, v227 offset:2816
    ds_write_b32 v7, v228 offset:3072
    ds_write_b32 v7, v229 offset:3328
    ds_write_b32 v7, v230 offset:3584
    ds_write_b32 v7, v231 offset:3840
    ds_write_b32 v7, v232 offset:4096
    ds_write_b32 v7, v233 offset:4352
    ds_write_b32 v7, v234 offset:4608
    ds_write_b32 v7, v235 offset:4864
    ds_write_b32 v7, v236 offset:5120
    ds_write_b32 v7, v237 offset:5376
    ds_write_b32 v7, v238 offset:5632
    ds_write_b32 v7, v239 offset:5888
    ds_write_b32 v7, v240 offset:6144
    ds_write_b32 v7, v241 offset:6400
    ds_write_b32 v7, v242 offset:6656
    ds_write_b32 v7, v243 offset:6912
    ds_write_b32 v7, v244 offset:7168
    ds_write_b32 v7, v245 offset:7424
    ds_write_b32 v7, v246 offset:7680
    ds_write_b32 v7, v247 offset:7936
    s_waitcnt lgkmcnt(0)
    s_barrier
    s_lshl_b32 s44, s3, 10
    s_add_u32 s44, s44, 88064
    v_add_u32 v7, s44, v6
    ds_read_b32 v216, v7 offset:0
    ds_read_b32 v217, v7 offset:8192
    ds_read_b32 v218, v7 offset:16384
    ds_read_b32 v219, v7 offset:24576
    ds_read_b32 v220, v7 offset:32768
    ds_read_b32 v221, v7 offset:40960
    ds_read_b32 v222, v7 offset:49152
    ds_read_b32 v223, v7 offset:57344
    ds_read_b32 v224, v7 offset:256
    ds_read_b32 v225, v7 offset:8448
    ds_read_b32 v226, v7 offset:16640
    ds_read_b32 v227, v7 offset:24832
    ds_read_b32 v228, v7 offset:33024
    ds_read_b32 v229, v7 offset:41216
    ds_read_b32 v230, v7 offset:49408
    ds_read_b32 v231, v7 offset:57600
    ds_read_b32 v232, v7 offset:512
    ds_read_b32 v233, v7 offset:8704
    ds_read_b32 v234, v7 offset:16896
    ds_read_b32 v235, v7 offset:25088
    ds_read_b32 v236, v7 offset:33280
    ds_read_b32 v237, v7 offset:41472
    ds_read_b32 v238, v7 offset:49664
    ds_read_b32 v239, v7 offset:57856
    ds_read_b32 v240, v7 offset:768
    ds_read_b32 v241, v7 offset:8960
    ds_read_b32 v242, v7 offset:17152
    ds_read_b32 v243, v7 offset:25344
    ds_read_b32 v244, v7 offset:33536
    ds_read_b32 v245, v7 offset:41728
    ds_read_b32 v246, v7 offset:49920
    ds_read_b32 v247, v7 offset:58112
    s_waitcnt lgkmcnt(0)
    v_add_f32 v216, v216, v217
    v_add_f32 v218, v218, v219
    v_add_f32 v220, v220, v221
    v_add_f32 v222, v222, v223
    v_add_f32 v216, v216, v218
    v_add_f32 v220, v220, v222
    v_add_f32 v216, v216, v220
    v_add_f32 v224, v224, v225
    v_add_f32 v226, v226, v227
    v_add_f32 v228, v228, v229
    v_add_f32 v230, v230, v231
    v_add_f32 v224, v224, v226
    v_add_f32 v228, v228, v230
    v_add_f32 v224, v224, v228
    v_add_f32 v232, v232, v233
    v_add_f32 v234, v234, v235
    v_add_f32 v236, v236, v237
    v_add_f32 v238, v238, v239
    v_add_f32 v232, v232, v234
    v_add_f32 v236, v236, v238
    v_add_f32 v232, v232, v236
    v_add_f32 v240, v240, v241
    v_add_f32 v242, v242, v243
    v_add_f32 v244, v244, v245
    v_add_f32 v246, v246, v247
    v_add_f32 v240, v240, v242
    v_add_f32 v244, v244, v246
    v_add_f32 v240, v240, v244
    s_add_u32 s20, s94, 7659520
    s_addc_u32 s21, s95, 0
    s_mov_b32 s22, 131072
    s_mov_b32 s23, 0x00020000
    s_lshl_b32 s44, s87, 13
    s_lshl_b32 s45, s3, 10
    s_add_u32 s44, s44, s45
    buffer_atomic_add_f32 v216, v6, s[20:23], s44 offen offset:0 sc1
    buffer_atomic_add_f32 v224, v6, s[20:23], s44 offen offset:256 sc1
    buffer_atomic_add_f32 v232, v6, s[20:23], s44 offen offset:512 sc1
    buffer_atomic_add_f32 v240, v6, s[20:23], s44 offen offset:768 sc1
    s_add_u32 s40, s2, 0
    s_waitcnt vmcnt(0)
    s_barrier
    s_cmp_lg_u32 s3, 0
    s_cbranch_scc1 L_sig_60
    s_add_u32 s28, s94, 7921664
    s_addc_u32 s29, s95, 0
    s_mov_b32 s30, 16384
    s_mov_b32 s31, 0x00020000
    s_lshl_b32 s48, s40, 2
    v_mov_b32 v6, 1
    v_mov_b32 v7, s48
    s_mov_b64 exec, 1
    buffer_store_dword v6, v7, s[28:31], 0 offen sc1
    s_mov_b64 exec, -1
    s_nop 0
L_sig_60:
    ds_read_b128 v[80:83], v2 offset:0
    ds_read_b128 v[84:87], v2 offset:14336
    ds_read_b128 v[104:107], v2 offset:1024
    ds_read_b128 v[108:111], v2 offset:15360
    s_waitcnt lgkmcnt(2)
    v_mfma_f32_16x16x32_bf16 v[128:131], v[80:83], v[16:19], 0
    v_mfma_f32_16x16x32_bf16 v[132:135], v[84:87], v[16:19], 0
    ds_read_b128 v[80:83], v2 offset:2048
    ds_read_b128 v[84:87], v2 offset:16384
    s_waitcnt lgkmcnt(2)
    v_mfma_f32_16x16x32_bf16 v[128:131], v[104:107], v[20:23], v[128:131]
    v_mfma_f32_16x16x32_bf16 v[132:135], v[108:111], v[20:23], v[132:135]
    ds_read_b128 v[104:107], v2 offset:3072
    ds_read_b128 v[108:111], v2 offset:17408
    s_waitcnt lgkmcnt(2)
    v_mfma_f32_16x16x32_bf16 v[128:131], v[80:83], v[24:27], v[128:131]
    v_mfma_f32_16x16x32_bf16 v[132:135], v[84:87], v[24:27], v[132:135]
    ds_read_b128 v[80:83], v2 offset:4096
    ds_read_b128 v[84:87], v2 offset:18432
    s_waitcnt lgkmcnt(2)
    v_mfma_f32_16x16x32_bf16 v[128:131], v[104:107], v[28:31], v[128:131]
    v_mfma_f32_16x16x32_bf16 v[132:135], v[108:111], v[28:31], v[132:135]
    ds_read_b128 v[104:107], v2 offset:5120
    ds_read_b128 v[108:111], v2 offset:19456
    s_waitcnt lgkmcnt(2)
    v_mfma_f32_16x16x32_bf16 v[128:131], v[80:83], v[32:35], v[128:131]
    v_mfma_f32_16x16x32_bf16 v[132:135], v[84:87], v[32:35], v[132:135]
    ds_read_b128 v[80:83], v2 offset:6144
    ds_read_b128 v[84:87], v2 offset:20480
    s_waitcnt lgkmcnt(2)
    v_mfma_f32_16x16x32_bf16 v[128:131], v[104:107], v[36:39], v[128:131]
    v_mfma_f32_16x16x32_bf16 v[132:135], v[108:111], v[36:39], v[132:135]
    ds_read_b128 v[104:107], v2 offset:7168
    ds_read_b128 v[108:111], v2 offset:21504
    s_waitcnt lgkmcnt(2)
    v_mfma_f32_16x16x32_bf16 v[128:131], v[80:83], v[40:43], v[128:131]
    v_mfma_f32_16x16x32_bf16 v[132:135], v[84:87], v[40:43], v[132:135]
    ds_read_b128 v[80:83], v2 offset:8192
    ds_read_b128 v[84:87], v2 offset:22528
    s_waitcnt lgkmcnt(2)
    v_mfma_f32_16x16x32_bf16 v[128:131], v[104:107], v[44:47], v[128:131]
    v_mfma_f32_16x16x32_bf16 v[132:135], v[108:111], v[44:47], v[132:135]
    ds_read_b128 v[104:107], v2 offset:9216
    ds_read_b128 v[108:111], v2 offset:23552
    s_waitcnt lgkmcnt(2)
    v_mfma_f32_16x16x32_bf16 v[128:131], v[80:83], v[48:51], v[128:131]
    v_mfma_f32_16x16x32_bf16 v[132:135], v[84:87], v[48:51], v[132:135]
    ds_read_b128 v[80:83], v2 offset:10240
    ds_read_b128 v[84:87], v2 offset:24576
    s_waitcnt lgkmcnt(2)
    v_mfma_f32_16x16x32_bf16 v[128:131], v[104:107], v[52:55], v[128:131]
    v_mfma_f32_16x16x32_bf16 v[132:135], v[108:111], v[52:55], v[132:135]
    ds_read_b128 v[104:107], v2 offset:11264
    ds_read_b128 v[108:111], v2 offset:25600
    s_waitcnt lgkmcnt(2)
    v_mfma_f32_16x16x32_bf16 v[128:131], v[80:83], v[56:59], v[128:131]
    v_mfma_f32_16x16x32_bf16 v[132:135], v[84:87], v[56:59], v[132:135]
    ds_read_b128 v[80:83], v2 offset:12288
    ds_read_b128 v[84:87], v2 offset:26624
    s_waitcnt lgkmcnt(2)
    v_mfma_f32_16x16x32_bf16 v[128:131], v[104:107], v[60:63], v[128:131]
    v_mfma_f32_16x16x32_bf16 v[132:135], v[108:111], v[60:63], v[132:135]
    ds_read_b128 v[104:107], v2 offset:13312
    ds_read_b128 v[108:111], v2 offset:27648
    s_waitcnt lgkmcnt(2)
    v_mfma_f32_16x16x32_bf16 v[128:131], v[80:83], v[64:67], v[128:131]
    v_mfma_f32_16x16x32_bf16 v[132:135], v[84:87], v[64:67], v[132:135]
    s_waitcnt lgkmcnt(0)
    v_mfma_f32_16x16x32_bf16 v[128:131], v[104:107], v[68:71], v[128:131]
    v_mfma_f32_16x16x32_bf16 v[132:135], v[108:111], v[68:71], v[132:135]
    ds_read_b128 v[80:83], v5 offset:20480
    ds_read_b128 v[84:87], v5 offset:21504
    s_nop 4
    v_cvt_pk_bf16_f32 v88, v128, v129
    v_cvt_pk_bf16_f32 v89, v130, v131
    v_cvt_pk_bf16_f32 v90, v132, v133
    v_cvt_pk_bf16_f32 v91, v134, v135
    s_waitcnt lgkmcnt(0)
    s_nop 0
    v_mfma_f32_16x16x32_bf16 v[96:99], v[80:83], v[88:91], 0
    v_mfma_f32_16x16x32_bf16 v[100:103], v[84:87], v[88:91], 0
    s_nop 6
    v_cvt_pk_bf16_f32 v97, v96, v97
    v_lshlrev_b32 v96, 16, v97
    v_and_b32 v97, 0xffff0000, v97
    v_cvt_pk_bf16_f32 v99, v98, v99
    v_lshlrev_b32 v98, 16, v99
    v_and_b32 v99, 0xffff0000, v99
    v_cvt_pk_bf16_f32 v101, v100, v101
    v_lshlrev_b32 v100, 16, v101
    v_and_b32 v101, 0xffff0000, v101
    v_cvt_pk_bf16_f32 v103, v102, v103
    v_lshlrev_b32 v102, 16, v103
    v_and_b32 v103, 0xffff0000, v103
    s_barrier
    s_cmp_ge_u32 s81, 224
    s_cbranch_scc1 L_k1pre_63
    s_mul_i32 s44, s85, 57344
    s_add_u32 s12, s94, s44
    s_addc_u32 s13, s95, 0
    s_add_u32 s12, s12, 1409024
    s_addc_u32 s13, s13, 0
    s_mov_b32 s14, 57344
    s_mov_b32 s15, 0x00020000
    s_mul_i32 s46, s3, 7
    s_lshl_b32 s44, s46, 10
    s_add_u32 s45, s44, 0
    s_mov_b32 m0, s45
    s_nop 0
    buffer_load_dwordx4 v2, s[12:15], s44 offen offset:0 lds
    buffer_load_dwordx4 v2, s[12:15], s44 offen offset:1024 lds
    buffer_load_dwordx4 v2, s[12:15], s44 offen offset:2048 lds
    buffer_load_dwordx4 v2, s[12:15], s44 offen offset:3072 lds
    s_add_u32 s44, s44, 4096
    s_add_u32 s45, s45, 4096
    s_mov_b32 m0, s45
    s_nop 0
    buffer_load_dwordx4 v2, s[12:15], s44 offen offset:0 lds
    buffer_load_dwordx4 v2, s[12:15], s44 offen offset:1024 lds
    buffer_load_dwordx4 v2, s[12:15], s44 offen offset:2048 lds
L_k1pre_63:
    v_max3_f32 v8, v96, v97, v98
    v_max_f32 v8, v8, v99
    v_min3_f32 v9, v96, v97, v98
    v_min_f32 v9, v9, v99
    v_max3_f32 v10, v100, v101, v102
    v_max3_f32 v10, v10, v103, v8
    v_min3_f32 v11, v100, v101, v102
    v_min3_f32 v11, v11, v103, v9
    v_cndmask_b32 v8, v10, v8, s[52:53]
    v_cndmask_b32 v9, v11, v9, s[52:53]
    v_mov_b32 v10, v8
    s_nop 1
    v_permlane32_swap_b32 v8, v10
    v_max_f32 v8, v8, v10
    v_mov_b32 v10, v8
    s_nop 1
    v_permlane16_swap_b32 v8, v10
    v_max_f32 v8, v8, v10
    v_mov_b32 v11, v9
    s_nop 1
    v_permlane32_swap_b32 v9, v11
    v_min_f32 v9, v9, v11
    v_mov_b32 v11, v9
    s_nop 1
    v_permlane16_swap_b32 v9, v11
    v_min_f32 v9, v9, v11
    v_mul_f32 v8, s61, v8
    v_mul_f32 v9, s61, v9
    v_fma_f32 v16, v96, s61, -v8
    v_fma_f32 v24, -v96, s61, v9
    v_fma_f32 v17, v97, s61, -v8
    v_fma_f32 v25, -v97, s61, v9
    v_fma_f32 v18, v98, s61, -v8
    v_fma_f32 v26, -v98, s61, v9
    v_fma_f32 v19, v99, s61, -v8
    v_fma_f32 v27, -v99, s61, v9
    v_fma_f32 v20, v100, s61, -v8
    v_fma_f32 v28, -v100, s61, v9
    v_fma_f32 v21, v101, s61, -v8
    v_fma_f32 v29, -v101, s61, v9
    v_fma_f32 v22, v102, s61, -v8
    v_fma_f32 v30, -v102, s61, v9
    v_fma_f32 v23, v103, s61, -v8
    v_fma_f32 v31, -v103, s61, v9
    v_exp_f32 v16, v16
    v_exp_f32 v24, v24
    v_exp_f32 v17, v17
    v_exp_f32 v25, v25
    v_exp_f32 v18, v18
    v_exp_f32 v26, v26
    v_exp_f32 v19, v19
    v_exp_f32 v27, v27
    v_exp_f32 v20, v20
    v_exp_f32 v28, v28
    v_exp_f32 v21, v21
    v_exp_f32 v29, v29
    v_exp_f32 v22, v22
    v_exp_f32 v30, v30
    v_exp_f32 v23, v23
    v_exp_f32 v31, v31
    v_cndmask_b32 v20, v20, 0, s[52:53]
    v_cndmask_b32 v28, v28, 0, s[52:53]
    v_cndmask_b32 v21, v21, 0, s[52:53]
    v_cndmask_b32 v29, v29, 0, s[52:53]
    v_cndmask_b32 v22, v22, 0, s[52:53]
    v_cndmask_b32 v30, v30, 0, s[52:53]
    v_cndmask_b32 v23, v23, 0, s[52:53]
    v_cndmask_b32 v31, v31, 0, s[52:53]
    v_add_f32 v8, v16, v17
    v_add_f32 v8, v8, v18
    v_add_f32 v8, v8, v19
    v_add_f32 v8, v8, v20
    v_add_f32 v8, v8, v21
    v_add_f32 v8, v8, v22
    v_add_f32 v8, v8, v23
    v_add_f32 v9, v24, v25
    v_add_f32 v9, v9, v26
    v_add_f32 v9, v9, v27
    v_add_f32 v9, v9, v28
    v_add_f32 v9, v9, v29
    v_add_f32 v9, v9, v30
    v_add_f32 v9, v9, v31
    v_mov_b32 v10, v8
    s_nop 1
    v_permlane32_swap_b32 v8, v10
    v_add_f32 v8, v8, v10
    v_mov_b32 v10, v8
    s_nop 1
    v_permlane16_swap_b32 v8, v10
    v_add_f32 v8, v8, v10
    v_mov_b32 v11, v9
    s_nop 1
    v_permlane32_swap_b32 v9, v11
    v_add_f32 v9, v9, v11
    v_mov_b32 v11, v9
    s_nop 1
    v_permlane16_swap_b32 v9, v11
    v_add_f32 v9, v9, v11
    v_rcp_f32 v8, v8
    v_rcp_f32 v9, v9
    v_mul_f32 v16, v16, v8
    v_mul_f32 v24, v24, v9
    v_mul_f32 v17, v17, v8
    v_mul_f32 v25, v25, v9
    v_mul_f32 v18, v18, v8
    v_mul_f32 v26, v26, v9
    v_mul_f32 v19, v19, v8
    v_mul_f32 v27, v27, v9
    v_mul_f32 v20, v20, v8
    v_mul_f32 v28, v28, v9
    v_mul_f32 v21, v21, v8
    v_mul_f32 v29, v29, v9
    v_mul_f32 v22, v22, v8
    v_mul_f32 v30, v30, v9
    v_mul_f32 v23, v23, v8
    v_mul_f32 v31, v31, v9
    v_cvt_pk_bf16_f32 v176, v16, v17
    v_cvt_pk_bf16_f32 v180, v24, v25
    v_cvt_pk_bf16_f32 v177, v18, v19
    v_cvt_pk_bf16_f32 v181, v26, v27
    v_cvt_pk_bf16_f32 v178, v20, v21
    v_cvt_pk_bf16_f32 v182, v28, v29
    v_cvt_pk_bf16_f32 v179, v22, v23
    v_cvt_pk_bf16_f32 v183, v30, v31
    s_mov_b32 s40, 0
    s_cmp_lg_u32 s3, 0
    s_cbranch_scc1 L_wsk_64
    s_add_u32 s28, s94, 7921664
    s_addc_u32 s29, s95, 0
    s_mov_b32 s30, 16384
    s_mov_b32 s31, 0x00020000
    s_mov_b32 s50, 0
    s_lshl_b32 s48, s40, 2
    v_add_u32 v6, s48, v2
    s_nop 1
L_wlp_65:
    buffer_load_dwordx4 v[8:11], v6, s[28:31], 0 offen sc1
    s_waitcnt vmcnt(0)
    v_min_u32 v8, v8, v9
    v_min_u32 v10, v10, v11
    v_min_u32 v8, v8, v10
    v_cmp_ne_u32 vcc, 0, v8
    s_nop 0
    s_cmp_eq_u64 vcc, -1
    s_nop 2
    s_cbranch_scc1 L_wdn_66
    s_sleep 1
    s_add_u32 s50, s50, 1
    s_cmp_lt_u32 s50, 65536
    s_cbranch_scc1 L_wlp_65
L_wdn_66:
    s_cmp_eq_u32 s80, 0
    s_cbranch_scc1 L_wsk_64
    buffer_inv sc1
    s_waitcnt vmcnt(0)
L_wsk_64:
    s_barrier
    v_lshlrev_b32 v6, 2, v1
    v_lshlrev_b32 v7, 6, v4
    v_add_u32 v7, 48, v7
    s_lshl_b32 s44, s87, 13
    s_add_u32 s45, s44, 4096
    buffer_load_dword v16, v6, s[20:23], s44 offen offset:0 sc1
    buffer_load_dword v17, v6, s[20:23], s44 offen offset:256 sc1
    buffer_load_dword v18, v6, s[20:23], s44 offen offset:512 sc1
    buffer_load_dword v19, v6, s[20:23], s44 offen offset:768 sc1
    buffer_load_dword v20, v6, s[20:23], s44 offen offset:1024 sc1
    buffer_load_dword v21, v6, s[20:23], s44 offen offset:1280 sc1
    buffer_load_dword v22, v6, s[20:23], s44 offen offset:1536 sc1
    buffer_load_dword v23, v6, s[20:23], s44 offen offset:1792 sc1
    buffer_load_dword v24, v6, s[20:23], s44 offen offset:2048 sc1
    buffer_load_dword v25, v6, s[20:23], s44 offen offset:2304 sc1
    buffer_load_dword v26, v6, s[20:23], s44 offen offset:2560 sc1
    buffer_load_dword v27, v6, s[20:23], s44 offen offset:2816 sc1
    buffer_load_dword v28, v6, s[20:23], s44 offen offset:3072 sc1
    buffer_load_dword v29, v6, s[20:23], s44 offen offset:3328 sc1
    buffer_load_dword v30, v6, s[20:23], s44 offen offset:3584 sc1
    buffer_load_dword v31, v6, s[20:23], s44 offen offset:3840 sc1
    buffer_load_dword v32, v6, s[20:23], s45 offen offset:0 sc1
    buffer_load_dword v33, v6, s[20:23], s45 offen offset:256 sc1
    buffer_load_dword v34, v6, s[20:23], s45 offen offset:512 sc1
    buffer_load_dword v35, v6, s[20:23], s45 offen offset:768 sc1
    buffer_load_dword v36, v6, s[20:23], s45 offen offset:1024 sc1
    buffer_load_dword v37, v6, s[20:23], s45 offen offset:1280 sc1
    buffer_load_dword v38, v6, s[20:23], s45 offen offset:1536 sc1
    buffer_load_dword v39, v6, s[20:23], s45 offen offset:1792 sc1
    buffer_load_dword v40, v6, s[20:23], s45 offen offset:2048 sc1
    buffer_load_dword v41, v6, s[20:23], s45 offen offset:2304 sc1
    buffer_load_dword v42, v6, s[20:23], s45 offen offset:2560 sc1
    buffer_load_dword v43, v6, s[20:23], s45 offen offset:2816 sc1
    buffer_load_dword v44, v6, s[20:23], s45 offen offset:3072 sc1
    buffer_load_dword v45, v6, s[20:23], s45 offen offset:3328 sc1
    buffer_load_dword v46, v6, s[20:23], s45 offen offset:3584 sc1
    buffer_load_dword v47, v6, s[20:23], s45 offen offset:3840 sc1
    buffer_load_dword v48, v7, s[20:23], s44 offen offset:2048 sc1
    buffer_load_dword v49, v7, s[20:23], s44 offen offset:2304 sc1
    buffer_load_dword v50, v7, s[20:23], s44 offen offset:2560 sc1
    buffer_load_dword v51, v7, s[20:23], s44 offen offset:2816 sc1
    buffer_load_dword v52, v7, s[20:23], s44 offen offset:3072 sc1
    buffer_load_dword v53, v7, s[20:23], s44 offen offset:3328 sc1
    buffer_load_dword v54, v7, s[20:23], s44 offen offset:3584 sc1
    buffer_load_dword v55, v7, s[20:23], s44 offen offset:3840 sc1
    buffer_load_dword v56, v7, s[20:23], s45 offen offset:2048 sc1
    buffer_load_dword v57, v7, s[20:23], s45 offen offset:2304 sc1
    buffer_load_dword v58, v7, s[20:23], s45 offen offset:2560 sc1
    buffer_load_dword v59, v7, s[20:23], s45 offen offset:2816 sc1
    buffer_load_dword v60, v7, s[20:23], s45 offen offset:3072 sc1
    buffer_load_dword v61, v7, s[20:23], s45 offen offset:3328 sc1
    buffer_load_dword v62, v7, s[20:23], s45 offen offset:3584 sc1
    buffer_load_dword v63, v7, s[20:23], s45 offen offset:3840 sc1
    s_waitcnt vmcnt(0)
    v_cvt_pk_bf16_f32 v64, v16, v17
    v_cvt_pk_bf16_f32 v65, v18, v19
    v_cvt_pk_bf16_f32 v66, v20, v21
    v_cvt_pk_bf16_f32 v67, v22, v23
    v_cvt_pk_bf16_f32 v68, v24, v25
    v_cvt_pk_bf16_f32 v69, v26, v27
    v_cvt_pk_bf16_f32 v70, v28, v29
    v_cvt_pk_bf16_f32 v71, v30, v31
    v_cvt_pk_bf16_f32 v72, v32, v33
    v_cvt_pk_bf16_f32 v73, v34, v35
    v_cvt_pk_bf16_f32 v74, v36, v37
    v_cvt_pk_bf16_f32 v75, v38, v39
    v_cvt_pk_bf16_f32 v76, v40, v41
    v_cvt_pk_bf16_f32 v77, v42, v43
    v_cvt_pk_bf16_f32 v78, v44, v45
    v_cvt_pk_bf16_f32 v79, v46, v47
    v_cvt_pk_bf16_f32 v80, v48, v49
    v_cvt_pk_bf16_f32 v81, v50, v51
    v_cvt_pk_bf16_f32 v82, v52, v53
    v_cvt_pk_bf16_f32 v83, v54, v55
    v_cvt_pk_bf16_f32 v84, v56, v57
    v_cvt_pk_bf16_f32 v85, v58, v59
    v_cvt_pk_bf16_f32 v86, v60, v61
    v_cvt_pk_bf16_f32 v87, v62, v63
    v_mfma_f32_16x16x32_bf16 v[96:99], v[64:67], v[176:179], 0
    v_mfma_f32_16x16x32_bf16 v[100:103], v[68:71], v[176:179], 0
    v_mfma_f32_16x16x32_bf16 v[104:107], v[80:83], v[176:179], 0
    v_mfma_f32_16x16x32_bf16 v[96:99], v[72:75], v[180:183], v[96:99]
    v_mfma_f32_16x16x32_bf16 v[100:103], v[76:79], v[180:183], v[100:103]
    v_mfma_f32_16x16x32_bf16 v[104:107], v[84:87], v[180:183], v[104:107]
    s_nop 7
    v_cvt_pk_bf16_f32 v104, v104, v104
    v_and_b32 v104, 0xffff0000, v104
    v_add_f32 v104, 0x358637bd, v104
    v_cvt_pk_bf16_f32 v104, v104, v104
    v_and_b32 v104, 0xffff0000, v104
    v_rcp_f32 v104, v104
    v_cvt_pk_bf16_f32 v97, v96, v97
    v_lshlrev_b32 v96, 16, v97
    v_and_b32 v97, 0xffff0000, v97
    v_cvt_pk_bf16_f32 v99, v98, v99
    v_lshlrev_b32 v98, 16, v99
    v_and_b32 v99, 0xffff0000, v99
    v_cvt_pk_bf16_f32 v101, v100, v101
    v_lshlrev_b32 v100, 16, v101
    v_and_b32 v101, 0xffff0000, v101
    v_cvt_pk_bf16_f32 v103, v102, v103
    v_lshlrev_b32 v102, 16, v103
    v_and_b32 v103, 0xffff0000, v103
    v_mul_f32 v96, v96, v104
    v_mul_f32 v97, v97, v104
    v_mul_f32 v98, v98, v104
    v_mul_f32 v99, v99, v104
    v_mul_f32 v100, v100, v104
    v_mul_f32 v101, v101, v104
    v_mul_f32 v102, v102, v104
    v_mul_f32 v103, v103, v104
    v_cvt_pk_bf16_f32 v108, v96, v97
    v_cvt_pk_bf16_f32 v109, v98, v99
    v_cvt_pk_bf16_f32 v110, v100, v101
    v_cvt_pk_bf16_f32 v111, v102, v103
    s_add_u32 s16, s94, 7938048
    s_addc_u32 s17, s95, 0
    s_mov_b32 s18, 1835008
    s_mov_b32 s19, 0x00020000
    s_mul_i32 s44, s87, 28
    v_lshl_add_u32 v8, v4, 2, s44
    v_lshrrev_b32 v9, 5, v8
    v_lshlrev_b32 v6, 10, v9
    v_bfe_u32 v9, v8, 3, 2
    v_lshl_add_u32 v6, v9, 8, v6
    v_lshl_add_u32 v6, v3, 4, v6
    v_and_b32 v9, 7, v8
    v_lshl_add_u32 v6, v9, 1, v6
    v_add_u32 v8, 16, v8
    v_lshrrev_b32 v9, 5, v8
    v_lshlrev_b32 v7, 10, v9
    v_bfe_u32 v9, v8, 3, 2
    v_lshl_add_u32 v7, v9, 8, v7
    v_lshl_add_u32 v7, v3, 4, v7
    v_and_b32 v9, 7, v8
    v_lshl_add_u32 v7, v9, 1, v7
    v_mov_b32 v8, 0x40000000
    v_cndmask_b32 v7, v7, v8, s[52:53]
    s_mul_i32 s44, s47, 14336
    buffer_store_dwordx2 v[108:109], v6, s[16:19], s44 offen
    buffer_store_dwordx2 v[110:111], v7, s[16:19], s44 offen
    s_lshl_b32 s40, s86, 4
    s_add_u32 s40, s40, s87
    s_add_u32 s40, s40, 256
    s_waitcnt vmcnt(0)
    s_barrier
    s_cmp_lg_u32 s3, 0
    s_cbranch_scc1 L_sig_67
    s_add_u32 s28, s94, 7921664
    s_addc_u32 s29, s95, 0
    s_mov_b32 s30, 16384
    s_mov_b32 s31, 0x00020000
    s_lshl_b32 s48, s40, 2
    v_mov_b32 v6, 1
    v_mov_b32 v7, s48
    s_mov_b64 exec, 1
    s_cmp_lg_u32 s80, 0
    s_cbranch_scc1 L_sigfb_68
    buffer_store_dword v6, v7, s[28:31], 0 offen
    s_nop 1
    s_branch L_sigj_69
L_sigfb_68:
    buffer_wbl2 sc1
    s_waitcnt vmcnt(0)
    buffer_store_dword v6, v7, s[28:31], 0 offen sc1
    s_nop 1
L_sigj_69:
    s_mov_b64 exec, -1
L_sig_67:
    s_cmp_ge_u32 s81, 224
    s_cbranch_scc1 L_idle_70
    s_lshr_b32 s40, s84, 1
    s_lshl_b32 s40, s40, 4
    s_add_u32 s40, s40, 256
    s_cmp_lg_u32 s3, 0
    s_cbranch_scc1 L_wsk_73
    s_add_u32 s28, s94, 7921664
    s_addc_u32 s29, s95, 0
    s_mov_b32 s30, 16384
    s_mov_b32 s31, 0x00020000
    s_mov_b32 s50, 0
    v_add_u32 v6, s40, v1
    v_cmp_le_u32 s[48:49], 16, v1
    v_lshlrev_b32 v6, 2, v6
    s_nop 0
    v_cndmask_b32 v6, v6, 0, s[48:49]
    s_nop 1
L_wlp_74:
    buffer_load_dword v8, v6, s[28:31], 0 offen sc1
    s_waitcnt vmcnt(0)
    v_cmp_ne_u32 vcc, 0, v8
    s_nop 0
    s_or_b64 vcc, vcc, s[48:49]
    s_cmp_eq_u64 vcc, -1
    s_nop 1
    s_cbranch_scc1 L_wdn_75
    s_sleep 1
    s_add_u32 s50, s50, 1
    s_cmp_lt_u32 s50, 65536
    s_cbranch_scc1 L_wlp_74
L_wdn_75:
    s_cmp_eq_u32 s80, 0
    s_cbranch_scc1 L_wsk_73
    buffer_inv sc1
    s_waitcnt vmcnt(0)
L_wsk_73:
    s_barrier
    s_add_u32 s8, s94, 7938048
    s_addc_u32 s9, s95, 0
    s_mov_b32 s10, 1835008
    s_mov_b32 s11, 0x00020000
    s_add_u32 s16, s94, 5824512
    s_addc_u32 s17, s95, 0
    s_mov_b32 s18, 1835008
    s_mov_b32 s19, 0x00020000
    s_add_u32 s20, s94, 11608064
    s_addc_u32 s21, s95, 0
    s_mov_b32 s22, 1835008
    s_mov_b32 s23, 0x00020000
    s_lshl_b32 s44, s84, 2
    s_add_u32 s44, s44, s88
    s_mul_i32 s44, s44, 14
    s_mul_i32 s45, s89, 7
    s_add_u32 s44, s44, s45
    s_lshl_b32 s44, s44, 10
    buffer_load_dwordx4 v[16:19], v2, s[8:11], s44 offen offset:0
    buffer_load_dwordx4 v[20:23], v2, s[8:11], s44 offen offset:1024
    buffer_load_dwordx4 v[24:27], v2, s[8:11], s44 offen offset:2048
    buffer_load_dwordx4 v[28:31], v2, s[8:11], s44 offen offset:3072
    s_add_u32 s44, s44, 4096
    buffer_load_dwordx4 v[32:35], v2, s[8:11], s44 offen offset:0
    buffer_load_dwordx4 v[36:39], v2, s[8:11], s44 offen offset:1024
    buffer_load_dwordx4 v[40:43], v2, s[8:11], s44 offen offset:2048
    s_lshl_b32 s41, s84, 2
    s_add_u32 s41, s41, s88
    s_mul_i32 s41, s41, 14
    s_lshl_b32 s45, s85, 1
    s_add_u32 s41, s41, s45
    s_add_u32 s41, s41, s89
    s_lshl_b32 s41, s41, 10
    buffer_load_dwordx4 v[60:63], v2, s[16:19], s41 offen
    s_waitcnt vmcnt(0)
    s_barrier
    s_mul_i32 s44, s85, 57344
    s_add_u32 s12, s94, s44
    s_addc_u32 s13, s95, 0
    s_add_u32 s12, s12, 1810432
    s_addc_u32 s13, s13, 0
    s_mov_b32 s14, 57344
    s_mov_b32 s15, 0x00020000
    s_mul_i32 s46, s3, 7
    s_lshl_b32 s46, s46, 10
    s_add_u32 s47, s46, 57344
    s_mul_i32 s44, s89, 7168
    v_add_u32 v8, s44, v2
    ds_read_b128 v[80:83], v8 offset:0
    ds_read_b128 v[84:87], v8 offset:14336
    ds_read_b128 v[88:91], v8 offset:28672
    ds_read_b128 v[92:95], v8 offset:43008
    ds_read_b128 v[96:99], v8 offset:1024
    ds_read_b128 v[100:103], v8 offset:15360
    ds_read_b128 v[104:107], v8 offset:29696
    ds_read_b128 v[108:111], v8 offset:44032
    s_waitcnt lgkmcnt(4)
    v_mfma_f32_16x16x32_bf16 v[64:67], v[80:83], v[16:19], 0
    v_mfma_f32_16x16x32_bf16 v[68:71], v[84:87], v[16:19], 0
    v_mfma_f32_16x16x32_bf16 v[72:75], v[88:91], v[16:19], 0
    v_mfma_f32_16x16x32_bf16 v[76:79], v[92:95], v[16:19], 0
    s_mov_b32 m0, s47
    s_nop 0
    buffer_load_dwordx4 v2, s[12:15], s46 offen lds
    s_add_u32 s46, s46, 1024
    s_add_u32 s47, s47, 1024
    ds_read_b128 v[80:83], v8 offset:2048
    ds_read_b128 v[84:87], v8 offset:16384
    ds_read_b128 v[88:91], v8 offset:30720
    ds_read_b128 v[92:95], v8 offset:45056
    s_waitcnt lgkmcnt(4)
    v_mfma_f32_16x16x32_bf16 v[64:67], v[96:99], v[20:23], v[64:67]
    v_mfma_f32_16x16x32_bf16 v[68:71], v[100:103], v[20:23], v[68:71]
    v_mfma_f32_16x16x32_bf16 v[72:75], v[104:107], v[20:23], v[72:75]
    v_mfma_f32_16x16x32_bf16 v[76:79], v[108:111], v[20:23], v[76:79]
    s_mov_b32 m0, s47
    s_nop 0
    buffer_load_dwordx4 v2, s[12:15], s46 offen lds
    s_add_u32 s46, s46, 1024
    s_add_u32 s47, s47, 1024
    ds_read_b128 v[96:99], v8 offset:3072
    ds_read_b128 v[100:103], v8 offset:17408
    ds_read_b128 v[104:107], v8 offset:31744
    ds_read_b128 v[108:111], v8 offset:46080
    s_waitcnt lgkmcnt(4)
    v_mfma_f32_16x16x32_bf16 v[64:67], v[80:83], v[24:27], v[64:67]
    v_mfma_f32_16x16x32_bf16 v[68:71], v[84:87], v[24:27], v[68:71]
    v_mfma_f32_16x16x32_bf16 v[72:75], v[88:91], v[24:27], v[72:75]
    v_mfma_f32_16x16x32_bf16 v[76:79], v[92:95], v[24:27], v[76:79]
    s_mov_b32 m0, s47
    s_nop 0
    buffer_load_dwordx4 v2, s[12:15], s46 offen lds
    s_add_u32 s46, s46, 1024
    s_add_u32 s47, s47, 1024
    ds_read_b128 v[80:83], v8 offset:4096
    ds_read_b128 v[84:87], v8 offset:18432
    ds_read_b128 v[88:91], v8 offset:32768
    ds_read_b128 v[92:95], v8 offset:47104
    s_waitcnt lgkmcnt(4)
    v_mfma_f32_16x16x32_bf16 v[64:67], v[96:99], v[28:31], v[64:67]
    v_mfma_f32_16x16x32_bf16 v[68:71], v[100:103], v[28:31], v[68:71]
    v_mfma_f32_16x16x32_bf16 v[72:75], v[104:107], v[28:31], v[72:75]
    v_mfma_f32_16x16x32_bf16 v[76:79], v[108:111], v[28:31], v[76:79]
    s_mov_b32 m0, s47
    s_nop 0
    buffer_load_dwordx4 v2, s[12:15], s46 offen lds
    s_add_u32 s46, s46, 1024
    s_add_u32 s47, s47, 1024
    ds_read_b128 v[96:99], v8 offset:5120
    ds_read_b128 v[100:103], v8 offset:19456
    ds_read_b128 v[104:107], v8 offset:33792
    ds_read_b128 v[108:111], v8 offset:48128
    s_waitcnt lgkmcnt(4)
    v_mfma_f32_16x16x32_bf16 v[64:67], v[80:83], v[32:35], v[64:67]
    v_mfma_f32_16x16x32_bf16 v[68:71], v[84:87], v[32:35], v[68:71]
    v_mfma_f32_16x16x32_bf16 v[72:75], v[88:91], v[32:35], v[72:75]
    v_mfma_f32_16x16x32_bf16 v[76:79], v[92:95], v[32:35], v[76:79]
    s_mov_b32 m0, s47
    s_nop 0
    buffer_load_dwordx4 v2, s[12:15], s46 offen lds
    s_add_u32 s46, s46, 1024
    s_add_u32 s47, s47, 1024
    ds_read_b128 v[80:83], v8 offset:6144
    ds_read_b128 v[84:87], v8 offset:20480
    ds_read_b128 v[88:91], v8 offset:34816
    ds_read_b128 v[92:95], v8 offset:49152
    s_waitcnt lgkmcnt(4)
    v_mfma_f32_16x16x32_bf16 v[64:67], v[96:99], v[36:39], v[64:67]
    v_mfma_f32_16x16x32_bf16 v[68:71], v[100:103], v[36:39], v[68:71]
    v_mfma_f32_16x16x32_bf16 v[72:75], v[104:107], v[36:39], v[72:75]
    v_mfma_f32_16x16x32_bf16 v[76:79], v[108:111], v[36:39], v[76:79]
    s_mov_b32 m0, s47
    s_nop 0
    buffer_load_dwordx4 v2, s[12:15], s46 offen lds
    s_add_u32 s46, s46, 1024
    s_add_u32 s47, s47, 1024
    s_waitcnt lgkmcnt(0)
    v_mfma_f32_16x16x32_bf16 v[64:67], v[80:83], v[40:43], v[64:67]
    v_mfma_f32_16x16x32_bf16 v[68:71], v[84:87], v[40:43], v[68:71]
    v_mfma_f32_16x16x32_bf16 v[72:75], v[88:91], v[40:43], v[72:75]
    v_mfma_f32_16x16x32_bf16 v[76:79], v[92:95], v[40:43], v[76:79]
    s_mov_b32 m0, s47
    s_nop 0
    buffer_load_dwordx4 v2, s[12:15], s46 offen lds
    s_add_u32 s46, s46, 1024
    s_add_u32 s47, s47, 1024
    s_lshl_b32 s44, s88, 1
    s_add_u32 s44, s44, s89
    s_lshl_b32 s45, s44, 11
    s_xor_b32 s44, s44, 1
    s_lshl_b32 s44, s44, 11
    s_add_u32 s45, s45, 147456
    s_add_u32 s44, s44, 147456
    v_add_u32 v6, s45, v2
    v_add_u32 v7, s44, v2
    s_cmp_eq_u32 s89, 0
    s_nop 0
    s_cbranch_scc1 L_hx_lo_76
    ds_write_b128 v6, v[64:67]
    ds_write_b128 v6, v[68:71] offset:1024
    v_mov_b32 v16, v72
    v_mov_b32 v17, v73
    v_mov_b32 v18, v74
    v_mov_b32 v19, v75
    v_mov_b32 v20, v76
    v_mov_b32 v21, v77
    v_mov_b32 v22, v78
    v_mov_b32 v23, v79
    s_nop 1
    s_branch L_hx_j1_77
L_hx_lo_76:
    ds_write_b128 v6, v[72:75]
    ds_write_b128 v6, v[76:79] offset:1024
    v_mov_b32 v16, v64
    v_mov_b32 v17, v65
    v_mov_b32 v18, v66
    v_mov_b32 v19, v67
    v_mov_b32 v20, v68
    v_mov_b32 v21, v69
    v_mov_b32 v22, v70
    v_mov_b32 v23, v71
    s_nop 1
L_hx_j1_77:
    s_waitcnt lgkmcnt(0)
    s_barrier
    ds_read_b128 v[64:67], v7
    ds_read_b128 v[68:71], v7 offset:1024
    s_waitcnt lgkmcnt(0)
    v_add_f32 v16, v16, v64
    v_add_f32 v17, v17, v65
    v_add_f32 v18, v18, v66
    v_add_f32 v19, v19, v67
    v_add_f32 v20, v20, v68
    v_add_f32 v21, v21, v69
    v_add_f32 v22, v22, v70
    v_add_f32 v23, v23, v71
    v_cvt_pk_bf16_f32 v17, v16, v17
    v_lshlrev_b32 v16, 16, v17
    v_and_b32 v17, 0xffff0000, v17
    v_cvt_pk_bf16_f32 v19, v18, v19
    v_lshlrev_b32 v18, 16, v19
    v_and_b32 v19, 0xffff0000, v19
    v_cvt_pk_bf16_f32 v21, v20, v21
    v_lshlrev_b32 v20, 16, v21
    v_and_b32 v21, 0xffff0000, v21
    v_cvt_pk_bf16_f32 v23, v22, v23
    v_lshlrev_b32 v22, 16, v23
    v_and_b32 v23, 0xffff0000, v23
    v_lshlrev_b32 v8, 16, v60
    v_and_b32 v9, 0xffff0000, v60
    v_add_f32 v16, v16, v8
    v_add_f32 v17, v17, v9
    v_lshlrev_b32 v8, 16, v61
    v_and_b32 v9, 0xffff0000, v61
    v_add_f32 v18, v18, v8
    v_add_f32 v19, v19, v9
    v_lshlrev_b32 v8, 16, v62
    v_and_b32 v9, 0xffff0000, v62
    v_add_f32 v20, v20, v8
    v_add_f32 v21, v21, v9
    v_lshlrev_b32 v8, 16, v63
    v_and_b32 v9, 0xffff0000, v63
    v_add_f32 v22, v22, v8
    v_add_f32 v23, v23, v9
    v_cvt_pk_bf16_f32 v24, v16, v17
    v_cvt_pk_bf16_f32 v25, v18, v19
    v_cvt_pk_bf16_f32 v26, v20, v21
    v_cvt_pk_bf16_f32 v27, v22, v23
    buffer_store_dwordx4 v[24:27], v2, s[20:23], s41 offen
    s_lshl_b32 s40, s84, 3
    s_add_u32 s40, s40, s85
    s_add_u32 s40, s40, 512
    s_waitcnt vmcnt(0)
    s_barrier
    s_cmp_lg_u32 s3, 0
    s_cbranch_scc1 L_sig_78
    s_add_u32 s28, s94, 7921664
    s_addc_u32 s29, s95, 0
    s_mov_b32 s30, 16384
    s_mov_b32 s31, 0x00020000
    s_lshl_b32 s48, s40, 2
    v_mov_b32 v6, 1
    v_mov_b32 v7, s48
    s_mov_b64 exec, 1
    s_cmp_lg_u32 s80, 0
    s_cbranch_scc1 L_sigfb_79
    buffer_store_dword v6, v7, s[28:31], 0 offen
    s_nop 1
    s_branch L_sigj_80
L_sigfb_79:
    buffer_wbl2 sc1
    s_waitcnt vmcnt(0)
    buffer_store_dword v6, v7, s[28:31], 0 offen sc1
    s_nop 1
L_sigj_80:
    s_mov_b64 exec, -1
L_sig_78:
    s_lshl_b32 s40, s84, 3
    s_add_u32 s40, s40, 512
    s_cmp_lg_u32 s3, 0
    s_cbranch_scc1 L_wsk_81
    s_add_u32 s28, s94, 7921664
    s_addc_u32 s29, s95, 0
    s_mov_b32 s30, 16384
    s_mov_b32 s31, 0x00020000
    s_mov_b32 s50, 0
    v_add_u32 v6, s40, v1
    v_cmp_le_u32 s[48:49], 7, v1
    v_lshlrev_b32 v6, 2, v6
    s_nop 0
    v_cndmask_b32 v6, v6, 0, s[48:49]
    s_nop 1
L_wlp_82:
    buffer_load_dword v8, v6, s[28:31], 0 offen sc1
    s_waitcnt vmcnt(0)
    v_cmp_ne_u32 vcc, 0, v8
    s_nop 0
    s_or_b64 vcc, vcc, s[48:49]
    s_cmp_eq_u64 vcc, -1
    s_nop 1
    s_cbranch_scc1 L_wdn_83
    s_sleep 1
    s_add_u32 s50, s50, 1
    s_cmp_lt_u32 s50, 65536
    s_cbranch_scc1 L_wlp_82
L_wdn_83:
    s_cmp_eq_u32 s80, 0
    s_cbranch_scc1 L_wsk_81
    buffer_inv sc1
    s_waitcnt vmcnt(0)
L_wsk_81:
    s_barrier
    s_add_u32 s8, s94, 11608064
    s_addc_u32 s9, s95, 0
    s_mov_b32 s10, 1835008
    s_mov_b32 s11, 0x00020000
    s_add_u32 s16, s94, 15278080
    s_addc_u32 s17, s95, 0
    s_mov_b32 s18, 1835008
    s_mov_b32 s19, 0x00020000
    s_add_u32 s20, s94, 18948096
    s_addc_u32 s21, s95, 0
    s_mov_b32 s22, 1835008
    s_mov_b32 s23, 0x00020000
    s_lshl_b32 s44, s84, 2
    s_add_u32 s44, s44, s88
    s_mul_i32 s44, s44, 14
    s_mul_i32 s45, s89, 7
    s_add_u32 s44, s44, s45
    s_lshl_b32 s44, s44, 10
    s_mov_b32 s42, s44
    buffer_load_dwordx4 v[16:19], v2, s[8:11], s44 offen offset:0
    buffer_load_dwordx4 v[20:23], v2, s[8:11], s44 offen offset:1024
    buffer_load_dwordx4 v[24:27], v2, s[8:11], s44 offen offset:2048
    buffer_load_dwordx4 v[28:31], v2, s[8:11], s44 offen offset:3072
    s_add_u32 s44, s44, 4096
    buffer_load_dwordx4 v[32:35], v2, s[8:11], s44 offen offset:0
    buffer_load_dwordx4 v[36:39], v2, s[8:11], s44 offen offset:1024
    buffer_load_dwordx4 v[40:43], v2, s[8:11], s44 offen offset:2048
    s_waitcnt vmcnt(0)
    v_mov_b32 v8, 0
    v_mov_b32 v9, 0
    v_mov_b32 v10, 0
    v_mov_b32 v11, 0
    v_dot2_f32_bf16 v8, v16, s60, v8
    v_dot2_f32_bf16 v9, v16, v16, v9
    v_dot2_f32_bf16 v10, v17, s60, v10
    v_dot2_f32_bf16 v11, v17, v17, v11
    v_dot2_f32_bf16 v8, v18, s60, v8
    v_dot2_f32_bf16 v9, v18, v18, v9
    v_dot2_f32_bf16 v10, v19, s60, v10
    v_dot2_f32_bf16 v11, v19, v19, v11
    v_dot2_f32_bf16 v8, v20, s60, v8
    v_dot2_f32_bf16 v9, v20, v20, v9
    v_dot2_f32_bf16 v10, v21, s60, v10
    v_dot2_f32_bf16 v11, v21, v21, v11
    v_dot2_f32_bf16 v8, v22, s60, v8
    v_dot2_f32_bf16 v9, v22, v22, v9
    v_dot2_f32_bf16 v10, v23, s60, v10
    v_dot2_f32_bf16 v11, v23, v23, v11
    v_dot2_f32_bf16 v8, v24, s60, v8
    v_dot2_f32_bf16 v9, v24, v24, v9
    v_dot2_f32_bf16 v10, v25, s60, v10
    v_dot2_f32_bf16 v11, v25, v25, v11
    v_dot2_f32_bf16 v8, v26, s60, v8
    v_dot2_f32_bf16 v9, v26, v26, v9
    v_dot2_f32_bf16 v10, v27, s60, v10
    v_dot2_f32_bf16 v11, v27, v27, v11
    v_dot2_f32_bf16 v8, v28, s60, v8
    v_dot2_f32_bf16 v9, v28, v28, v9
    v_dot2_f32_bf16 v10, v29, s60, v10
    v_dot2_f32_bf16 v11, v29, v29, v11
    v_dot2_f32_bf16 v8, v30, s60, v8
    v_dot2_f32_bf16 v9, v30, v30, v9
    v_dot2_f32_bf16 v10, v31, s60, v10
    v_dot2_f32_bf16 v11, v31, v31, v11
    v_dot2_f32_bf16 v8, v32, s60, v8
    v_dot2_f32_bf16 v9, v32, v32, v9
    v_dot2_f32_bf16 v10, v33, s60, v10
    v_dot2_f32_bf16 v11, v33, v33, v11
    v_dot2_f32_bf16 v8, v34, s60, v8
    v_dot2_f32_bf16 v9, v34, v34, v9
    v_dot2_f32_bf16 v10, v35, s60, v10
    v_dot2_f32_bf16 v11, v35, v35, v11
    v_dot2_f32_bf16 v8, v36, s60, v8
    v_dot2_f32_bf16 v9, v36, v36, v9
    v_dot2_f32_bf16 v10, v37, s60, v10
    v_dot2_f32_bf16 v11, v37, v37, v11
    v_dot2_f32_bf16 v8, v38, s60, v8
    v_dot2_f32_bf16 v9, v38, v38, v9
    v_dot2_f32_bf16 v10, v39, s60, v10
    v_dot2_f32_bf16 v11, v39, v39, v11
    v_dot2_f32_bf16 v8, v40, s60, v8
    v_dot2_f32_bf16 v9, v40, v40, v9
    v_dot2_f32_bf16 v10, v41, s60, v10
    v_dot2_f32_bf16 v11, v41, v41, v11
    v_dot2_f32_bf16 v8, v42, s60, v8
    v_dot2_f32_bf16 v9, v42, v42, v9
    v_dot2_f32_bf16 v10, v43, s60, v10
    v_dot2_f32_bf16 v11, v43, v43, v11
    s_nop 1
    v_add_f32 v8, v8, v10
    v_add_f32 v9, v9, v11
    v_mov_b32 v10, v8
    s_nop 1
    v_permlane32_swap_b32 v8, v10
    v_add_f32 v8, v8, v10
    v_mov_b32 v10, v8
    s_nop 1
    v_permlane16_swap_b32 v8, v10
    v_add_f32 v8, v8, v10
    v_mov_b32 v11, v9
    s_nop 1
    v_permlane32_swap_b32 v9, v11
    v_add_f32 v9, v9, v11
    v_mov_b32 v11, v9
    s_nop 1
    v_permlane16_swap_b32 v9, v11
    v_add_f32 v9, v9, v11
    s_lshl_b32 s44, s89, 2
    s_add_u32 s44, s44, s88
    s_lshl_b32 s45, s44, 7
    s_xor_b32 s44, s44, 4
    s_lshl_b32 s44, s44, 7
    s_add_u32 s45, s45, 145408
    s_add_u32 s44, s44, 145408
    v_lshl_add_u32 v6, v3, 3, s45
    v_lshl_add_u32 v7, v3, 3, s44
    ds_write_b64 v6, v[8:9] offset:0
    s_waitcnt lgkmcnt(0)
    s_barrier
    ds_read_b64 v[6:7], v7 offset:0
    s_waitcnt lgkmcnt(0)
    v_add_f32 v8, v8, v6
    v_add_f32 v9, v9, v7
    v_mul_f32 v8, 0x3b124925, v8
    v_mul_f32 v9, 0x3b124925, v9
    v_fma_f32 v9, -v8, v8, v9
    v_max_f32 v9, 0, v9
    v_cvt_pk_bf16_f32 v8, v8, v8
    v_and_b32 v8, 0xffff0000, v8
    v_cvt_pk_bf16_f32 v9, v9, v9
    v_and_b32 v9, 0xffff0000, v9
    v_add_f32 v9, 0x3727c5ac, v9
    v_cvt_pk_bf16_f32 v9, v9, v9
    v_and_b32 v9, 0xffff0000, v9
    v_sqrt_f32 v9, v9
    s_nop 0
    v_cvt_pk_bf16_f32 v9, v9, v9
    v_and_b32 v9, 0xffff0000, v9
    v_rcp_f32 v72, v9
    s_nop 0
    v_mul_f32 v74, v8, v72
    v_sub_f32 v74, 0, v74
    v_lshlrev_b32 v76, 16, v16
    v_and_b32 v77, 0xffff0000, v16
    v_pk_fma_f32 v[76:77], v[76:77], v[72:73], v[74:75] op_sel_hi:[1,0,0]
    v_cvt_pk_bf16_f32 v16, v76, v77
    v_lshlrev_b32 v78, 16, v17
    v_and_b32 v79, 0xffff0000, v17
    v_pk_fma_f32 v[78:79], v[78:79], v[72:73], v[74:75] op_sel_hi:[1,0,0]
    v_cvt_pk_bf16_f32 v17, v78, v79
    v_lshlrev_b32 v80, 16, v18
    v_and_b32 v81, 0xffff0000, v18
    v_pk_fma_f32 v[80:81], v[80:81], v[72:73], v[74:75] op_sel_hi:[1,0,0]
    v_cvt_pk_bf16_f32 v18, v80, v81
    v_lshlrev_b32 v82, 16, v19
    v_and_b32 v83, 0xffff0000, v19
    v_pk_fma_f32 v[82:83], v[82:83], v[72:73], v[74:75] op_sel_hi:[1,0,0]
    v_cvt_pk_bf16_f32 v19, v82, v83
    v_lshlrev_b32 v76, 16, v20
    v_and_b32 v77, 0xffff0000, v20
    v_pk_fma_f32 v[76:77], v[76:77], v[72:73], v[74:75] op_sel_hi:[1,0,0]
    v_cvt_pk_bf16_f32 v20, v76, v77
    v_lshlrev_b32 v78, 16, v21
    v_and_b32 v79, 0xffff0000, v21
    v_pk_fma_f32 v[78:79], v[78:79], v[72:73], v[74:75] op_sel_hi:[1,0,0]
    v_cvt_pk_bf16_f32 v21, v78, v79
    v_lshlrev_b32 v80, 16, v22
    v_and_b32 v81, 0xffff0000, v22
    v_pk_fma_f32 v[80:81], v[80:81], v[72:73], v[74:75] op_sel_hi:[1,0,0]
    v_cvt_pk_bf16_f32 v22, v80, v81
    v_lshlrev_b32 v82, 16, v23
    v_and_b32 v83, 0xffff0000, v23
    v_pk_fma_f32 v[82:83], v[82:83], v[72:73], v[74:75] op_sel_hi:[1,0,0]
    v_cvt_pk_bf16_f32 v23, v82, v83
    v_lshlrev_b32 v76, 16, v24
    v_and_b32 v77, 0xffff0000, v24
    v_pk_fma_f32 v[76:77], v[76:77], v[72:73], v[74:75] op_sel_hi:[1,0,0]
    v_cvt_pk_bf16_f32 v24, v76, v77
    v_lshlrev_b32 v78, 16, v25
    v_and_b32 v79, 0xffff0000, v25
    v_pk_fma_f32 v[78:79], v[78:79], v[72:73], v[74:75] op_sel_hi:[1,0,0]
    v_cvt_pk_bf16_f32 v25, v78, v79
    v_lshlrev_b32 v80, 16, v26
    v_and_b32 v81, 0xffff0000, v26
    v_pk_fma_f32 v[80:81], v[80:81], v[72:73], v[74:75] op_sel_hi:[1,0,0]
    v_cvt_pk_bf16_f32 v26, v80, v81
    v_lshlrev_b32 v82, 16, v27
    v_and_b32 v83, 0xffff0000, v27
    v_pk_fma_f32 v[82:83], v[82:83], v[72:73], v[74:75] op_sel_hi:[1,0,0]
    v_cvt_pk_bf16_f32 v27, v82, v83
    v_lshlrev_b32 v76, 16, v28
    v_and_b32 v77, 0xffff0000, v28
    v_pk_fma_f32 v[76:77], v[76:77], v[72:73], v[74:75] op_sel_hi:[1,0,0]
    v_cvt_pk_bf16_f32 v28, v76, v77
    v_lshlrev_b32 v78, 16, v29
    v_and_b32 v79, 0xffff0000, v29
    v_pk_fma_f32 v[78:79], v[78:79], v[72:73], v[74:75] op_sel_hi:[1,0,0]
    v_cvt_pk_bf16_f32 v29, v78, v79
    v_lshlrev_b32 v80, 16, v30
    v_and_b32 v81, 0xffff0000, v30
    v_pk_fma_f32 v[80:81], v[80:81], v[72:73], v[74:75] op_sel_hi:[1,0,0]
    v_cvt_pk_bf16_f32 v30, v80, v81
    v_lshlrev_b32 v82, 16, v31
    v_and_b32 v83, 0xffff0000, v31
    v_pk_fma_f32 v[82:83], v[82:83], v[72:73], v[74:75] op_sel_hi:[1,0,0]
    v_cvt_pk_bf16_f32 v31, v82, v83
    v_lshlrev_b32 v76, 16, v32
    v_and_b32 v77, 0xffff0000, v32
    v_pk_fma_f32 v[76:77], v[76:77], v[72:73], v[74:75] op_sel_hi:[1,0,0]
    v_cvt_pk_bf16_f32 v32, v76, v77
    v_lshlrev_b32 v78, 16, v33
    v_and_b32 v79, 0xffff0000, v33
    v_pk_fma_f32 v[78:79], v[78:79], v[72:73], v[74:75] op_sel_hi:[1,0,0]
    v_cvt_pk_bf16_f32 v33, v78, v79
    v_lshlrev_b32 v80, 16, v34
    v_and_b32 v81, 0xffff0000, v34
    v_pk_fma_f32 v[80:81], v[80:81], v[72:73], v[74:75] op_sel_hi:[1,0,0]
    v_cvt_pk_bf16_f32 v34, v80, v81
    v_lshlrev_b32 v82, 16, v35
    v_and_b32 v83, 0xffff0000, v35
    v_pk_fma_f32 v[82:83], v[82:83], v[72:73], v[74:75] op_sel_hi:[1,0,0]
    v_cvt_pk_bf16_f32 v35, v82, v83
    v_lshlrev_b32 v76, 16, v36
    v_and_b32 v77, 0xffff0000, v36
    v_pk_fma_f32 v[76:77], v[76:77], v[72:73], v[74:75] op_sel_hi:[1,0,0]
    v_cvt_pk_bf16_f32 v36, v76, v77
    v_lshlrev_b32 v78, 16, v37
    v_and_b32 v79, 0xffff0000, v37
    v_pk_fma_f32 v[78:79], v[78:79], v[72:73], v[74:75] op_sel_hi:[1,0,0]
    v_cvt_pk_bf16_f32 v37, v78, v79
    v_lshlrev_b32 v80, 16, v38
    v_and_b32 v81, 0xffff0000, v38
    v_pk_fma_f32 v[80:81], v[80:81], v[72:73], v[74:75] op_sel_hi:[1,0,0]
    v_cvt_pk_bf16_f32 v38, v80, v81
    v_lshlrev_b32 v82, 16, v39
    v_and_b32 v83, 0xffff0000, v39
    v_pk_fma_f32 v[82:83], v[82:83], v[72:73], v[74:75] op_sel_hi:[1,0,0]
    v_cvt_pk_bf16_f32 v39, v82, v83
    v_lshlrev_b32 v76, 16, v40
    v_and_b32 v77, 0xffff0000, v40
    v_pk_fma_f32 v[76:77], v[76:77], v[72:73], v[74:75] op_sel_hi:[1,0,0]
    v_cvt_pk_bf16_f32 v40, v76, v77
    v_lshlrev_b32 v78, 16, v41
    v_and_b32 v79, 0xffff0000, v41
    v_pk_fma_f32 v[78:79], v[78:79], v[72:73], v[74:75] op_sel_hi:[1,0,0]
    v_cvt_pk_bf16_f32 v41, v78, v79
    v_lshlrev_b32 v80, 16, v42
    v_and_b32 v81, 0xffff0000, v42
    v_pk_fma_f32 v[80:81], v[80:81], v[72:73], v[74:75] op_sel_hi:[1,0,0]
    v_cvt_pk_bf16_f32 v42, v80, v81
    v_lshlrev_b32 v82, 16, v43
    v_and_b32 v83, 0xffff0000, v43
    v_pk_fma_f32 v[82:83], v[82:83], v[72:73], v[74:75] op_sel_hi:[1,0,0]
    v_cvt_pk_bf16_f32 v43, v82, v83
    s_mul_i32 s47, s89, 7
    s_add_u32 s44, s47, 0
    s_lshr_b32 s44, s44, 1
    s_cmp_lg_u32 s44, s85
    s_cbranch_scc1 L_k3sk_84
    s_add_u32 s44, s42, 0
    buffer_store_dwordx4 v[16:19], v2, s[16:19], s44 offen
    s_nop 1
L_k3sk_84:
    s_add_u32 s44, s47, 1
    s_lshr_b32 s44, s44, 1
    s_cmp_lg_u32 s44, s85
    s_cbranch_scc1 L_k3sk_85
    s_add_u32 s44, s42, 1024
    buffer_store_dwordx4 v[20:23], v2, s[16:19], s44 offen
    s_nop 1
L_k3sk_85:
    s_add_u32 s44, s47, 2
    s_lshr_b32 s44, s44, 1
    s_cmp_lg_u32 s44, s85
    s_cbranch_scc1 L_k3sk_86
    s_add_u32 s44, s42, 2048
    buffer_store_dwordx4 v[24:27], v2, s[16:19], s44 offen
    s_nop 1
L_k3sk_86:
    s_add_u32 s44, s47, 3
    s_lshr_b32 s44, s44, 1
    s_cmp_lg_u32 s44, s85
    s_cbranch_scc1 L_k3sk_87
    s_add_u32 s44, s42, 3072
    buffer_store_dwordx4 v[28:31], v2, s[16:19], s44 offen
    s_nop 1
L_k3sk_87:
    s_add_u32 s44, s47, 4
    s_lshr_b32 s44, s44, 1
    s_cmp_lg_u32 s44, s85
    s_cbranch_scc1 L_k3sk_88
    s_add_u32 s44, s42, 4096
    buffer_store_dwordx4 v[32:35], v2, s[16:19], s44 offen
    s_nop 1
L_k3sk_88:
    s_add_u32 s44, s47, 5
    s_lshr_b32 s44, s44, 1
    s_cmp_lg_u32 s44, s85
    s_cbranch_scc1 L_k3sk_89
    s_add_u32 s44, s42, 5120
    buffer_store_dwordx4 v[36:39], v2, s[16:19], s44 offen
    s_nop 1
L_k3sk_89:
    s_add_u32 s44, s47, 6
    s_lshr_b32 s44, s44, 1
    s_cmp_lg_u32 s44, s85
    s_cbranch_scc1 L_k3sk_90
    s_add_u32 s44, s42, 6144
    buffer_store_dwordx4 v[40:43], v2, s[16:19], s44 offen
    s_nop 1
L_k3sk_90:
    v_mov_b32 v8, 0
    v_mov_b32 v9, 0
    v_mov_b32 v10, 0
    v_mov_b32 v11, 0
    v_dot2_f32_bf16 v8, v16, s60, v8
    v_dot2_f32_bf16 v9, v16, v16, v9
    v_dot2_f32_bf16 v10, v17, s60, v10
    v_dot2_f32_bf16 v11, v17, v17, v11
    v_dot2_f32_bf16 v8, v18, s60, v8
    v_dot2_f32_bf16 v9, v18, v18, v9
    v_dot2_f32_bf16 v10, v19, s60, v10
    v_dot2_f32_bf16 v11, v19, v19, v11
    v_dot2_f32_bf16 v8, v20, s60, v8
    v_dot2_f32_bf16 v9, v20, v20, v9
    v_dot2_f32_bf16 v10, v21, s60, v10
    v_dot2_f32_bf16 v11, v21, v21, v11
    v_dot2_f32_bf16 v8, v22, s60, v8
    v_dot2_f32_bf16 v9, v22, v22, v9
    v_dot2_f32_bf16 v10, v23, s60, v10
    v_dot2_f32_bf16 v11, v23, v23, v11
    v_dot2_f32_bf16 v8, v24, s60, v8
    v_dot2_f32_bf16 v9, v24, v24, v9
    v_dot2_f32_bf16 v10, v25, s60, v10
    v_dot2_f32_bf16 v11, v25, v25, v11
    v_dot2_f32_bf16 v8, v26, s60, v8
    v_dot2_f32_bf16 v9, v26, v26, v9
    v_dot2_f32_bf16 v10, v27, s60, v10
    v_dot2_f32_bf16 v11, v27, v27, v11
    v_dot2_f32_bf16 v8, v28, s60, v8
    v_dot2_f32_bf16 v9, v28, v28, v9
    v_dot2_f32_bf16 v10, v29, s60, v10
    v_dot2_f32_bf16 v11, v29, v29, v11
    v_dot2_f32_bf16 v8, v30, s60, v8
    v_dot2_f32_bf16 v9, v30, v30, v9
    v_dot2_f32_bf16 v10, v31, s60, v10
    v_dot2_f32_bf16 v11, v31, v31, v11
    v_dot2_f32_bf16 v8, v32, s60, v8
    v_dot2_f32_bf16 v9, v32, v32, v9
    v_dot2_f32_bf16 v10, v33, s60, v10
    v_dot2_f32_bf16 v11, v33, v33, v11
    v_dot2_f32_bf16 v8, v34, s60, v8
    v_dot2_f32_bf16 v9, v34, v34, v9
    v_dot2_f32_bf16 v10, v35, s60, v10
    v_dot2_f32_bf16 v11, v35, v35, v11
    v_dot2_f32_bf16 v8, v36, s60, v8
    v_dot2_f32_bf16 v9, v36, v36, v9
    v_dot2_f32_bf16 v10, v37, s60, v10
    v_dot2_f32_bf16 v11, v37, v37, v11
    v_dot2_f32_bf16 v8, v38, s60, v8
    v_dot2_f32_bf16 v9, v38, v38, v9
    v_dot2_f32_bf16 v10, v39, s60, v10
    v_dot2_f32_bf16 v11, v39, v39, v11
    v_dot2_f32_bf16 v8, v40, s60, v8
    v_dot2_f32_bf16 v9, v40, v40, v9
    v_dot2_f32_bf16 v10, v41, s60, v10
    v_dot2_f32_bf16 v11, v41, v41, v11
    v_dot2_f32_bf16 v8, v42, s60, v8
    v_dot2_f32_bf16 v9, v42, v42, v9
    v_dot2_f32_bf16 v10, v43, s60, v10
    v_dot2_f32_bf16 v11, v43, v43, v11
    s_nop 1
    v_add_f32 v8, v8, v10
    v_add_f32 v9, v9, v11
    v_mov_b32 v10, v8
    s_nop 1
    v_permlane32_swap_b32 v8, v10
    v_add_f32 v8, v8, v10
    v_mov_b32 v10, v8
    s_nop 1
    v_permlane16_swap_b32 v8, v10
    v_add_f32 v8, v8, v10
    v_mov_b32 v11, v9
    s_nop 1
    v_permlane32_swap_b32 v9, v11
    v_add_f32 v9, v9, v11
    v_mov_b32 v11, v9
    s_nop 1
    v_permlane16_swap_b32 v9, v11
    v_add_f32 v9, v9, v11
    s_lshl_b32 s44, s89, 2
    s_add_u32 s44, s44, s88
    s_lshl_b32 s45, s44, 7
    s_xor_b32 s44, s44, 4
    s_lshl_b32 s44, s44, 7
    s_add_u32 s45, s45, 145408
    s_add_u32 s44, s44, 145408
    v_lshl_add_u32 v6, v3, 3, s45
    v_lshl_add_u32 v7, v3, 3, s44
    ds_write_b64 v6, v[8:9] offset:1024
    s_waitcnt lgkmcnt(0)
    s_barrier
    ds_read_b64 v[6:7], v7 offset:1024
    s_waitcnt lgkmcnt(0)
    v_add_f32 v8, v8, v6
    v_add_f32 v9, v9, v7
    v_mul_f32 v8, 0x3b124925, v8
    v_mul_f32 v9, 0x3b124925, v9
    v_fma_f32 v9, -v8, v8, v9
    v_max_f32 v9, 0, v9
    v_cvt_pk_bf16_f32 v8, v8, v8
    v_and_b32 v8, 0xffff0000, v8
    v_cvt_pk_bf16_f32 v9, v9, v9
    v_and_b32 v9, 0xffff0000, v9
    v_add_f32 v9, 0x3727c5ac, v9
    v_cvt_pk_bf16_f32 v9, v9, v9
    v_and_b32 v9, 0xffff0000, v9
    v_sqrt_f32 v9, v9
    s_nop 0
    v_cvt_pk_bf16_f32 v9, v9, v9
    v_and_b32 v9, 0xffff0000, v9
    v_rcp_f32 v72, v9
    s_nop 0
    v_mul_f32 v74, v8, v72
    v_sub_f32 v74, 0, v74
    v_lshlrev_b32 v76, 16, v16
    v_and_b32 v77, 0xffff0000, v16
    v_pk_fma_f32 v[76:77], v[76:77], v[72:73], v[74:75] op_sel_hi:[1,0,0]
    v_cvt_pk_bf16_f32 v16, v76, v77
    v_lshlrev_b32 v78, 16, v17
    v_and_b32 v79, 0xffff0000, v17
    v_pk_fma_f32 v[78:79], v[78:79], v[72:73], v[74:75] op_sel_hi:[1,0,0]
    v_cvt_pk_bf16_f32 v17, v78, v79
    v_lshlrev_b32 v80, 16, v18
    v_and_b32 v81, 0xffff0000, v18
    v_pk_fma_f32 v[80:81], v[80:81], v[72:73], v[74:75] op_sel_hi:[1,0,0]
    v_cvt_pk_bf16_f32 v18, v80, v81
    v_lshlrev_b32 v82, 16, v19
    v_and_b32 v83, 0xffff0000, v19
    v_pk_fma_f32 v[82:83], v[82:83], v[72:73], v[74:75] op_sel_hi:[1,0,0]
    v_cvt_pk_bf16_f32 v19, v82, v83
    v_lshlrev_b32 v76, 16, v20
    v_and_b32 v77, 0xffff0000, v20
    v_pk_fma_f32 v[76:77], v[76:77], v[72:73], v[74:75] op_sel_hi:[1,0,0]
    v_cvt_pk_bf16_f32 v20, v76, v77
    v_lshlrev_b32 v78, 16, v21
    v_and_b32 v79, 0xffff0000, v21
    v_pk_fma_f32 v[78:79], v[78:79], v[72:73], v[74:75] op_sel_hi:[1,0,0]
    v_cvt_pk_bf16_f32 v21, v78, v79
    v_lshlrev_b32 v80, 16, v22
    v_and_b32 v81, 0xffff0000, v22
    v_pk_fma_f32 v[80:81], v[80:81], v[72:73], v[74:75] op_sel_hi:[1,0,0]
    v_cvt_pk_bf16_f32 v22, v80, v81
    v_lshlrev_b32 v82, 16, v23
    v_and_b32 v83, 0xffff0000, v23
    v_pk_fma_f32 v[82:83], v[82:83], v[72:73], v[74:75] op_sel_hi:[1,0,0]
    v_cvt_pk_bf16_f32 v23, v82, v83
    v_lshlrev_b32 v76, 16, v24
    v_and_b32 v77, 0xffff0000, v24
    v_pk_fma_f32 v[76:77], v[76:77], v[72:73], v[74:75] op_sel_hi:[1,0,0]
    v_cvt_pk_bf16_f32 v24, v76, v77
    v_lshlrev_b32 v78, 16, v25
    v_and_b32 v79, 0xffff0000, v25
    v_pk_fma_f32 v[78:79], v[78:79], v[72:73], v[74:75] op_sel_hi:[1,0,0]
    v_cvt_pk_bf16_f32 v25, v78, v79
    v_lshlrev_b32 v80, 16, v26
    v_and_b32 v81, 0xffff0000, v26
    v_pk_fma_f32 v[80:81], v[80:81], v[72:73], v[74:75] op_sel_hi:[1,0,0]
    v_cvt_pk_bf16_f32 v26, v80, v81
    v_lshlrev_b32 v82, 16, v27
    v_and_b32 v83, 0xffff0000, v27
    v_pk_fma_f32 v[82:83], v[82:83], v[72:73], v[74:75] op_sel_hi:[1,0,0]
    v_cvt_pk_bf16_f32 v27, v82, v83
    v_lshlrev_b32 v76, 16, v28
    v_and_b32 v77, 0xffff0000, v28
    v_pk_fma_f32 v[76:77], v[76:77], v[72:73], v[74:75] op_sel_hi:[1,0,0]
    v_cvt_pk_bf16_f32 v28, v76, v77
    v_lshlrev_b32 v78, 16, v29
    v_and_b32 v79, 0xffff0000, v29
    v_pk_fma_f32 v[78:79], v[78:79], v[72:73], v[74:75] op_sel_hi:[1,0,0]
    v_cvt_pk_bf16_f32 v29, v78, v79
    v_lshlrev_b32 v80, 16, v30
    v_and_b32 v81, 0xffff0000, v30
    v_pk_fma_f32 v[80:81], v[80:81], v[72:73], v[74:75] op_sel_hi:[1,0,0]
    v_cvt_pk_bf16_f32 v30, v80, v81
    v_lshlrev_b32 v82, 16, v31
    v_and_b32 v83, 0xffff0000, v31
    v_pk_fma_f32 v[82:83], v[82:83], v[72:73], v[74:75] op_sel_hi:[1,0,0]
    v_cvt_pk_bf16_f32 v31, v82, v83
    v_lshlrev_b32 v76, 16, v32
    v_and_b32 v77, 0xffff0000, v32
    v_pk_fma_f32 v[76:77], v[76:77], v[72:73], v[74:75] op_sel_hi:[1,0,0]
    v_cvt_pk_bf16_f32 v32, v76, v77
    v_lshlrev_b32 v78, 16, v33
    v_and_b32 v79, 0xffff0000, v33
    v_pk_fma_f32 v[78:79], v[78:79], v[72:73], v[74:75] op_sel_hi:[1,0,0]
    v_cvt_pk_bf16_f32 v33, v78, v79
    v_lshlrev_b32 v80, 16, v34
    v_and_b32 v81, 0xffff0000, v34
    v_pk_fma_f32 v[80:81], v[80:81], v[72:73], v[74:75] op_sel_hi:[1,0,0]
    v_cvt_pk_bf16_f32 v34, v80, v81
    v_lshlrev_b32 v82, 16, v35
    v_and_b32 v83, 0xffff0000, v35
    v_pk_fma_f32 v[82:83], v[82:83], v[72:73], v[74:75] op_sel_hi:[1,0,0]
    v_cvt_pk_bf16_f32 v35, v82, v83
    v_lshlrev_b32 v76, 16, v36
    v_and_b32 v77, 0xffff0000, v36
    v_pk_fma_f32 v[76:77], v[76:77], v[72:73], v[74:75] op_sel_hi:[1,0,0]
    v_cvt_pk_bf16_f32 v36, v76, v77
    v_lshlrev_b32 v78, 16, v37
    v_and_b32 v79, 0xffff0000, v37
    v_pk_fma_f32 v[78:79], v[78:79], v[72:73], v[74:75] op_sel_hi:[1,0,0]
    v_cvt_pk_bf16_f32 v37, v78, v79
    v_lshlrev_b32 v80, 16, v38
    v_and_b32 v81, 0xffff0000, v38
    v_pk_fma_f32 v[80:81], v[80:81], v[72:73], v[74:75] op_sel_hi:[1,0,0]
    v_cvt_pk_bf16_f32 v38, v80, v81
    v_lshlrev_b32 v82, 16, v39
    v_and_b32 v83, 0xffff0000, v39
    v_pk_fma_f32 v[82:83], v[82:83], v[72:73], v[74:75] op_sel_hi:[1,0,0]
    v_cvt_pk_bf16_f32 v39, v82, v83
    v_lshlrev_b32 v76, 16, v40
    v_and_b32 v77, 0xffff0000, v40
    v_pk_fma_f32 v[76:77], v[76:77], v[72:73], v[74:75] op_sel_hi:[1,0,0]
    v_cvt_pk_bf16_f32 v40, v76, v77
    v_lshlrev_b32 v78, 16, v41
    v_and_b32 v79, 0xffff0000, v41
    v_pk_fma_f32 v[78:79], v[78:79], v[72:73], v[74:75] op_sel_hi:[1,0,0]
    v_cvt_pk_bf16_f32 v41, v78, v79
    v_lshlrev_b32 v80, 16, v42
    v_and_b32 v81, 0xffff0000, v42
    v_pk_fma_f32 v[80:81], v[80:81], v[72:73], v[74:75] op_sel_hi:[1,0,0]
    v_cvt_pk_bf16_f32 v42, v80, v81
    v_lshlrev_b32 v82, 16, v43
    v_and_b32 v83, 0xffff0000, v43
    v_pk_fma_f32 v[82:83], v[82:83], v[72:73], v[74:75] op_sel_hi:[1,0,0]
    v_cvt_pk_bf16_f32 v43, v82, v83
    s_mul_i32 s44, s85, 57344
    s_add_u32 s12, s94, s44
    s_addc_u32 s13, s95, 0
    s_add_u32 s12, s12, 2211840
    s_addc_u32 s13, s13, 0
    s_mov_b32 s14, 57344
    s_mov_b32 s15, 0x00020000
    s_mul_i32 s46, s3, 7
    s_lshl_b32 s46, s46, 10
    s_add_u32 s47, s46, 0
    s_mul_i32 s44, s89, 7168
    s_add_u32 s44, s44, 57344
    v_add_u32 v8, s44, v2
    ds_read_b128 v[80:83], v8 offset:0
    ds_read_b128 v[84:87], v8 offset:14336
    ds_read_b128 v[88:91], v8 offset:28672
    ds_read_b128 v[92:95], v8 offset:43008
    ds_read_b128 v[96:99], v8 offset:1024
    ds_read_b128 v[100:103], v8 offset:15360
    ds_read_b128 v[104:107], v8 offset:29696
    ds_read_b128 v[108:111], v8 offset:44032
    s_waitcnt lgkmcnt(4)
    v_mfma_f32_16x16x32_bf16 v[64:67], v[80:83], v[16:19], 0
    v_mfma_f32_16x16x32_bf16 v[68:71], v[84:87], v[16:19], 0
    v_mfma_f32_16x16x32_bf16 v[72:75], v[88:91], v[16:19], 0
    v_mfma_f32_16x16x32_bf16 v[76:79], v[92:95], v[16:19], 0
    s_mov_b32 m0, s47
    s_nop 0
    buffer_load_dwordx4 v2, s[12:15], s46 offen lds
    s_add_u32 s46, s46, 1024
    s_add_u32 s47, s47, 1024
    ds_read_b128 v[80:83], v8 offset:2048
    ds_read_b128 v[84:87], v8 offset:16384
    ds_read_b128 v[88:91], v8 offset:30720
    ds_read_b128 v[92:95], v8 offset:45056
    s_waitcnt lgkmcnt(4)
    v_mfma_f32_16x16x32_bf16 v[64:67], v[96:99], v[20:23], v[64:67]
    v_mfma_f32_16x16x32_bf16 v[68:71], v[100:103], v[20:23], v[68:71]
    v_mfma_f32_16x16x32_bf16 v[72:75], v[104:107], v[20:23], v[72:75]
    v_mfma_f32_16x16x32_bf16 v[76:79], v[108:111], v[20:23], v[76:79]
    s_mov_b32 m0, s47
    s_nop 0
    buffer_load_dwordx4 v2, s[12:15], s46 offen lds
    s_add_u32 s46, s46, 1024
    s_add_u32 s47, s47, 1024
    ds_read_b128 v[96:99], v8 offset:3072
    ds_read_b128 v[100:103], v8 offset:17408
    ds_read_b128 v[104:107], v8 offset:31744
    ds_read_b128 v[108:111], v8 offset:46080
    s_waitcnt lgkmcnt(4)
    v_mfma_f32_16x16x32_bf16 v[64:67], v[80:83], v[24:27], v[64:67]
    v_mfma_f32_16x16x32_bf16 v[68:71], v[84:87], v[24:27], v[68:71]
    v_mfma_f32_16x16x32_bf16 v[72:75], v[88:91], v[24:27], v[72:75]
    v_mfma_f32_16x16x32_bf16 v[76:79], v[92:95], v[24:27], v[76:79]
    s_mov_b32 m0, s47
    s_nop 0
    buffer_load_dwordx4 v2, s[12:15], s46 offen lds
    s_add_u32 s46, s46, 1024
    s_add_u32 s47, s47, 1024
    ds_read_b128 v[80:83], v8 offset:4096
    ds_read_b128 v[84:87], v8 offset:18432
    ds_read_b128 v[88:91], v8 offset:32768
    ds_read_b128 v[92:95], v8 offset:47104
    s_waitcnt lgkmcnt(4)
    v_mfma_f32_16x16x32_bf16 v[64:67], v[96:99], v[28:31], v[64:67]
    v_mfma_f32_16x16x32_bf16 v[68:71], v[100:103], v[28:31], v[68:71]
    v_mfma_f32_16x16x32_bf16 v[72:75], v[104:107], v[28:31], v[72:75]
    v_mfma_f32_16x16x32_bf16 v[76:79], v[108:111], v[28:31], v[76:79]
    s_mov_b32 m0, s47
    s_nop 0
    buffer_load_dwordx4 v2, s[12:15], s46 offen lds
    s_add_u32 s46, s46, 1024
    s_add_u32 s47, s47, 1024
    ds_read_b128 v[96:99], v8 offset:5120
    ds_read_b128 v[100:103], v8 offset:19456
    ds_read_b128 v[104:107], v8 offset:33792
    ds_read_b128 v[108:111], v8 offset:48128
    s_waitcnt lgkmcnt(4)
    v_mfma_f32_16x16x32_bf16 v[64:67], v[80:83], v[32:35], v[64:67]
    v_mfma_f32_16x16x32_bf16 v[68:71], v[84:87], v[32:35], v[68:71]
    v_mfma_f32_16x16x32_bf16 v[72:75], v[88:91], v[32:35], v[72:75]
    v_mfma_f32_16x16x32_bf16 v[76:79], v[92:95], v[32:35], v[76:79]
    s_mov_b32 m0, s47
    s_nop 0
    buffer_load_dwordx4 v2, s[12:15], s46 offen lds
    s_add_u32 s46, s46, 1024
    s_add_u32 s47, s47, 1024
    ds_read_b128 v[80:83], v8 offset:6144
    ds_read_b128 v[84:87], v8 offset:20480
    ds_read_b128 v[88:91], v8 offset:34816
    ds_read_b128 v[92:95], v8 offset:49152
    s_waitcnt lgkmcnt(4)
    v_mfma_f32_16x16x32_bf16 v[64:67], v[96:99], v[36:39], v[64:67]
    v_mfma_f32_16x16x32_bf16 v[68:71], v[100:103], v[36:39], v[68:71]
    v_mfma_f32_16x16x32_bf16 v[72:75], v[104:107], v[36:39], v[72:75]
    v_mfma_f32_16x16x32_bf16 v[76:79], v[108:111], v[36:39], v[76:79]
    s_mov_b32 m0, s47
    s_nop 0
    buffer_load_dwordx4 v2, s[12:15], s46 offen lds
    s_add_u32 s46, s46, 1024
    s_add_u32 s47, s47, 1024
    s_waitcnt lgkmcnt(0)
    v_mfma_f32_16x16x32_bf16 v[64:67], v[80:83], v[40:43], v[64:67]
    v_mfma_f32_16x16x32_bf16 v[68:71], v[84:87], v[40:43], v[68:71]
    v_mfma_f32_16x16x32_bf16 v[72:75], v[88:91], v[40:43], v[72:75]
    v_mfma_f32_16x16x32_bf16 v[76:79], v[92:95], v[40:43], v[76:79]
    s_mov_b32 m0, s47
    s_nop 0
    buffer_load_dwordx4 v2, s[12:15], s46 offen lds
    s_add_u32 s46, s46, 1024
    s_add_u32 s47, s47, 1024
    s_lshl_b32 s44, s88, 1
    s_add_u32 s44, s44, s89
    s_lshl_b32 s45, s44, 11
    s_xor_b32 s44, s44, 1
    s_lshl_b32 s44, s44, 11
    s_add_u32 s45, s45, 147456
    s_add_u32 s44, s44, 147456
    v_add_u32 v6, s45, v2
    v_add_u32 v7, s44, v2
    s_cmp_eq_u32 s89, 0
    s_nop 0
    s_cbranch_scc1 L_hx_lo_91
    ds_write_b128 v6, v[64:67]
    ds_write_b128 v6, v[68:71] offset:1024
    v_mov_b32 v16, v72
    v_mov_b32 v17, v73
    v_mov_b32 v18, v74
    v_mov_b32 v19, v75
    v_mov_b32 v20, v76
    v_mov_b32 v21, v77
    v_mov_b32 v22, v78
    v_mov_b32 v23, v79
    s_nop 1
    s_branch L_hx_j1_92
L_hx_lo_91:
    ds_write_b128 v6, v[72:75]
    ds_write_b128 v6, v[76:79] offset:1024
    v_mov_b32 v16, v64
    v_mov_b32 v17, v65
    v_mov_b32 v18, v66
    v_mov_b32 v19, v67
    v_mov_b32 v20, v68
    v_mov_b32 v21, v69
    v_mov_b32 v22, v70
    v_mov_b32 v23, v71
    s_nop 1
L_hx_j1_92:
    s_waitcnt lgkmcnt(0)
    s_barrier
    ds_read_b128 v[64:67], v7
    ds_read_b128 v[68:71], v7 offset:1024
    s_waitcnt lgkmcnt(0)
    v_add_f32 v16, v16, v64
    v_add_f32 v17, v17, v65
    v_add_f32 v18, v18, v66
    v_add_f32 v19, v19, v67
    v_add_f32 v20, v20, v68
    v_add_f32 v21, v21, v69
    v_add_f32 v22, v22, v70
    v_add_f32 v23, v23, v71
    v_cvt_pk_bf16_f32 v17, v16, v17
    v_lshlrev_b32 v16, 16, v17
    v_and_b32 v17, 0xffff0000, v17
    v_cvt_pk_bf16_f32 v19, v18, v19
    v_lshlrev_b32 v18, 16, v19
    v_and_b32 v19, 0xffff0000, v19
    v_cvt_pk_bf16_f32 v21, v20, v21
    v_lshlrev_b32 v20, 16, v21
    v_and_b32 v21, 0xffff0000, v21
    v_cvt_pk_bf16_f32 v23, v22, v23
    v_lshlrev_b32 v22, 16, v23
    v_and_b32 v23, 0xffff0000, v23
    v_mul_f32 v32, v16, v16
    v_mul_f32 v33, v17, v17
    v_mul_f32 v34, v18, v18
    v_mul_f32 v35, v19, v19
    v_fma_f32 v32, v32, s90, 1.0
    v_fma_f32 v33, v33, s90, 1.0
    v_fma_f32 v34, v34, s90, 1.0
    v_fma_f32 v35, v35, s90, 1.0
    v_mul_f32 v32, v32, v16
    v_mul_f32 v33, v33, v17
    v_mul_f32 v34, v34, v18
    v_mul_f32 v35, v35, v19
    v_mul_f32 v32, s91, v32
    v_mul_f32 v33, s91, v33
    v_mul_f32 v34, s91, v34
    v_mul_f32 v35, s91, v35
    v_exp_f32 v32, v32
    v_exp_f32 v33, v33
    v_exp_f32 v34, v34
    v_exp_f32 v35, v35
    v_add_f32 v32, 1.0, v32
    v_add_f32 v33, 1.0, v33
    v_add_f32 v34, 1.0, v34
    v_add_f32 v35, 1.0, v35
    v_rcp_f32 v32, v32
    v_rcp_f32 v33, v33
    v_rcp_f32 v34, v34
    v_rcp_f32 v35, v35
    v_mul_f32 v16, v16, v32
    v_mul_f32 v17, v17, v33
    v_mul_f32 v18, v18, v34
    v_mul_f32 v19, v19, v35
    v_mul_f32 v32, v20, v20
    v_mul_f32 v33, v21, v21
    v_mul_f32 v34, v22, v22
    v_mul_f32 v35, v23, v23
    v_fma_f32 v32, v32, s90, 1.0
    v_fma_f32 v33, v33, s90, 1.0
    v_fma_f32 v34, v34, s90, 1.0
    v_fma_f32 v35, v35, s90, 1.0
    v_mul_f32 v32, v32, v20
    v_mul_f32 v33, v33, v21
    v_mul_f32 v34, v34, v22
    v_mul_f32 v35, v35, v23
    v_mul_f32 v32, s91, v32
    v_mul_f32 v33, s91, v33
    v_mul_f32 v34, s91, v34
    v_mul_f32 v35, s91, v35
    v_exp_f32 v32, v32
    v_exp_f32 v33, v33
    v_exp_f32 v34, v34
    v_exp_f32 v35, v35
    v_add_f32 v32, 1.0, v32
    v_add_f32 v33, 1.0, v33
    v_add_f32 v34, 1.0, v34
    v_add_f32 v35, 1.0, v35
    v_rcp_f32 v32, v32
    v_rcp_f32 v33, v33
    v_rcp_f32 v34, v34
    v_rcp_f32 v35, v35
    v_mul_f32 v20, v20, v32
    v_mul_f32 v21, v21, v33
    v_mul_f32 v22, v22, v34
    v_mul_f32 v23, v23, v35
    v_cvt_pk_bf16_f32 v24, v16, v17
    v_cvt_pk_bf16_f32 v25, v18, v19
    v_cvt_pk_bf16_f32 v26, v20, v21
    v_cvt_pk_bf16_f32 v27, v22, v23
    s_lshl_b32 s41, s84, 2
    s_add_u32 s41, s41, s88
    s_mul_i32 s41, s41, 14
    s_lshl_b32 s45, s85, 1
    s_add_u32 s41, s41, s45
    s_add_u32 s41, s41, s89
    s_lshl_b32 s41, s41, 10
    s_and_b32 s42, s84, 3
    s_cmp_eq_u32 s42, s88
    s_cselect_b32 s43, 1, 0
    s_add_u32 s44, s42, 1
    s_and_b32 s44, s44, 2
    s_cmp_eq_u32 s44, 0
    s_cselect_b32 s42, 1, 0
    s_and_b32 s43, s43, s42
    s_cmp_lg_u32 s43, 0
    s_cbranch_scc1 L_k3bs_93
    buffer_store_dwordx4 v[24:27], v2, s[20:23], s41 offen
    s_nop 1
    s_branch L_k3bj_94
L_k3bs_93:
    buffer_store_dwordx4 v[24:27], v2, s[20:23], s41 offen sc1
    s_nop 1
L_k3bj_94:
    s_lshl_b32 s40, s84, 3
    s_add_u32 s40, s40, s85
    s_add_u32 s40, s40, 768
    s_waitcnt vmcnt(0)
    s_barrier
    s_cmp_lg_u32 s3, 0
    s_cbranch_scc1 L_sig_95
    s_add_u32 s28, s94, 7921664
    s_addc_u32 s29, s95, 0
    s_mov_b32 s30, 16384
    s_mov_b32 s31, 0x00020000
    s_lshl_b32 s48, s40, 2
    v_mov_b32 v6, 1
    v_mov_b32 v7, s48
    s_mov_b64 exec, 1
    s_cmp_lg_u32 s80, 0
    s_cbranch_scc1 L_sigfb_96
    buffer_store_dword v6, v7, s[28:31], 0 offen
    s_nop 1
    s_branch L_sigj_97
L_sigfb_96:
    buffer_wbl2 sc1
    s_waitcnt vmcnt(0)
    buffer_store_dword v6, v7, s[28:31], 0 offen sc1
    s_nop 1
L_sigj_97:
    s_cmp_eq_u32 s42, 0
    s_cbranch_scc1 L_signr_98
    v_add_u32 v7, 4096, v7
    buffer_store_dword v6, v7, s[28:31], 0 offen sc1
    s_nop 1
L_signr_98:
    s_mov_b64 exec, -1
L_sig_95:
    s_lshl_b32 s40, s84, 3
    s_add_u32 s40, s40, 760
    s_cmp_lg_u32 s3, 0
    s_cbranch_scc1 L_wsk_99
    s_add_u32 s28, s94, 7921664
    s_addc_u32 s29, s95, 0
    s_mov_b32 s30, 16384
    s_mov_b32 s31, 0x00020000
    s_mov_b32 s50, 0
    v_add_u32 v6, s40, v1
    v_and_b32 v7, 7, v1
    v_cmp_eq_u32 s[48:49], 7, v7
    v_cmp_le_u32 vcc, 24, v1
    s_nop 0
    s_or_b64 s[48:49], s[48:49], vcc
    v_lshrrev_b32 v7, 3, v1
    v_add_u32 v7, s84, v7
    v_cmp_eq_u32 vcc, 0, v7
    s_nop 0
    s_or_b64 s[48:49], s[48:49], vcc
    v_cmp_lt_u32 vcc, 32, v7
    s_nop 0
    s_or_b64 s[48:49], s[48:49], vcc
    s_and_b32 s51, s84, 3
    s_cmp_eq_u32 s51, 0
    s_cselect_b32 s45, 1024, 0
    s_cmp_eq_u32 s51, 3
    s_cselect_b32 s51, 1024, 0
    v_cmp_gt_u32 vcc, 8, v1
    v_mov_b32 v7, s45
    s_nop 0
    v_cndmask_b32 v7, 0, v7, vcc
    v_add_u32 v6, v6, v7
    v_cmp_le_u32 vcc, 16, v1
    v_mov_b32 v7, s51
    s_nop 0
    v_cndmask_b32 v7, 0, v7, vcc
    v_add_u32 v6, v6, v7
    v_lshlrev_b32 v6, 2, v6
    v_cndmask_b32 v6, v6, 0, s[48:49]
    s_nop 1
L_wlp_100:
    buffer_load_dword v8, v6, s[28:31], 0 offen sc1
    s_waitcnt vmcnt(0)
    v_cmp_ne_u32 vcc, 0, v8
    s_nop 0
    s_or_b64 vcc, vcc, s[48:49]
    s_cmp_eq_u64 vcc, -1
    s_nop 1
    s_cbranch_scc1 L_wdn_101
    s_sleep 1
    s_add_u32 s50, s50, 1
    s_cmp_lt_u32 s50, 65536
    s_cbranch_scc1 L_wlp_100
L_wdn_101:
    s_cmp_eq_u32 s80, 0
    s_cbranch_scc1 L_wsk_99
    buffer_inv sc1
    s_waitcnt vmcnt(0)
L_wsk_99:
    s_barrier
    s_add_u32 s8, s94, 18948096
    s_addc_u32 s9, s95, 0
    s_mov_b32 s10, 1835008
    s_mov_b32 s11, 0x00020000
    s_add_u32 s16, s94, 15278080
    s_addc_u32 s17, s95, 0
    s_mov_b32 s18, 1835008
    s_mov_b32 s19, 0x00020000
    s_add_u32 s20, s94, 22618112
    s_addc_u32 s21, s95, 0
    s_mov_b32 s22, 1835008
    s_mov_b32 s23, 0x00020000
    s_lshl_b32 s44, s84, 6
    s_lshl_b32 s45, s88, 4
    s_add_u32 s44, s44, s45
    v_add_u32 v12, s44, v3
    s_mov_b32 s45, 14336
    v_add_u32 v10, -1, v12
    v_ashrrev_i32 v9, 4, v10
    v_mul_lo_u32 v13, v9, s45
    v_and_b32 v10, 15, v10
    v_lshl_add_u32 v13, v10, 4, v13
    v_lshl_add_u32 v13, v4, 8, v13
    v_add_u32 v10, 1, v12
    v_ashrrev_i32 v9, 4, v10
    v_mul_lo_u32 v14, v9, s45
    v_and_b32 v10, 15, v10
    v_lshl_add_u32 v14, v10, 4, v14
    v_lshl_add_u32 v14, v4, 8, v14
    v_add_u32 v10, -2, v12
    v_ashrrev_i32 v9, 4, v10
    v_mul_lo_u32 v15, v9, s45
    v_and_b32 v10, 15, v10
    v_lshl_add_u32 v15, v10, 4, v15
    v_lshl_add_u32 v15, v4, 8, v15
    v_add_u32 v10, 2, v12
    v_ashrrev_i32 v9, 4, v10
    v_mul_lo_u32 v11, v9, s45
    v_and_b32 v10, 15, v10
    v_lshl_add_u32 v11, v10, 4, v11
    v_lshl_add_u32 v11, v4, 8, v11
    s_mul_i32 s44, s89, 7168
    s_add_u32 s45, s44, 4096
    s_cmp_eq_u32 s89, 1
    s_cbranch_scc1 L_k4hi_102
    v_cndmask_b32 v10, v14, v13, s[58:59]
    buffer_load_dwordx4 v[16:19], v13, s[8:11], s44 offen offset:0
    buffer_load_dwordx4 v[20:23], v13, s[8:11], s44 offen offset:1024
    buffer_load_dwordx4 v[24:27], v13, s[8:11], s44 offen offset:2048
    buffer_load_dwordx4 v[28:31], v10, s[8:11], s44 offen offset:3072
    buffer_load_dwordx4 v[32:35], v14, s[8:11], s45 offen offset:0
    buffer_load_dwordx4 v[36:39], v14, s[8:11], s45 offen offset:1024
    buffer_load_dwordx4 v[40:43], v14, s[8:11], s45 offen offset:2048
    s_branch L_k4jn_103
L_k4hi_102:
    v_cndmask_b32 v10, v11, v15, s[58:59]
    buffer_load_dwordx4 v[16:19], v15, s[8:11], s44 offen offset:0
    buffer_load_dwordx4 v[20:23], v15, s[8:11], s44 offen offset:1024
    buffer_load_dwordx4 v[24:27], v15, s[8:11], s44 offen offset:2048
    buffer_load_dwordx4 v[28:31], v10, s[8:11], s44 offen offset:3072
    buffer_load_dwordx4 v[32:35], v11, s[8:11], s45 offen offset:0
    buffer_load_dwordx4 v[36:39], v11, s[8:11], s45 offen offset:1024
    buffer_load_dwordx4 v[40:43], v11, s[8:11], s45 offen offset:2048
L_k4jn_103:
    s_lshl_b32 s41, s84, 2
    s_add_u32 s41, s41, s88
    s_mul_i32 s41, s41, 14
    s_lshl_b32 s45, s85, 1
    s_add_u32 s41, s41, s45
    s_add_u32 s41, s41, s89
    s_lshl_b32 s41, s41, 10
    buffer_load_dwordx4 v[60:63], v2, s[16:19], s41 offen
    s_waitcnt vmcnt(0)
    s_barrier
    s_mul_i32 s44, s83, 114688
    s_add_u32 s12, s94, s44
    s_addc_u32 s13, s95, 0
    s_add_u32 s12, s12, 2613248
    s_addc_u32 s13, s13, 0
    s_mov_b32 s14, 114688
    s_mov_b32 s15, 0x00020000
    s_mul_i32 s46, s3, 11
    s_min_u32 s46, s46, 73
    s_lshl_b32 s46, s46, 10
    s_add_u32 s47, s46, 57344
    s_mul_i32 s44, s89, 7168
    v_add_u32 v8, s44, v2
    ds_read_b128 v[80:83], v8 offset:0
    ds_read_b128 v[84:87], v8 offset:14336
    ds_read_b128 v[88:91], v8 offset:28672
    ds_read_b128 v[92:95], v8 offset:43008
    ds_read_b128 v[96:99], v8 offset:1024
    ds_read_b128 v[100:103], v8 offset:15360
    ds_read_b128 v[104:107], v8 offset:29696
    ds_read_b128 v[108:111], v8 offset:44032
    s_waitcnt lgkmcnt(4)
    v_mfma_f32_16x16x32_bf16 v[64:67], v[80:83], v[16:19], 0
    v_mfma_f32_16x16x32_bf16 v[68:71], v[84:87], v[16:19], 0
    v_mfma_f32_16x16x32_bf16 v[72:75], v[88:91], v[16:19], 0
    v_mfma_f32_16x16x32_bf16 v[76:79], v[92:95], v[16:19], 0
    s_mov_b32 m0, s47
    s_nop 0
    buffer_load_dwordx4 v2, s[12:15], s46 offen lds
    s_add_u32 s46, s46, 1024
    s_add_u32 s47, s47, 1024
    s_mov_b32 m0, s47
    s_nop 0
    buffer_load_dwordx4 v2, s[12:15], s46 offen lds
    s_add_u32 s46, s46, 1024
    s_add_u32 s47, s47, 1024
    ds_read_b128 v[80:83], v8 offset:2048
    ds_read_b128 v[84:87], v8 offset:16384
    ds_read_b128 v[88:91], v8 offset:30720
    ds_read_b128 v[92:95], v8 offset:45056
    s_waitcnt lgkmcnt(4)
    v_mfma_f32_16x16x32_bf16 v[64:67], v[96:99], v[20:23], v[64:67]
    v_mfma_f32_16x16x32_bf16 v[68:71], v[100:103], v[20:23], v[68:71]
    v_mfma_f32_16x16x32_bf16 v[72:75], v[104:107], v[20:23], v[72:75]
    v_mfma_f32_16x16x32_bf16 v[76:79], v[108:111], v[20:23], v[76:79]
    s_mov_b32 m0, s47
    s_nop 0
    buffer_load_dwordx4 v2, s[12:15], s46 offen lds
    s_add_u32 s46, s46, 1024
    s_add_u32 s47, s47, 1024
    s_mov_b32 m0, s47
    s_nop 0
    buffer_load_dwordx4 v2, s[12:15], s46 offen lds
    s_add_u32 s46, s46, 1024
    s_add_u32 s47, s47, 1024
    ds_read_b128 v[96:99], v8 offset:3072
    ds_read_b128 v[100:103], v8 offset:17408
    ds_read_b128 v[104:107], v8 offset:31744
    ds_read_b128 v[108:111], v8 offset:46080
    s_waitcnt lgkmcnt(4)
    v_mfma_f32_16x16x32_bf16 v[64:67], v[80:83], v[24:27], v[64:67]
    v_mfma_f32_16x16x32_bf16 v[68:71], v[84:87], v[24:27], v[68:71]
    v_mfma_f32_16x16x32_bf16 v[72:75], v[88:91], v[24:27], v[72:75]
    v_mfma_f32_16x16x32_bf16 v[76:79], v[92:95], v[24:27], v[76:79]
    s_mov_b32 m0, s47
    s_nop 0
    buffer_load_dwordx4 v2, s[12:15], s46 offen lds
    s_add_u32 s46, s46, 1024
    s_add_u32 s47, s47, 1024
    s_mov_b32 m0, s47
    s_nop 0
    buffer_load_dwordx4 v2, s[12:15], s46 offen lds
    s_add_u32 s46, s46, 1024
    s_add_u32 s47, s47, 1024
    ds_read_b128 v[80:83], v8 offset:4096
    ds_read_b128 v[84:87], v8 offset:18432
    ds_read_b128 v[88:91], v8 offset:32768
    ds_read_b128 v[92:95], v8 offset:47104
    s_waitcnt lgkmcnt(4)
    v_mfma_f32_16x16x32_bf16 v[64:67], v[96:99], v[28:31], v[64:67]
    v_mfma_f32_16x16x32_bf16 v[68:71], v[100:103], v[28:31], v[68:71]
    v_mfma_f32_16x16x32_bf16 v[72:75], v[104:107], v[28:31], v[72:75]
    v_mfma_f32_16x16x32_bf16 v[76:79], v[108:111], v[28:31], v[76:79]
    s_mov_b32 m0, s47
    s_nop 0
    buffer_load_dwordx4 v2, s[12:15], s46 offen lds
    s_add_u32 s46, s46, 1024
    s_add_u32 s47, s47, 1024
    s_mov_b32 m0, s47
    s_nop 0
    buffer_load_dwordx4 v2, s[12:15], s46 offen lds
    s_add_u32 s46, s46, 1024
    s_add_u32 s47, s47, 1024
    ds_read_b128 v[96:99], v8 offset:5120
    ds_read_b128 v[100:103], v8 offset:19456
    ds_read_b128 v[104:107], v8 offset:33792
    ds_read_b128 v[108:111], v8 offset:48128
    s_waitcnt lgkmcnt(4)
    v_mfma_f32_16x16x32_bf16 v[64:67], v[80:83], v[32:35], v[64:67]
    v_mfma_f32_16x16x32_bf16 v[68:71], v[84:87], v[32:35], v[68:71]
    v_mfma_f32_16x16x32_bf16 v[72:75], v[88:91], v[32:35], v[72:75]
    v_mfma_f32_16x16x32_bf16 v[76:79], v[92:95], v[32:35], v[76:79]
    s_mov_b32 m0, s47
    s_nop 0
    buffer_load_dwordx4 v2, s[12:15], s46 offen lds
    s_add_u32 s46, s46, 1024
    s_add_u32 s47, s47, 1024
    ds_read_b128 v[80:83], v8 offset:6144
    ds_read_b128 v[84:87], v8 offset:20480
    ds_read_b128 v[88:91], v8 offset:34816
    ds_read_b128 v[92:95], v8 offset:49152
    s_waitcnt lgkmcnt(4)
    v_mfma_f32_16x16x32_bf16 v[64:67], v[96:99], v[36:39], v[64:67]
    v_mfma_f32_16x16x32_bf16 v[68:71], v[100:103], v[36:39], v[68:71]
    v_mfma_f32_16x16x32_bf16 v[72:75], v[104:107], v[36:39], v[72:75]
    v_mfma_f32_16x16x32_bf16 v[76:79], v[108:111], v[36:39], v[76:79]
    s_mov_b32 m0, s47
    s_nop 0
    buffer_load_dwordx4 v2, s[12:15], s46 offen lds
    s_add_u32 s46, s46, 1024
    s_add_u32 s47, s47, 1024
    s_waitcnt lgkmcnt(0)
    v_mfma_f32_16x16x32_bf16 v[64:67], v[80:83], v[40:43], v[64:67]
    v_mfma_f32_16x16x32_bf16 v[68:71], v[84:87], v[40:43], v[68:71]
    v_mfma_f32_16x16x32_bf16 v[72:75], v[88:91], v[40:43], v[72:75]
    v_mfma_f32_16x16x32_bf16 v[76:79], v[92:95], v[40:43], v[76:79]
    s_mov_b32 m0, s47
    s_nop 0
    buffer_load_dwordx4 v2, s[12:15], s46 offen lds
    s_add_u32 s46, s46, 1024
    s_add_u32 s47, s47, 1024
    s_lshl_b32 s44, s88, 1
    s_add_u32 s44, s44, s89
    s_lshl_b32 s45, s44, 11
    s_xor_b32 s44, s44, 1
    s_lshl_b32 s44, s44, 11
    s_add_u32 s45, s45, 147456
    s_add_u32 s44, s44, 147456
    v_add_u32 v6, s45, v2
    v_add_u32 v7, s44, v2
    s_cmp_eq_u32 s89, 0
    s_nop 0
    s_cbranch_scc1 L_hx_lo_104
    ds_write_b128 v6, v[64:67]
    ds_write_b128 v6, v[68:71] offset:1024
    v_mov_b32 v16, v72
    v_mov_b32 v17, v73
    v_mov_b32 v18, v74
    v_mov_b32 v19, v75
    v_mov_b32 v20, v76
    v_mov_b32 v21, v77
    v_mov_b32 v22, v78
    v_mov_b32 v23, v79
    s_nop 1
    s_branch L_hx_j1_105
L_hx_lo_104:
    ds_write_b128 v6, v[72:75]
    ds_write_b128 v6, v[76:79] offset:1024
    v_mov_b32 v16, v64
    v_mov_b32 v17, v65
    v_mov_b32 v18, v66
    v_mov_b32 v19, v67
    v_mov_b32 v20, v68
    v_mov_b32 v21, v69
    v_mov_b32 v22, v70
    v_mov_b32 v23, v71
    s_nop 1
L_hx_j1_105:
    s_waitcnt lgkmcnt(0)
    s_barrier
    ds_read_b128 v[64:67], v7
    ds_read_b128 v[68:71], v7 offset:1024
    s_waitcnt lgkmcnt(0)
    v_add_f32 v16, v16, v64
    v_add_f32 v17, v17, v65
    v_add_f32 v18, v18, v66
    v_add_f32 v19, v19, v67
    v_add_f32 v20, v20, v68
    v_add_f32 v21, v21, v69
    v_add_f32 v22, v22, v70
    v_add_f32 v23, v23, v71
    v_cvt_pk_bf16_f32 v17, v16, v17
    v_lshlrev_b32 v16, 16, v17
    v_and_b32 v17, 0xffff0000, v17
    v_cvt_pk_bf16_f32 v19, v18, v19
    v_lshlrev_b32 v18, 16, v19
    v_and_b32 v19, 0xffff0000, v19
    v_cvt_pk_bf16_f32 v21, v20, v21
    v_lshlrev_b32 v20, 16, v21
    v_and_b32 v21, 0xffff0000, v21
    v_cvt_pk_bf16_f32 v23, v22, v23
    v_lshlrev_b32 v22, 16, v23
    v_and_b32 v23, 0xffff0000, v23
    v_lshlrev_b32 v8, 16, v60
    v_and_b32 v9, 0xffff0000, v60
    v_add_f32 v16, v16, v8
    v_add_f32 v17, v17, v9
    v_lshlrev_b32 v8, 16, v61
    v_and_b32 v9, 0xffff0000, v61
    v_add_f32 v18, v18, v8
    v_add_f32 v19, v19, v9
    v_lshlrev_b32 v8, 16, v62
    v_and_b32 v9, 0xffff0000, v62
    v_add_f32 v20, v20, v8
    v_add_f32 v21, v21, v9
    v_lshlrev_b32 v8, 16, v63
    v_and_b32 v9, 0xffff0000, v63
    v_add_f32 v22, v22, v8
    v_add_f32 v23, v23, v9
    v_cvt_pk_bf16_f32 v24, v16, v17
    v_cvt_pk_bf16_f32 v25, v18, v19
    v_cvt_pk_bf16_f32 v26, v20, v21
    v_cvt_pk_bf16_f32 v27, v22, v23
    buffer_store_dwordx4 v[24:27], v2, s[20:23], s41 offen
    s_lshl_b32 s40, s84, 3
    s_add_u32 s40, s40, s85
    s_add_u32 s40, s40, 1024
    s_waitcnt vmcnt(0)
    s_barrier
    s_cmp_lg_u32 s3, 0
    s_cbranch_scc1 L_sig_106
    s_add_u32 s28, s94, 7921664
    s_addc_u32 s29, s95, 0
    s_mov_b32 s30, 16384
    s_mov_b32 s31, 0x00020000
    s_lshl_b32 s48, s40, 2
    v_mov_b32 v6, 1
    v_mov_b32 v7, s48
    s_mov_b64 exec, 1
    s_cmp_lg_u32 s80, 0
    s_cbranch_scc1 L_sigfb_107
    buffer_store_dword v6, v7, s[28:31], 0 offen
    s_nop 1
    s_branch L_sigj_108
L_sigfb_107:
    buffer_wbl2 sc1
    s_waitcnt vmcnt(0)
    buffer_store_dword v6, v7, s[28:31], 0 offen sc1
    s_nop 1
L_sigj_108:
    s_mov_b64 exec, -1
L_sig_106:
    s_mul_i32 s44, s83, 114688
    s_add_u32 s12, s94, s44
    s_addc_u32 s13, s95, 0
    s_add_u32 s12, s12, 2613248
    s_addc_u32 s13, s13, 0
    s_mov_b32 s14, 114688
    s_mov_b32 s15, 0x00020000
    s_mul_i32 s46, s3, 3
    s_min_u32 s47, s3, 4
    s_add_u32 s46, s46, s47
    s_add_u32 s46, s46, 84
    s_lshl_b32 s44, s46, 10
    s_add_u32 s45, s44, 4294881280
    s_mov_b32 m0, s45
    s_nop 0
    buffer_load_dwordx4 v2, s[12:15], s44 offen offset:0 lds
    buffer_load_dwordx4 v2, s[12:15], s44 offen offset:1024 lds
    buffer_load_dwordx4 v2, s[12:15], s44 offen offset:2048 lds
    s_cmp_ge_u32 s3, 4
    s_cbranch_scc1 L_k5b_109
    s_add_u32 s46, s46, 3
    s_lshl_b32 s44, s46, 10
    s_add_u32 s45, s44, 4294881280
    s_mov_b32 m0, s45
    s_nop 0
    buffer_load_dwordx4 v2, s[12:15], s44 offen offset:0 lds
L_k5b_109:
    s_lshl_b32 s40, s82, 4
    s_add_u32 s40, s40, 1024
    s_cmp_lg_u32 s3, 0
    s_cbranch_scc1 L_wsk_110
    s_add_u32 s28, s94, 7921664
    s_addc_u32 s29, s95, 0
    s_mov_b32 s30, 16384
    s_mov_b32 s31, 0x00020000
    s_mov_b32 s50, 0
    v_add_u32 v6, s40, v1
    v_and_b32 v7, 7, v1
    v_cmp_eq_u32 s[48:49], 7, v7
    v_cmp_le_u32 vcc, 16, v1
    s_nop 0
    s_or_b64 s[48:49], s[48:49], vcc
    v_lshlrev_b32 v6, 2, v6
    v_cndmask_b32 v6, v6, 0, s[48:49]
    s_nop 1
L_wlp_111:
    buffer_load_dword v8, v6, s[28:31], 0 offen sc1
    s_waitcnt vmcnt(0)
    v_cmp_ne_u32 vcc, 0, v8
    s_nop 0
    s_or_b64 vcc, vcc, s[48:49]
    s_cmp_eq_u64 vcc, -1
    s_nop 1
    s_cbranch_scc1 L_wdn_112
    s_sleep 1
    s_add_u32 s50, s50, 1
    s_cmp_lt_u32 s50, 65536
    s_cbranch_scc1 L_wlp_111
L_wdn_112:
    s_cmp_eq_u32 s80, 0
    s_cbranch_scc1 L_wsk_110
    buffer_inv sc1
    s_waitcnt vmcnt(0)
L_wsk_110:
    s_barrier
    s_add_u32 s8, s94, 22618112
    s_addc_u32 s9, s95, 0
    s_mov_b32 s10, 1835008
    s_mov_b32 s11, 0x00020000
    s_add_u32 s20, s94, 26288128
    s_addc_u32 s21, s95, 0
    s_mov_b32 s22, 7340032
    s_mov_b32 s23, 0x00020000
    s_lshl_b32 s47, s82, 3
    s_add_u32 s47, s47, s3
    s_mul_i32 s44, s47, 14336
    buffer_load_dwordx4 v[16:19], v2, s[8:11], s44 offen offset:0
    buffer_load_dwordx4 v[20:23], v2, s[8:11], s44 offen offset:1024
    buffer_load_dwordx4 v[24:27], v2, s[8:11], s44 offen offset:2048
    buffer_load_dwordx4 v[28:31], v2, s[8:11], s44 offen offset:3072
    s_add_u32 s44, s44, 4096
    buffer_load_dwordx4 v[32:35], v2, s[8:11], s44 offen offset:0
    buffer_load_dwordx4 v[36:39], v2, s[8:11], s44 offen offset:1024
    buffer_load_dwordx4 v[40:43], v2, s[8:11], s44 offen offset:2048
    buffer_load_dwordx4 v[44:47], v2, s[8:11], s44 offen offset:3072
    s_add_u32 s44, s44, 4096
    buffer_load_dwordx4 v[48:51], v2, s[8:11], s44 offen offset:0
    buffer_load_dwordx4 v[52:55], v2, s[8:11], s44 offen offset:1024
    buffer_load_dwordx4 v[56:59], v2, s[8:11], s44 offen offset:2048
    buffer_load_dwordx4 v[60:63], v2, s[8:11], s44 offen offset:3072
    s_add_u32 s44, s44, 4096
    buffer_load_dwordx4 v[64:67], v2, s[8:11], s44 offen offset:0
    buffer_load_dwordx4 v[68:71], v2, s[8:11], s44 offen offset:1024
    s_waitcnt vmcnt(0)
    v_mov_b32 v8, 0
    v_mov_b32 v9, 0
    v_mov_b32 v10, 0
    v_mov_b32 v11, 0
    v_dot2_f32_bf16 v8, v16, s60, v8
    v_dot2_f32_bf16 v9, v16, v16, v9
    v_dot2_f32_bf16 v10, v17, s60, v10
    v_dot2_f32_bf16 v11, v17, v17, v11
    v_dot2_f32_bf16 v8, v18, s60, v8
    v_dot2_f32_bf16 v9, v18, v18, v9
    v_dot2_f32_bf16 v10, v19, s60, v10
    v_dot2_f32_bf16 v11, v19, v19, v11
    v_dot2_f32_bf16 v8, v20, s60, v8
    v_dot2_f32_bf16 v9, v20, v20, v9
    v_dot2_f32_bf16 v10, v21, s60, v10
    v_dot2_f32_bf16 v11, v21, v21, v11
    v_dot2_f32_bf16 v8, v22, s60, v8
    v_dot2_f32_bf16 v9, v22, v22, v9
    v_dot2_f32_bf16 v10, v23, s60, v10
    v_dot2_f32_bf16 v11, v23, v23, v11
    v_dot2_f32_bf16 v8, v24, s60, v8
    v_dot2_f32_bf16 v9, v24, v24, v9
    v_dot2_f32_bf16 v10, v25, s60, v10
    v_dot2_f32_bf16 v11, v25, v25, v11
    v_dot2_f32_bf16 v8, v26, s60, v8
    v_dot2_f32_bf16 v9, v26, v26, v9
    v_dot2_f32_bf16 v10, v27, s60, v10
    v_dot2_f32_bf16 v11, v27, v27, v11
    v_dot2_f32_bf16 v8, v28, s60, v8
    v_dot2_f32_bf16 v9, v28, v28, v9
    v_dot2_f32_bf16 v10, v29, s60, v10
    v_dot2_f32_bf16 v11, v29, v29, v11
    v_dot2_f32_bf16 v8, v30, s60, v8
    v_dot2_f32_bf16 v9, v30, v30, v9
    v_dot2_f32_bf16 v10, v31, s60, v10
    v_dot2_f32_bf16 v11, v31, v31, v11
    v_dot2_f32_bf16 v8, v32, s60, v8
    v_dot2_f32_bf16 v9, v32, v32, v9
    v_dot2_f32_bf16 v10, v33, s60, v10
    v_dot2_f32_bf16 v11, v33, v33, v11
    v_dot2_f32_bf16 v8, v34, s60, v8
    v_dot2_f32_bf16 v9, v34, v34, v9
    v_dot2_f32_bf16 v10, v35, s60, v10
    v_dot2_f32_bf16 v11, v35, v35, v11
    v_dot2_f32_bf16 v8, v36, s60, v8
    v_dot2_f32_bf16 v9, v36, v36, v9
    v_dot2_f32_bf16 v10, v37, s60, v10
    v_dot2_f32_bf16 v11, v37, v37, v11
    v_dot2_f32_bf16 v8, v38, s60, v8
    v_dot2_f32_bf16 v9, v38, v38, v9
    v_dot2_f32_bf16 v10, v39, s60, v10
    v_dot2_f32_bf16 v11, v39, v39, v11
    v_dot2_f32_bf16 v8, v40, s60, v8
    v_dot2_f32_bf16 v9, v40, v40, v9
    v_dot2_f32_bf16 v10, v41, s60, v10
    v_dot2_f32_bf16 v11, v41, v41, v11
    v_dot2_f32_bf16 v8, v42, s60, v8
    v_dot2_f32_bf16 v9, v42, v42, v9
    v_dot2_f32_bf16 v10, v43, s60, v10
    v_dot2_f32_bf16 v11, v43, v43, v11
    v_dot2_f32_bf16 v8, v44, s60, v8
    v_dot2_f32_bf16 v9, v44, v44, v9
    v_dot2_f32_bf16 v10, v45, s60, v10
    v_dot2_f32_bf16 v11, v45, v45, v11
    v_dot2_f32_bf16 v8, v46, s60, v8
    v_dot2_f32_bf16 v9, v46, v46, v9
    v_dot2_f32_bf16 v10, v47, s60, v10
    v_dot2_f32_bf16 v11, v47, v47, v11
    v_dot2_f32_bf16 v8, v48, s60, v8
    v_dot2_f32_bf16 v9, v48, v48, v9
    v_dot2_f32_bf16 v10, v49, s60, v10
    v_dot2_f32_bf16 v11, v49, v49, v11
    v_dot2_f32_bf16 v8, v50, s60, v8
    v_dot2_f32_bf16 v9, v50, v50, v9
    v_dot2_f32_bf16 v10, v51, s60, v10
    v_dot2_f32_bf16 v11, v51, v51, v11
    v_dot2_f32_bf16 v8, v52, s60, v8
    v_dot2_f32_bf16 v9, v52, v52, v9
    v_dot2_f32_bf16 v10, v53, s60, v10
    v_dot2_f32_bf16 v11, v53, v53, v11
    v_dot2_f32_bf16 v8, v54, s60, v8
    v_dot2_f32_bf16 v9, v54, v54, v9
    v_dot2_f32_bf16 v10, v55, s60, v10
    v_dot2_f32_bf16 v11, v55, v55, v11
    v_dot2_f32_bf16 v8, v56, s60, v8
    v_dot2_f32_bf16 v9, v56, v56, v9
    v_dot2_f32_bf16 v10, v57, s60, v10
    v_dot2_f32_bf16 v11, v57, v57, v11
    v_dot2_f32_bf16 v8, v58, s60, v8
    v_dot2_f32_bf16 v9, v58, v58, v9
    v_dot2_f32_bf16 v10, v59, s60, v10
    v_dot2_f32_bf16 v11, v59, v59, v11
    v_dot2_f32_bf16 v8, v60, s60, v8
    v_dot2_f32_bf16 v9, v60, v60, v9
    v_dot2_f32_bf16 v10, v61, s60, v10
    v_dot2_f32_bf16 v11, v61, v61, v11
    v_dot2_f32_bf16 v8, v62, s60, v8
    v_dot2_f32_bf16 v9, v62, v62, v9
    v_dot2_f32_bf16 v10, v63, s60, v10
    v_dot2_f32_bf16 v11, v63, v63, v11
    v_dot2_f32_bf16 v8, v64, s60, v8
    v_dot2_f32_bf16 v9, v64, v64, v9
    v_dot2_f32_bf16 v10, v65, s60, v10
    v_dot2_f32_bf16 v11, v65, v65, v11
    v_dot2_f32_bf16 v8, v66, s60, v8
    v_dot2_f32_bf16 v9, v66, v66, v9
    v_dot2_f32_bf16 v10, v67, s60, v10
    v_dot2_f32_bf16 v11, v67, v67, v11
    v_dot2_f32_bf16 v8, v68, s60, v8
    v_dot2_f32_bf16 v9, v68, v68, v9
    v_dot2_f32_bf16 v10, v69, s60, v10
    v_dot2_f32_bf16 v11, v69, v69, v11
    v_dot2_f32_bf16 v8, v70, s60, v8
    v_dot2_f32_bf16 v9, v70, v70, v9
    v_dot2_f32_bf16 v10, v71, s60, v10
    v_dot2_f32_bf16 v11, v71, v71, v11
    s_nop 1
    v_add_f32 v8, v8, v10
    v_add_f32 v9, v9, v11
    v_mov_b32 v10, v8
    s_nop 1
    v_permlane32_swap_b32 v8, v10
    v_add_f32 v8, v8, v10
    v_mov_b32 v10, v8
    s_nop 1
    v_permlane16_swap_b32 v8, v10
    v_add_f32 v8, v8, v10
    v_mov_b32 v11, v9
    s_nop 1
    v_permlane32_swap_b32 v9, v11
    v_add_f32 v9, v9, v11
    v_mov_b32 v11, v9
    s_nop 1
    v_permlane16_swap_b32 v9, v11
    v_add_f32 v9, v9, v11
    v_mul_f32 v8, 0x3b124925, v8
    v_mul_f32 v9, 0x3b124925, v9
    v_fma_f32 v9, -v8, v8, v9
    v_max_f32 v9, 0, v9
    v_cvt_pk_bf16_f32 v8, v8, v8
    v_and_b32 v8, 0xffff0000, v8
    v_cvt_pk_bf16_f32 v9, v9, v9
    v_and_b32 v9, 0xffff0000, v9
    v_add_f32 v9, 0x3727c5ac, v9
    v_cvt_pk_bf16_f32 v9, v9, v9
    v_and_b32 v9, 0xffff0000, v9
    v_sqrt_f32 v9, v9
    s_nop 0
    v_cvt_pk_bf16_f32 v9, v9, v9
    v_and_b32 v9, 0xffff0000, v9
    v_rcp_f32 v72, v9
    s_nop 0
    v_mul_f32 v74, v8, v72
    v_sub_f32 v74, 0, v74
    v_lshlrev_b32 v76, 16, v16
    v_and_b32 v77, 0xffff0000, v16
    v_pk_fma_f32 v[76:77], v[76:77], v[72:73], v[74:75] op_sel_hi:[1,0,0]
    v_cvt_pk_bf16_f32 v16, v76, v77
    v_lshlrev_b32 v78, 16, v17
    v_and_b32 v79, 0xffff0000, v17
    v_pk_fma_f32 v[78:79], v[78:79], v[72:73], v[74:75] op_sel_hi:[1,0,0]
    v_cvt_pk_bf16_f32 v17, v78, v79
    v_lshlrev_b32 v80, 16, v18
    v_and_b32 v81, 0xffff0000, v18
    v_pk_fma_f32 v[80:81], v[80:81], v[72:73], v[74:75] op_sel_hi:[1,0,0]
    v_cvt_pk_bf16_f32 v18, v80, v81
    v_lshlrev_b32 v82, 16, v19
    v_and_b32 v83, 0xffff0000, v19
    v_pk_fma_f32 v[82:83], v[82:83], v[72:73], v[74:75] op_sel_hi:[1,0,0]
    v_cvt_pk_bf16_f32 v19, v82, v83
    v_lshlrev_b32 v76, 16, v20
    v_and_b32 v77, 0xffff0000, v20
    v_pk_fma_f32 v[76:77], v[76:77], v[72:73], v[74:75] op_sel_hi:[1,0,0]
    v_cvt_pk_bf16_f32 v20, v76, v77
    v_lshlrev_b32 v78, 16, v21
    v_and_b32 v79, 0xffff0000, v21
    v_pk_fma_f32 v[78:79], v[78:79], v[72:73], v[74:75] op_sel_hi:[1,0,0]
    v_cvt_pk_bf16_f32 v21, v78, v79
    v_lshlrev_b32 v80, 16, v22
    v_and_b32 v81, 0xffff0000, v22
    v_pk_fma_f32 v[80:81], v[80:81], v[72:73], v[74:75] op_sel_hi:[1,0,0]
    v_cvt_pk_bf16_f32 v22, v80, v81
    v_lshlrev_b32 v82, 16, v23
    v_and_b32 v83, 0xffff0000, v23
    v_pk_fma_f32 v[82:83], v[82:83], v[72:73], v[74:75] op_sel_hi:[1,0,0]
    v_cvt_pk_bf16_f32 v23, v82, v83
    v_lshlrev_b32 v76, 16, v24
    v_and_b32 v77, 0xffff0000, v24
    v_pk_fma_f32 v[76:77], v[76:77], v[72:73], v[74:75] op_sel_hi:[1,0,0]
    v_cvt_pk_bf16_f32 v24, v76, v77
    v_lshlrev_b32 v78, 16, v25
    v_and_b32 v79, 0xffff0000, v25
    v_pk_fma_f32 v[78:79], v[78:79], v[72:73], v[74:75] op_sel_hi:[1,0,0]
    v_cvt_pk_bf16_f32 v25, v78, v79
    v_lshlrev_b32 v80, 16, v26
    v_and_b32 v81, 0xffff0000, v26
    v_pk_fma_f32 v[80:81], v[80:81], v[72:73], v[74:75] op_sel_hi:[1,0,0]
    v_cvt_pk_bf16_f32 v26, v80, v81
    v_lshlrev_b32 v82, 16, v27
    v_and_b32 v83, 0xffff0000, v27
    v_pk_fma_f32 v[82:83], v[82:83], v[72:73], v[74:75] op_sel_hi:[1,0,0]
    v_cvt_pk_bf16_f32 v27, v82, v83
    v_lshlrev_b32 v76, 16, v28
    v_and_b32 v77, 0xffff0000, v28
    v_pk_fma_f32 v[76:77], v[76:77], v[72:73], v[74:75] op_sel_hi:[1,0,0]
    v_cvt_pk_bf16_f32 v28, v76, v77
    v_lshlrev_b32 v78, 16, v29
    v_and_b32 v79, 0xffff0000, v29
    v_pk_fma_f32 v[78:79], v[78:79], v[72:73], v[74:75] op_sel_hi:[1,0,0]
    v_cvt_pk_bf16_f32 v29, v78, v79
    v_lshlrev_b32 v80, 16, v30
    v_and_b32 v81, 0xffff0000, v30
    v_pk_fma_f32 v[80:81], v[80:81], v[72:73], v[74:75] op_sel_hi:[1,0,0]
    v_cvt_pk_bf16_f32 v30, v80, v81
    v_lshlrev_b32 v82, 16, v31
    v_and_b32 v83, 0xffff0000, v31
    v_pk_fma_f32 v[82:83], v[82:83], v[72:73], v[74:75] op_sel_hi:[1,0,0]
    v_cvt_pk_bf16_f32 v31, v82, v83
    v_lshlrev_b32 v76, 16, v32
    v_and_b32 v77, 0xffff0000, v32
    v_pk_fma_f32 v[76:77], v[76:77], v[72:73], v[74:75] op_sel_hi:[1,0,0]
    v_cvt_pk_bf16_f32 v32, v76, v77
    v_lshlrev_b32 v78, 16, v33
    v_and_b32 v79, 0xffff0000, v33
    v_pk_fma_f32 v[78:79], v[78:79], v[72:73], v[74:75] op_sel_hi:[1,0,0]
    v_cvt_pk_bf16_f32 v33, v78, v79
    v_lshlrev_b32 v80, 16, v34
    v_and_b32 v81, 0xffff0000, v34
    v_pk_fma_f32 v[80:81], v[80:81], v[72:73], v[74:75] op_sel_hi:[1,0,0]
    v_cvt_pk_bf16_f32 v34, v80, v81
    v_lshlrev_b32 v82, 16, v35
    v_and_b32 v83, 0xffff0000, v35
    v_pk_fma_f32 v[82:83], v[82:83], v[72:73], v[74:75] op_sel_hi:[1,0,0]
    v_cvt_pk_bf16_f32 v35, v82, v83
    v_lshlrev_b32 v76, 16, v36
    v_and_b32 v77, 0xffff0000, v36
    v_pk_fma_f32 v[76:77], v[76:77], v[72:73], v[74:75] op_sel_hi:[1,0,0]
    v_cvt_pk_bf16_f32 v36, v76, v77
    v_lshlrev_b32 v78, 16, v37
    v_and_b32 v79, 0xffff0000, v37
    v_pk_fma_f32 v[78:79], v[78:79], v[72:73], v[74:75] op_sel_hi:[1,0,0]
    v_cvt_pk_bf16_f32 v37, v78, v79
    v_lshlrev_b32 v80, 16, v38
    v_and_b32 v81, 0xffff0000, v38
    v_pk_fma_f32 v[80:81], v[80:81], v[72:73], v[74:75] op_sel_hi:[1,0,0]
    v_cvt_pk_bf16_f32 v38, v80, v81
    v_lshlrev_b32 v82, 16, v39
    v_and_b32 v83, 0xffff0000, v39
    v_pk_fma_f32 v[82:83], v[82:83], v[72:73], v[74:75] op_sel_hi:[1,0,0]
    v_cvt_pk_bf16_f32 v39, v82, v83
    v_lshlrev_b32 v76, 16, v40
    v_and_b32 v77, 0xffff0000, v40
    v_pk_fma_f32 v[76:77], v[76:77], v[72:73], v[74:75] op_sel_hi:[1,0,0]
    v_cvt_pk_bf16_f32 v40, v76, v77
    v_lshlrev_b32 v78, 16, v41
    v_and_b32 v79, 0xffff0000, v41
    v_pk_fma_f32 v[78:79], v[78:79], v[72:73], v[74:75] op_sel_hi:[1,0,0]
    v_cvt_pk_bf16_f32 v41, v78, v79
    v_lshlrev_b32 v80, 16, v42
    v_and_b32 v81, 0xffff0000, v42
    v_pk_fma_f32 v[80:81], v[80:81], v[72:73], v[74:75] op_sel_hi:[1,0,0]
    v_cvt_pk_bf16_f32 v42, v80, v81
    v_lshlrev_b32 v82, 16, v43
    v_and_b32 v83, 0xffff0000, v43
    v_pk_fma_f32 v[82:83], v[82:83], v[72:73], v[74:75] op_sel_hi:[1,0,0]
    v_cvt_pk_bf16_f32 v43, v82, v83
    v_lshlrev_b32 v76, 16, v44
    v_and_b32 v77, 0xffff0000, v44
    v_pk_fma_f32 v[76:77], v[76:77], v[72:73], v[74:75] op_sel_hi:[1,0,0]
    v_cvt_pk_bf16_f32 v44, v76, v77
    v_lshlrev_b32 v78, 16, v45
    v_and_b32 v79, 0xffff0000, v45
    v_pk_fma_f32 v[78:79], v[78:79], v[72:73], v[74:75] op_sel_hi:[1,0,0]
    v_cvt_pk_bf16_f32 v45, v78, v79
    v_lshlrev_b32 v80, 16, v46
    v_and_b32 v81, 0xffff0000, v46
    v_pk_fma_f32 v[80:81], v[80:81], v[72:73], v[74:75] op_sel_hi:[1,0,0]
    v_cvt_pk_bf16_f32 v46, v80, v81
    v_lshlrev_b32 v82, 16, v47
    v_and_b32 v83, 0xffff0000, v47
    v_pk_fma_f32 v[82:83], v[82:83], v[72:73], v[74:75] op_sel_hi:[1,0,0]
    v_cvt_pk_bf16_f32 v47, v82, v83
    v_lshlrev_b32 v76, 16, v48
    v_and_b32 v77, 0xffff0000, v48
    v_pk_fma_f32 v[76:77], v[76:77], v[72:73], v[74:75] op_sel_hi:[1,0,0]
    v_cvt_pk_bf16_f32 v48, v76, v77
    v_lshlrev_b32 v78, 16, v49
    v_and_b32 v79, 0xffff0000, v49
    v_pk_fma_f32 v[78:79], v[78:79], v[72:73], v[74:75] op_sel_hi:[1,0,0]
    v_cvt_pk_bf16_f32 v49, v78, v79
    v_lshlrev_b32 v80, 16, v50
    v_and_b32 v81, 0xffff0000, v50
    v_pk_fma_f32 v[80:81], v[80:81], v[72:73], v[74:75] op_sel_hi:[1,0,0]
    v_cvt_pk_bf16_f32 v50, v80, v81
    v_lshlrev_b32 v82, 16, v51
    v_and_b32 v83, 0xffff0000, v51
    v_pk_fma_f32 v[82:83], v[82:83], v[72:73], v[74:75] op_sel_hi:[1,0,0]
    v_cvt_pk_bf16_f32 v51, v82, v83
    v_lshlrev_b32 v76, 16, v52
    v_and_b32 v77, 0xffff0000, v52
    v_pk_fma_f32 v[76:77], v[76:77], v[72:73], v[74:75] op_sel_hi:[1,0,0]
    v_cvt_pk_bf16_f32 v52, v76, v77
    v_lshlrev_b32 v78, 16, v53
    v_and_b32 v79, 0xffff0000, v53
    v_pk_fma_f32 v[78:79], v[78:79], v[72:73], v[74:75] op_sel_hi:[1,0,0]
    v_cvt_pk_bf16_f32 v53, v78, v79
    v_lshlrev_b32 v80, 16, v54
    v_and_b32 v81, 0xffff0000, v54
    v_pk_fma_f32 v[80:81], v[80:81], v[72:73], v[74:75] op_sel_hi:[1,0,0]
    v_cvt_pk_bf16_f32 v54, v80, v81
    v_lshlrev_b32 v82, 16, v55
    v_and_b32 v83, 0xffff0000, v55
    v_pk_fma_f32 v[82:83], v[82:83], v[72:73], v[74:75] op_sel_hi:[1,0,0]
    v_cvt_pk_bf16_f32 v55, v82, v83
    v_lshlrev_b32 v76, 16, v56
    v_and_b32 v77, 0xffff0000, v56
    v_pk_fma_f32 v[76:77], v[76:77], v[72:73], v[74:75] op_sel_hi:[1,0,0]
    v_cvt_pk_bf16_f32 v56, v76, v77
    v_lshlrev_b32 v78, 16, v57
    v_and_b32 v79, 0xffff0000, v57
    v_pk_fma_f32 v[78:79], v[78:79], v[72:73], v[74:75] op_sel_hi:[1,0,0]
    v_cvt_pk_bf16_f32 v57, v78, v79
    v_lshlrev_b32 v80, 16, v58
    v_and_b32 v81, 0xffff0000, v58
    v_pk_fma_f32 v[80:81], v[80:81], v[72:73], v[74:75] op_sel_hi:[1,0,0]
    v_cvt_pk_bf16_f32 v58, v80, v81
    v_lshlrev_b32 v82, 16, v59
    v_and_b32 v83, 0xffff0000, v59
    v_pk_fma_f32 v[82:83], v[82:83], v[72:73], v[74:75] op_sel_hi:[1,0,0]
    v_cvt_pk_bf16_f32 v59, v82, v83
    v_lshlrev_b32 v76, 16, v60
    v_and_b32 v77, 0xffff0000, v60
    v_pk_fma_f32 v[76:77], v[76:77], v[72:73], v[74:75] op_sel_hi:[1,0,0]
    v_cvt_pk_bf16_f32 v60, v76, v77
    v_lshlrev_b32 v78, 16, v61
    v_and_b32 v79, 0xffff0000, v61
    v_pk_fma_f32 v[78:79], v[78:79], v[72:73], v[74:75] op_sel_hi:[1,0,0]
    v_cvt_pk_bf16_f32 v61, v78, v79
    v_lshlrev_b32 v80, 16, v62
    v_and_b32 v81, 0xffff0000, v62
    v_pk_fma_f32 v[80:81], v[80:81], v[72:73], v[74:75] op_sel_hi:[1,0,0]
    v_cvt_pk_bf16_f32 v62, v80, v81
    v_lshlrev_b32 v82, 16, v63
    v_and_b32 v83, 0xffff0000, v63
    v_pk_fma_f32 v[82:83], v[82:83], v[72:73], v[74:75] op_sel_hi:[1,0,0]
    v_cvt_pk_bf16_f32 v63, v82, v83
    v_lshlrev_b32 v76, 16, v64
    v_and_b32 v77, 0xffff0000, v64
    v_pk_fma_f32 v[76:77], v[76:77], v[72:73], v[74:75] op_sel_hi:[1,0,0]
    v_cvt_pk_bf16_f32 v64, v76, v77
    v_lshlrev_b32 v78, 16, v65
    v_and_b32 v79, 0xffff0000, v65
    v_pk_fma_f32 v[78:79], v[78:79], v[72:73], v[74:75] op_sel_hi:[1,0,0]
    v_cvt_pk_bf16_f32 v65, v78, v79
    v_lshlrev_b32 v80, 16, v66
    v_and_b32 v81, 0xffff0000, v66
    v_pk_fma_f32 v[80:81], v[80:81], v[72:73], v[74:75] op_sel_hi:[1,0,0]
    v_cvt_pk_bf16_f32 v66, v80, v81
    v_lshlrev_b32 v82, 16, v67
    v_and_b32 v83, 0xffff0000, v67
    v_pk_fma_f32 v[82:83], v[82:83], v[72:73], v[74:75] op_sel_hi:[1,0,0]
    v_cvt_pk_bf16_f32 v67, v82, v83
    v_lshlrev_b32 v76, 16, v68
    v_and_b32 v77, 0xffff0000, v68
    v_pk_fma_f32 v[76:77], v[76:77], v[72:73], v[74:75] op_sel_hi:[1,0,0]
    v_cvt_pk_bf16_f32 v68, v76, v77
    v_lshlrev_b32 v78, 16, v69
    v_and_b32 v79, 0xffff0000, v69
    v_pk_fma_f32 v[78:79], v[78:79], v[72:73], v[74:75] op_sel_hi:[1,0,0]
    v_cvt_pk_bf16_f32 v69, v78, v79
    v_lshlrev_b32 v80, 16, v70
    v_and_b32 v81, 0xffff0000, v70
    v_pk_fma_f32 v[80:81], v[80:81], v[72:73], v[74:75] op_sel_hi:[1,0,0]
    v_cvt_pk_bf16_f32 v70, v80, v81
    v_lshlrev_b32 v82, 16, v71
    v_and_b32 v83, 0xffff0000, v71
    v_pk_fma_f32 v[82:83], v[82:83], v[72:73], v[74:75] op_sel_hi:[1,0,0]
    v_cvt_pk_bf16_f32 v71, v82, v83
    s_barrier
    v_add_u32 v13, 0x20000, v2
    ds_read_b128 v[84:87], v2 offset:57344
    ds_read_b128 v[88:91], v5 offset:6144
    ds_read_b128 v[92:95], v5 offset:20480
    ds_read_b128 v[96:99], v5 offset:34816
    ds_read_b128 v[100:103], v5 offset:49152
    ds_read_b128 v[104:107], v5 offset:63488
    ds_read_b128 v[108:111], v2 offset:0
    ds_read_b128 v[112:115], v2 offset:14336
    ds_read_b128 v[116:119], v2 offset:58368
    ds_read_b128 v[120:123], v5 offset:7168
    ds_read_b128 v[124:127], v5 offset:21504
    ds_read_b128 v[128:131], v5 offset:35840
    ds_read_b128 v[132:135], v5 offset:50176
    ds_read_b128 v[136:139], v5 offset:64512
    ds_read_b128 v[140:143], v2 offset:1024
    ds_read_b128 v[144:147], v2 offset:15360
    s_waitcnt lgkmcnt(8)
    v_mfma_f32_16x16x32_bf16 v[148:151], v[84:87], v[16:19], 0
    v_mfma_f32_16x16x32_bf16 v[152:155], v[88:91], v[16:19], 0
    v_mfma_f32_16x16x32_bf16 v[156:159], v[92:95], v[16:19], 0
    v_mfma_f32_16x16x32_bf16 v[160:163], v[96:99], v[16:19], 0
    v_mfma_f32_16x16x32_bf16 v[164:167], v[100:103], v[16:19], 0
    v_mfma_f32_16x16x32_bf16 v[168:171], v[104:107], v[16:19], 0
    v_mfma_f32_16x16x32_bf16 v[172:175], v[108:111], v[16:19], 0
    v_mfma_f32_16x16x32_bf16 v[176:179], v[112:115], v[16:19], 0
    ds_read_b128 v[84:87], v2 offset:59392
    ds_read_b128 v[88:91], v5 offset:8192
    ds_read_b128 v[92:95], v5 offset:22528
    ds_read_b128 v[96:99], v5 offset:36864
    ds_read_b128 v[100:103], v5 offset:51200
    ds_read_b128 v[104:107], v13 offset:0
    ds_read_b128 v[108:111], v2 offset:2048
    ds_read_b128 v[112:115], v2 offset:16384
    s_waitcnt lgkmcnt(8)
    v_mfma_f32_16x16x32_bf16 v[148:151], v[116:119], v[20:23], v[148:151]
    v_mfma_f32_16x16x32_bf16 v[152:155], v[120:123], v[20:23], v[152:155]
    v_mfma_f32_16x16x32_bf16 v[156:159], v[124:127], v[20:23], v[156:159]
    v_mfma_f32_16x16x32_bf16 v[160:163], v[128:131], v[20:23], v[160:163]
    v_mfma_f32_16x16x32_bf16 v[164:167], v[132:135], v[20:23], v[164:167]
    v_mfma_f32_16x16x32_bf16 v[168:171], v[136:139], v[20:23], v[168:171]
    v_mfma_f32_16x16x32_bf16 v[172:175], v[140:143], v[20:23], v[172:175]
    v_mfma_f32_16x16x32_bf16 v[176:179], v[144:147], v[20:23], v[176:179]
    ds_read_b128 v[116:119], v2 offset:60416
    ds_read_b128 v[120:123], v5 offset:9216
    ds_read_b128 v[124:127], v5 offset:23552
    ds_read_b128 v[128:131], v5 offset:37888
    ds_read_b128 v[132:135], v5 offset:52224
    ds_read_b128 v[136:139], v13 offset:1024
    ds_read_b128 v[140:143], v2 offset:3072
    ds_read_b128 v[144:147], v2 offset:17408
    s_waitcnt lgkmcnt(8)
    v_mfma_f32_16x16x32_bf16 v[148:151], v[84:87], v[24:27], v[148:151]
    v_mfma_f32_16x16x32_bf16 v[152:155], v[88:91], v[24:27], v[152:155]
    v_mfma_f32_16x16x32_bf16 v[156:159], v[92:95], v[24:27], v[156:159]
    v_mfma_f32_16x16x32_bf16 v[160:163], v[96:99], v[24:27], v[160:163]
    v_mfma_f32_16x16x32_bf16 v[164:167], v[100:103], v[24:27], v[164:167]
    v_mfma_f32_16x16x32_bf16 v[168:171], v[104:107], v[24:27], v[168:171]
    v_mfma_f32_16x16x32_bf16 v[172:175], v[108:111], v[24:27], v[172:175]
    v_mfma_f32_16x16x32_bf16 v[176:179], v[112:115], v[24:27], v[176:179]
    ds_read_b128 v[84:87], v2 offset:61440
    ds_read_b128 v[88:91], v5 offset:10240
    ds_read_b128 v[92:95], v5 offset:24576
    ds_read_b128 v[96:99], v5 offset:38912
    ds_read_b128 v[100:103], v5 offset:53248
    ds_read_b128 v[104:107], v13 offset:2048
    ds_read_b128 v[108:111], v2 offset:4096
    ds_read_b128 v[112:115], v2 offset:18432
    s_waitcnt lgkmcnt(8)
    v_mfma_f32_16x16x32_bf16 v[148:151], v[116:119], v[28:31], v[148:151]
    v_mfma_f32_16x16x32_bf16 v[152:155], v[120:123], v[28:31], v[152:155]
    v_mfma_f32_16x16x32_bf16 v[156:159], v[124:127], v[28:31], v[156:159]
    v_mfma_f32_16x16x32_bf16 v[160:163], v[128:131], v[28:31], v[160:163]
    v_mfma_f32_16x16x32_bf16 v[164:167], v[132:135], v[28:31], v[164:167]
    v_mfma_f32_16x16x32_bf16 v[168:171], v[136:139], v[28:31], v[168:171]
    v_mfma_f32_16x16x32_bf16 v[172:175], v[140:143], v[28:31], v[172:175]
    v_mfma_f32_16x16x32_bf16 v[176:179], v[144:147], v[28:31], v[176:179]
    ds_read_b128 v[116:119], v2 offset:62464
    ds_read_b128 v[120:123], v5 offset:11264
    ds_read_b128 v[124:127], v5 offset:25600
    ds_read_b128 v[128:131], v5 offset:39936
    ds_read_b128 v[132:135], v5 offset:54272
    ds_read_b128 v[136:139], v13 offset:3072
    ds_read_b128 v[140:143], v2 offset:5120
    ds_read_b128 v[144:147], v2 offset:19456
    s_waitcnt lgkmcnt(8)
    v_mfma_f32_16x16x32_bf16 v[148:151], v[84:87], v[32:35], v[148:151]
    v_mfma_f32_16x16x32_bf16 v[152:155], v[88:91], v[32:35], v[152:155]
    v_mfma_f32_16x16x32_bf16 v[156:159], v[92:95], v[32:35], v[156:159]
    v_mfma_f32_16x16x32_bf16 v[160:163], v[96:99], v[32:35], v[160:163]
    v_mfma_f32_16x16x32_bf16 v[164:167], v[100:103], v[32:35], v[164:167]
    v_mfma_f32_16x16x32_bf16 v[168:171], v[104:107], v[32:35], v[168:171]
    v_mfma_f32_16x16x32_bf16 v[172:175], v[108:111], v[32:35], v[172:175]
    v_mfma_f32_16x16x32_bf16 v[176:179], v[112:115], v[32:35], v[176:179]
    ds_read_b128 v[84:87], v2 offset:63488
    ds_read_b128 v[88:91], v5 offset:12288
    ds_read_b128 v[92:95], v5 offset:26624
    ds_read_b128 v[96:99], v5 offset:40960
    ds_read_b128 v[100:103], v5 offset:55296
    ds_read_b128 v[104:107], v13 offset:4096
    ds_read_b128 v[108:111], v2 offset:6144
    ds_read_b128 v[112:115], v2 offset:20480
    s_waitcnt lgkmcnt(8)
    v_mfma_f32_16x16x32_bf16 v[148:151], v[116:119], v[36:39], v[148:151]
    v_mfma_f32_16x16x32_bf16 v[152:155], v[120:123], v[36:39], v[152:155]
    v_mfma_f32_16x16x32_bf16 v[156:159], v[124:127], v[36:39], v[156:159]
    v_mfma_f32_16x16x32_bf16 v[160:163], v[128:131], v[36:39], v[160:163]
    v_mfma_f32_16x16x32_bf16 v[164:167], v[132:135], v[36:39], v[164:167]
    v_mfma_f32_16x16x32_bf16 v[168:171], v[136:139], v[36:39], v[168:171]
    v_mfma_f32_16x16x32_bf16 v[172:175], v[140:143], v[36:39], v[172:175]
    v_mfma_f32_16x16x32_bf16 v[176:179], v[144:147], v[36:39], v[176:179]
    ds_read_b128 v[116:119], v2 offset:64512
    ds_read_b128 v[120:123], v5 offset:13312
    ds_read_b128 v[124:127], v5 offset:27648
    ds_read_b128 v[128:131], v5 offset:41984
    ds_read_b128 v[132:135], v5 offset:56320
    ds_read_b128 v[136:139], v13 offset:5120
    ds_read_b128 v[140:143], v2 offset:7168
    ds_read_b128 v[144:147], v2 offset:21504
    s_waitcnt lgkmcnt(8)
    v_mfma_f32_16x16x32_bf16 v[148:151], v[84:87], v[40:43], v[148:151]
    v_mfma_f32_16x16x32_bf16 v[152:155], v[88:91], v[40:43], v[152:155]
    v_mfma_f32_16x16x32_bf16 v[156:159], v[92:95], v[40:43], v[156:159]
    v_mfma_f32_16x16x32_bf16 v[160:163], v[96:99], v[40:43], v[160:163]
    v_mfma_f32_16x16x32_bf16 v[164:167], v[100:103], v[40:43], v[164:167]
    v_mfma_f32_16x16x32_bf16 v[168:171], v[104:107], v[40:43], v[168:171]
    v_mfma_f32_16x16x32_bf16 v[172:175], v[108:111], v[40:43], v[172:175]
    v_mfma_f32_16x16x32_bf16 v[176:179], v[112:115], v[40:43], v[176:179]
    ds_read_b128 v[84:87], v5 offset:0
    ds_read_b128 v[88:91], v5 offset:14336
    ds_read_b128 v[92:95], v5 offset:28672
    ds_read_b128 v[96:99], v5 offset:43008
    ds_read_b128 v[100:103], v5 offset:57344
    ds_read_b128 v[104:107], v13 offset:6144
    ds_read_b128 v[108:111], v2 offset:8192
    ds_read_b128 v[112:115], v2 offset:22528
    s_waitcnt lgkmcnt(8)
    v_mfma_f32_16x16x32_bf16 v[148:151], v[116:119], v[44:47], v[148:151]
    v_mfma_f32_16x16x32_bf16 v[152:155], v[120:123], v[44:47], v[152:155]
    v_mfma_f32_16x16x32_bf16 v[156:159], v[124:127], v[44:47], v[156:159]
    v_mfma_f32_16x16x32_bf16 v[160:163], v[128:131], v[44:47], v[160:163]
    v_mfma_f32_16x16x32_bf16 v[164:167], v[132:135], v[44:47], v[164:167]
    v_mfma_f32_16x16x32_bf16 v[168:171], v[136:139], v[44:47], v[168:171]
    v_mfma_f32_16x16x32_bf16 v[172:175], v[140:143], v[44:47], v[172:175]
    v_mfma_f32_16x16x32_bf16 v[176:179], v[144:147], v[44:47], v[176:179]
    ds_read_b128 v[116:119], v5 offset:1024
    ds_read_b128 v[120:123], v5 offset:15360
    ds_read_b128 v[124:127], v5 offset:29696
    ds_read_b128 v[128:131], v5 offset:44032
    ds_read_b128 v[132:135], v5 offset:58368
    ds_read_b128 v[136:139], v13 offset:7168
    ds_read_b128 v[140:143], v2 offset:9216
    ds_read_b128 v[144:147], v2 offset:23552
    s_waitcnt lgkmcnt(8)
    v_mfma_f32_16x16x32_bf16 v[148:151], v[84:87], v[48:51], v[148:151]
    v_mfma_f32_16x16x32_bf16 v[152:155], v[88:91], v[48:51], v[152:155]
    v_mfma_f32_16x16x32_bf16 v[156:159], v[92:95], v[48:51], v[156:159]
    v_mfma_f32_16x16x32_bf16 v[160:163], v[96:99], v[48:51], v[160:163]
    v_mfma_f32_16x16x32_bf16 v[164:167], v[100:103], v[48:51], v[164:167]
    v_mfma_f32_16x16x32_bf16 v[168:171], v[104:107], v[48:51], v[168:171]
    v_mfma_f32_16x16x32_bf16 v[172:175], v[108:111], v[48:51], v[172:175]
    v_mfma_f32_16x16x32_bf16 v[176:179], v[112:115], v[48:51], v[176:179]
    ds_read_b128 v[84:87], v5 offset:2048
    ds_read_b128 v[88:91], v5 offset:16384
    ds_read_b128 v[92:95], v5 offset:30720
    ds_read_b128 v[96:99], v5 offset:45056
    ds_read_b128 v[100:103], v5 offset:59392
    ds_read_b128 v[104:107], v13 offset:8192
    ds_read_b128 v[108:111], v2 offset:10240
    ds_read_b128 v[112:115], v2 offset:24576
    s_waitcnt lgkmcnt(8)
    v_mfma_f32_16x16x32_bf16 v[148:151], v[116:119], v[52:55], v[148:151]
    v_mfma_f32_16x16x32_bf16 v[152:155], v[120:123], v[52:55], v[152:155]
    v_mfma_f32_16x16x32_bf16 v[156:159], v[124:127], v[52:55], v[156:159]
    v_mfma_f32_16x16x32_bf16 v[160:163], v[128:131], v[52:55], v[160:163]
    v_mfma_f32_16x16x32_bf16 v[164:167], v[132:135], v[52:55], v[164:167]
    v_mfma_f32_16x16x32_bf16 v[168:171], v[136:139], v[52:55], v[168:171]
    v_mfma_f32_16x16x32_bf16 v[172:175], v[140:143], v[52:55], v[172:175]
    v_mfma_f32_16x16x32_bf16 v[176:179], v[144:147], v[52:55], v[176:179]
    ds_read_b128 v[116:119], v5 offset:3072
    ds_read_b128 v[120:123], v5 offset:17408
    ds_read_b128 v[124:127], v5 offset:31744
    ds_read_b128 v[128:131], v5 offset:46080
    ds_read_b128 v[132:135], v5 offset:60416
    ds_read_b128 v[136:139], v13 offset:9216
    ds_read_b128 v[140:143], v2 offset:11264
    ds_read_b128 v[144:147], v2 offset:25600
    s_waitcnt lgkmcnt(8)
    v_mfma_f32_16x16x32_bf16 v[148:151], v[84:87], v[56:59], v[148:151]
    v_mfma_f32_16x16x32_bf16 v[152:155], v[88:91], v[56:59], v[152:155]
    v_mfma_f32_16x16x32_bf16 v[156:159], v[92:95], v[56:59], v[156:159]
    v_mfma_f32_16x16x32_bf16 v[160:163], v[96:99], v[56:59], v[160:163]
    v_mfma_f32_16x16x32_bf16 v[164:167], v[100:103], v[56:59], v[164:167]
    v_mfma_f32_16x16x32_bf16 v[168:171], v[104:107], v[56:59], v[168:171]
    v_mfma_f32_16x16x32_bf16 v[172:175], v[108:111], v[56:59], v[172:175]
    v_mfma_f32_16x16x32_bf16 v[176:179], v[112:115], v[56:59], v[176:179]
    ds_read_b128 v[84:87], v5 offset:4096
    ds_read_b128 v[88:91], v5 offset:18432
    ds_read_b128 v[92:95], v5 offset:32768
    ds_read_b128 v[96:99], v5 offset:47104
    ds_read_b128 v[100:103], v5 offset:61440
    ds_read_b128 v[104:107], v13 offset:10240
    ds_read_b128 v[108:111], v2 offset:12288
    ds_read_b128 v[112:115], v2 offset:26624
    s_waitcnt lgkmcnt(8)
    v_mfma_f32_16x16x32_bf16 v[148:151], v[116:119], v[60:63], v[148:151]
    v_mfma_f32_16x16x32_bf16 v[152:155], v[120:123], v[60:63], v[152:155]
    v_mfma_f32_16x16x32_bf16 v[156:159], v[124:127], v[60:63], v[156:159]
    v_mfma_f32_16x16x32_bf16 v[160:163], v[128:131], v[60:63], v[160:163]
    v_mfma_f32_16x16x32_bf16 v[164:167], v[132:135], v[60:63], v[164:167]
    v_mfma_f32_16x16x32_bf16 v[168:171], v[136:139], v[60:63], v[168:171]
    v_mfma_f32_16x16x32_bf16 v[172:175], v[140:143], v[60:63], v[172:175]
    v_mfma_f32_16x16x32_bf16 v[176:179], v[144:147], v[60:63], v[176:179]
    ds_read_b128 v[116:119], v5 offset:5120
    ds_read_b128 v[120:123], v5 offset:19456
    ds_read_b128 v[124:127], v5 offset:33792
    ds_read_b128 v[128:131], v5 offset:48128
    ds_read_b128 v[132:135], v5 offset:62464
    ds_read_b128 v[136:139], v13 offset:11264
    ds_read_b128 v[140:143], v2 offset:13312
    ds_read_b128 v[144:147], v2 offset:27648
    s_waitcnt lgkmcnt(8)
    v_mfma_f32_16x16x32_bf16 v[148:151], v[84:87], v[64:67], v[148:151]
    v_mfma_f32_16x16x32_bf16 v[152:155], v[88:91], v[64:67], v[152:155]
    v_mfma_f32_16x16x32_bf16 v[156:159], v[92:95], v[64:67], v[156:159]
    v_mfma_f32_16x16x32_bf16 v[160:163], v[96:99], v[64:67], v[160:163]
    v_mfma_f32_16x16x32_bf16 v[164:167], v[100:103], v[64:67], v[164:167]
    v_mfma_f32_16x16x32_bf16 v[168:171], v[104:107], v[64:67], v[168:171]
    v_mfma_f32_16x16x32_bf16 v[172:175], v[108:111], v[64:67], v[172:175]
    v_mfma_f32_16x16x32_bf16 v[176:179], v[112:115], v[64:67], v[176:179]
    s_waitcnt lgkmcnt(0)
    v_mfma_f32_16x16x32_bf16 v[148:151], v[116:119], v[68:71], v[148:151]
    v_mfma_f32_16x16x32_bf16 v[152:155], v[120:123], v[68:71], v[152:155]
    v_mfma_f32_16x16x32_bf16 v[156:159], v[124:127], v[68:71], v[156:159]
    v_mfma_f32_16x16x32_bf16 v[160:163], v[128:131], v[68:71], v[160:163]
    v_mfma_f32_16x16x32_bf16 v[164:167], v[132:135], v[68:71], v[164:167]
    v_mfma_f32_16x16x32_bf16 v[168:171], v[136:139], v[68:71], v[168:171]
    v_mfma_f32_16x16x32_bf16 v[172:175], v[140:143], v[68:71], v[172:175]
    v_mfma_f32_16x16x32_bf16 v[176:179], v[144:147], v[68:71], v[176:179]
    s_nop 0
    v_cvt_pk_bf16_f32 v149, v148, v149
    v_lshlrev_b32 v148, 16, v149
    v_and_b32 v149, 0xffff0000, v149
    v_cvt_pk_bf16_f32 v151, v150, v151
    v_lshlrev_b32 v150, 16, v151
    v_and_b32 v151, 0xffff0000, v151
    v_cvt_pk_bf16_f32 v153, v152, v153
    v_lshlrev_b32 v152, 16, v153
    v_and_b32 v153, 0xffff0000, v153
    v_cvt_pk_bf16_f32 v155, v154, v155
    v_lshlrev_b32 v154, 16, v155
    v_and_b32 v155, 0xffff0000, v155
    v_cvt_pk_bf16_f32 v157, v156, v157
    v_lshlrev_b32 v156, 16, v157
    v_and_b32 v157, 0xffff0000, v157
    v_cvt_pk_bf16_f32 v159, v158, v159
    v_lshlrev_b32 v158, 16, v159
    v_and_b32 v159, 0xffff0000, v159
    v_cvt_pk_bf16_f32 v161, v160, v161
    v_lshlrev_b32 v160, 16, v161
    v_and_b32 v161, 0xffff0000, v161
    v_cvt_pk_bf16_f32 v163, v162, v163
    v_lshlrev_b32 v162, 16, v163
    v_and_b32 v163, 0xffff0000, v163
    v_cvt_pk_bf16_f32 v165, v164, v165
    v_lshlrev_b32 v164, 16, v165
    v_and_b32 v165, 0xffff0000, v165
    v_cvt_pk_bf16_f32 v167, v166, v167
    v_lshlrev_b32 v166, 16, v167
    v_and_b32 v167, 0xffff0000, v167
    v_cvt_pk_bf16_f32 v169, v168, v169
    v_lshlrev_b32 v168, 16, v169
    v_and_b32 v169, 0xffff0000, v169
    v_cvt_pk_bf16_f32 v171, v170, v171
    v_lshlrev_b32 v170, 16, v171
    v_and_b32 v171, 0xffff0000, v171
    v_cvt_pk_bf16_f32 v173, v172, v173
    v_lshlrev_b32 v172, 16, v173
    v_and_b32 v173, 0xffff0000, v173
    v_cvt_pk_bf16_f32 v175, v174, v175
    v_lshlrev_b32 v174, 16, v175
    v_and_b32 v175, 0xffff0000, v175
    v_cvt_pk_bf16_f32 v177, v176, v177
    v_lshlrev_b32 v176, 16, v177
    v_and_b32 v177, 0xffff0000, v177
    v_cvt_pk_bf16_f32 v179, v178, v179
    v_lshlrev_b32 v178, 16, v179
    v_and_b32 v179, 0xffff0000, v179
    v_mul_f32 v32, v148, v148
    v_mul_f32 v33, v149, v149
    v_mul_f32 v34, v150, v150
    v_mul_f32 v35, v151, v151
    v_fma_f32 v32, v32, s90, 1.0
    v_fma_f32 v33, v33, s90, 1.0
    v_fma_f32 v34, v34, s90, 1.0
    v_fma_f32 v35, v35, s90, 1.0
    v_mul_f32 v32, v32, v148
    v_mul_f32 v33, v33, v149
    v_mul_f32 v34, v34, v150
    v_mul_f32 v35, v35, v151
    v_mul_f32 v32, s91, v32
    v_mul_f32 v33, s91, v33
    v_mul_f32 v34, s91, v34
    v_mul_f32 v35, s91, v35
    v_exp_f32 v32, v32
    v_exp_f32 v33, v33
    v_exp_f32 v34, v34
    v_exp_f32 v35, v35
    v_add_f32 v32, 1.0, v32
    v_add_f32 v33, 1.0, v33
    v_add_f32 v34, 1.0, v34
    v_add_f32 v35, 1.0, v35
    v_rcp_f32 v32, v32
    v_rcp_f32 v33, v33
    v_rcp_f32 v34, v34
    v_rcp_f32 v35, v35
    v_mul_f32 v148, v148, v32
    v_mul_f32 v149, v149, v33
    v_mul_f32 v150, v150, v34
    v_mul_f32 v151, v151, v35
    v_mul_f32 v32, v152, v152
    v_mul_f32 v33, v153, v153
    v_mul_f32 v34, v154, v154
    v_mul_f32 v35, v155, v155
    v_fma_f32 v32, v32, s90, 1.0
    v_fma_f32 v33, v33, s90, 1.0
    v_fma_f32 v34, v34, s90, 1.0
    v_fma_f32 v35, v35, s90, 1.0
    v_mul_f32 v32, v32, v152
    v_mul_f32 v33, v33, v153
    v_mul_f32 v34, v34, v154
    v_mul_f32 v35, v35, v155
    v_mul_f32 v32, s91, v32
    v_mul_f32 v33, s91, v33
    v_mul_f32 v34, s91, v34
    v_mul_f32 v35, s91, v35
    v_exp_f32 v32, v32
    v_exp_f32 v33, v33
    v_exp_f32 v34, v34
    v_exp_f32 v35, v35
    v_add_f32 v32, 1.0, v32
    v_add_f32 v33, 1.0, v33
    v_add_f32 v34, 1.0, v34
    v_add_f32 v35, 1.0, v35
    v_rcp_f32 v32, v32
    v_rcp_f32 v33, v33
    v_rcp_f32 v34, v34
    v_rcp_f32 v35, v35
    v_mul_f32 v152, v152, v32
    v_mul_f32 v153, v153, v33
    v_mul_f32 v154, v154, v34
    v_mul_f32 v155, v155, v35
    v_mul_f32 v32, v156, v156
    v_mul_f32 v33, v157, v157
    v_mul_f32 v34, v158, v158
    v_mul_f32 v35, v159, v159
    v_fma_f32 v32, v32, s90, 1.0
    v_fma_f32 v33, v33, s90, 1.0
    v_fma_f32 v34, v34, s90, 1.0
    v_fma_f32 v35, v35, s90, 1.0
    v_mul_f32 v32, v32, v156
    v_mul_f32 v33, v33, v157
    v_mul_f32 v34, v34, v158
    v_mul_f32 v35, v35, v159
    v_mul_f32 v32, s91, v32
    v_mul_f32 v33, s91, v33
    v_mul_f32 v34, s91, v34
    v_mul_f32 v35, s91, v35
    v_exp_f32 v32, v32
    v_exp_f32 v33, v33
    v_exp_f32 v34, v34
    v_exp_f32 v35, v35
    v_add_f32 v32, 1.0, v32
    v_add_f32 v33, 1.0, v33
    v_add_f32 v34, 1.0, v34
    v_add_f32 v35, 1.0, v35
    v_rcp_f32 v32, v32
    v_rcp_f32 v33, v33
    v_rcp_f32 v34, v34
    v_rcp_f32 v35, v35
    v_mul_f32 v156, v156, v32
    v_mul_f32 v157, v157, v33
    v_mul_f32 v158, v158, v34
    v_mul_f32 v159, v159, v35
    v_mul_f32 v32, v160, v160
    v_mul_f32 v33, v161, v161
    v_mul_f32 v34, v162, v162
    v_mul_f32 v35, v163, v163
    v_fma_f32 v32, v32, s90, 1.0
    v_fma_f32 v33, v33, s90, 1.0
    v_fma_f32 v34, v34, s90, 1.0
    v_fma_f32 v35, v35, s90, 1.0
    v_mul_f32 v32, v32, v160
    v_mul_f32 v33, v33, v161
    v_mul_f32 v34, v34, v162
    v_mul_f32 v35, v35, v163
    v_mul_f32 v32, s91, v32
    v_mul_f32 v33, s91, v33
    v_mul_f32 v34, s91, v34
    v_mul_f32 v35, s91, v35
    v_exp_f32 v32, v32
    v_exp_f32 v33, v33
    v_exp_f32 v34, v34
    v_exp_f32 v35, v35
    v_add_f32 v32, 1.0, v32
    v_add_f32 v33, 1.0, v33
    v_add_f32 v34, 1.0, v34
    v_add_f32 v35, 1.0, v35
    v_rcp_f32 v32, v32
    v_rcp_f32 v33, v33
    v_rcp_f32 v34, v34
    v_rcp_f32 v35, v35
    v_mul_f32 v160, v160, v32
    v_mul_f32 v161, v161, v33
    v_mul_f32 v162, v162, v34
    v_mul_f32 v163, v163, v35
    v_mul_f32 v32, v164, v164
    v_mul_f32 v33, v165, v165
    v_mul_f32 v34, v166, v166
    v_mul_f32 v35, v167, v167
    v_fma_f32 v32, v32, s90, 1.0
    v_fma_f32 v33, v33, s90, 1.0
    v_fma_f32 v34, v34, s90, 1.0
    v_fma_f32 v35, v35, s90, 1.0
    v_mul_f32 v32, v32, v164
    v_mul_f32 v33, v33, v165
    v_mul_f32 v34, v34, v166
    v_mul_f32 v35, v35, v167
    v_mul_f32 v32, s91, v32
    v_mul_f32 v33, s91, v33
    v_mul_f32 v34, s91, v34
    v_mul_f32 v35, s91, v35
    v_exp_f32 v32, v32
    v_exp_f32 v33, v33
    v_exp_f32 v34, v34
    v_exp_f32 v35, v35
    v_add_f32 v32, 1.0, v32
    v_add_f32 v33, 1.0, v33
    v_add_f32 v34, 1.0, v34
    v_add_f32 v35, 1.0, v35
    v_rcp_f32 v32, v32
    v_rcp_f32 v33, v33
    v_rcp_f32 v34, v34
    v_rcp_f32 v35, v35
    v_mul_f32 v164, v164, v32
    v_mul_f32 v165, v165, v33
    v_mul_f32 v166, v166, v34
    v_mul_f32 v167, v167, v35
    v_mul_f32 v32, v168, v168
    v_mul_f32 v33, v169, v169
    v_mul_f32 v34, v170, v170
    v_mul_f32 v35, v171, v171
    v_fma_f32 v32, v32, s90, 1.0
    v_fma_f32 v33, v33, s90, 1.0
    v_fma_f32 v34, v34, s90, 1.0
    v_fma_f32 v35, v35, s90, 1.0
    v_mul_f32 v32, v32, v168
    v_mul_f32 v33, v33, v169
    v_mul_f32 v34, v34, v170
    v_mul_f32 v35, v35, v171
    v_mul_f32 v32, s91, v32
    v_mul_f32 v33, s91, v33
    v_mul_f32 v34, s91, v34
    v_mul_f32 v35, s91, v35
    v_exp_f32 v32, v32
    v_exp_f32 v33, v33
    v_exp_f32 v34, v34
    v_exp_f32 v35, v35
    v_add_f32 v32, 1.0, v32
    v_add_f32 v33, 1.0, v33
    v_add_f32 v34, 1.0, v34
    v_add_f32 v35, 1.0, v35
    v_rcp_f32 v32, v32
    v_rcp_f32 v33, v33
    v_rcp_f32 v34, v34
    v_rcp_f32 v35, v35
    v_mul_f32 v168, v168, v32
    v_mul_f32 v169, v169, v33
    v_mul_f32 v170, v170, v34
    v_mul_f32 v171, v171, v35
    v_mul_f32 v32, v172, v172
    v_mul_f32 v33, v173, v173
    v_mul_f32 v34, v174, v174
    v_mul_f32 v35, v175, v175
    v_fma_f32 v32, v32, s90, 1.0
    v_fma_f32 v33, v33, s90, 1.0
    v_fma_f32 v34, v34, s90, 1.0
    v_fma_f32 v35, v35, s90, 1.0
    v_mul_f32 v32, v32, v172
    v_mul_f32 v33, v33, v173
    v_mul_f32 v34, v34, v174
    v_mul_f32 v35, v35, v175
    v_mul_f32 v32, s91, v32
    v_mul_f32 v33, s91, v33
    v_mul_f32 v34, s91, v34
    v_mul_f32 v35, s91, v35
    v_exp_f32 v32, v32
    v_exp_f32 v33, v33
    v_exp_f32 v34, v34
    v_exp_f32 v35, v35
    v_add_f32 v32, 1.0, v32
    v_add_f32 v33, 1.0, v33
    v_add_f32 v34, 1.0, v34
    v_add_f32 v35, 1.0, v35
    v_rcp_f32 v32, v32
    v_rcp_f32 v33, v33
    v_rcp_f32 v34, v34
    v_rcp_f32 v35, v35
    v_mul_f32 v172, v172, v32
    v_mul_f32 v173, v173, v33
    v_mul_f32 v174, v174, v34
    v_mul_f32 v175, v175, v35
    v_mul_f32 v32, v176, v176
    v_mul_f32 v33, v177, v177
    v_mul_f32 v34, v178, v178
    v_mul_f32 v35, v179, v179
    v_fma_f32 v32, v32, s90, 1.0
    v_fma_f32 v33, v33, s90, 1.0
    v_fma_f32 v34, v34, s90, 1.0
    v_fma_f32 v35, v35, s90, 1.0
    v_mul_f32 v32, v32, v176
    v_mul_f32 v33, v33, v177
    v_mul_f32 v34, v34, v178
    v_mul_f32 v35, v35, v179
    v_mul_f32 v32, s91, v32
    v_mul_f32 v33, s91, v33
    v_mul_f32 v34, s91, v34
    v_mul_f32 v35, s91, v35
    v_exp_f32 v32, v32
    v_exp_f32 v33, v33
    v_exp_f32 v34, v34
    v_exp_f32 v35, v35
    v_add_f32 v32, 1.0, v32
    v_add_f32 v33, 1.0, v33
    v_add_f32 v34, 1.0, v34
    v_add_f32 v35, 1.0, v35
    v_rcp_f32 v32, v32
    v_rcp_f32 v33, v33
    v_rcp_f32 v34, v34
    v_rcp_f32 v35, v35
    v_mul_f32 v176, v176, v32
    v_mul_f32 v177, v177, v33
    v_mul_f32 v178, v178, v34
    v_mul_f32 v179, v179, v35
    v_cvt_pk_bf16_f32 v16, v148, v149
    v_cvt_pk_bf16_f32 v17, v150, v151
    v_cvt_pk_bf16_f32 v18, v152, v153
    v_cvt_pk_bf16_f32 v19, v154, v155
    v_cvt_pk_bf16_f32 v20, v156, v157
    v_cvt_pk_bf16_f32 v21, v158, v159
    v_cvt_pk_bf16_f32 v22, v160, v161
    v_cvt_pk_bf16_f32 v23, v162, v163
    v_cvt_pk_bf16_f32 v24, v164, v165
    v_cvt_pk_bf16_f32 v25, v166, v167
    v_cvt_pk_bf16_f32 v26, v168, v169
    v_cvt_pk_bf16_f32 v27, v170, v171
    v_cvt_pk_bf16_f32 v28, v172, v173
    v_cvt_pk_bf16_f32 v29, v174, v175
    v_cvt_pk_bf16_f32 v30, v176, v177
    v_cvt_pk_bf16_f32 v31, v178, v179
    s_mul_i32 s44, s47, 56
    s_lshl_b32 s45, s83, 2
    s_add_u32 s44, s44, s45
    s_lshl_b32 s44, s44, 10
    buffer_store_dwordx4 v[16:19], v2, s[20:23], s44 offen offset:0
    buffer_store_dwordx4 v[20:23], v2, s[20:23], s44 offen offset:1024
    buffer_store_dwordx4 v[24:27], v2, s[20:23], s44 offen offset:2048
    buffer_store_dwordx4 v[28:31], v2, s[20:23], s44 offen offset:3072
    s_lshl_b32 s40, s82, 4
    s_add_u32 s40, s40, s83
    s_add_u32 s40, s40, 1280
    s_waitcnt vmcnt(0)
    s_barrier
    s_cmp_lg_u32 s3, 0
    s_cbranch_scc1 L_sig_113
    s_add_u32 s28, s94, 7921664
    s_addc_u32 s29, s95, 0
    s_mov_b32 s30, 16384
    s_mov_b32 s31, 0x00020000
    s_lshl_b32 s48, s40, 2
    v_mov_b32 v6, 1
    v_mov_b32 v7, s48
    s_mov_b64 exec, 1
    s_cmp_lg_u32 s80, 0
    s_cbranch_scc1 L_sigfb_114
    buffer_store_dword v6, v7, s[28:31], 0 offen
    s_nop 1
    s_branch L_sigj_115
L_sigfb_114:
    buffer_wbl2 sc1
    s_waitcnt vmcnt(0)
    buffer_store_dword v6, v7, s[28:31], 0 offen sc1
    s_nop 1
L_sigj_115:
    s_mov_b64 exec, -1
L_sig_113:
    s_mul_i32 s44, s85, 229376
    s_add_u32 s12, s94, s44
    s_addc_u32 s13, s95, 0
    s_add_u32 s12, s12, 4218880
    s_addc_u32 s13, s13, 0
    s_mov_b32 s14, 229376
    s_mov_b32 s15, 0x00020000
    s_lshr_b32 s44, s3, 1
    s_and_b32 s45, s3, 1
    s_mul_i32 s46, s44, 56
    s_mul_i32 s47, s45, 28
    s_add_u32 s46, s46, s47
    s_lshl_b32 s46, s46, 10
    s_lshl_b32 s47, s3, 12
    s_add_u32 s44, s46, 0
    s_add_u32 s45, s47, 0
    s_mov_b32 m0, s45
    s_nop 0
    buffer_load_dwordx4 v2, s[12:15], s44 offen offset:0 lds
    buffer_load_dwordx4 v2, s[12:15], s44 offen offset:1024 lds
    buffer_load_dwordx4 v2, s[12:15], s44 offen offset:2048 lds
    buffer_load_dwordx4 v2, s[12:15], s44 offen offset:3072 lds
    s_add_u32 s44, s46, 4096
    s_add_u32 s45, s47, 32768
    s_mov_b32 m0, s45
    s_nop 0
    buffer_load_dwordx4 v2, s[12:15], s44 offen offset:0 lds
    buffer_load_dwordx4 v2, s[12:15], s44 offen offset:1024 lds
    buffer_load_dwordx4 v2, s[12:15], s44 offen offset:2048 lds
    buffer_load_dwordx4 v2, s[12:15], s44 offen offset:3072 lds
    s_add_u32 s44, s46, 8192
    s_add_u32 s45, s47, 65536
    s_mov_b32 m0, s45
    s_nop 0
    buffer_load_dwordx4 v2, s[12:15], s44 offen offset:0 lds
    buffer_load_dwordx4 v2, s[12:15], s44 offen offset:1024 lds
    buffer_load_dwordx4 v2, s[12:15], s44 offen offset:2048 lds
    buffer_load_dwordx4 v2, s[12:15], s44 offen offset:3072 lds
    s_add_u32 s44, s46, 12288
    s_add_u32 s45, s47, 98304
    s_mov_b32 m0, s45
    s_nop 0
    buffer_load_dwordx4 v2, s[12:15], s44 offen offset:0 lds
    buffer_load_dwordx4 v2, s[12:15], s44 offen offset:1024 lds
    buffer_load_dwordx4 v2, s[12:15], s44 offen offset:2048 lds
    buffer_load_dwordx4 v2, s[12:15], s44 offen offset:3072 lds
    s_lshr_b32 s40, s84, 1
    s_lshl_b32 s40, s40, 4
    s_add_u32 s40, s40, 1280
    s_cmp_lg_u32 s3, 0
    s_cbranch_scc1 L_wsk_116
    s_add_u32 s28, s94, 7921664
    s_addc_u32 s29, s95, 0
    s_mov_b32 s30, 16384
    s_mov_b32 s31, 0x00020000
    s_mov_b32 s50, 0
    v_add_u32 v6, s40, v1
    v_cmp_le_u32 s[48:49], 14, v1
    v_lshlrev_b32 v6, 2, v6
    s_nop 0
    v_cndmask_b32 v6, v6, 0, s[48:49]
    s_nop 1
L_wlp_117:
    buffer_load_dword v8, v6, s[28:31], 0 offen sc1
    s_waitcnt vmcnt(0)
    v_cmp_ne_u32 vcc, 0, v8
    s_nop 0
    s_or_b64 vcc, vcc, s[48:49]
    s_cmp_eq_u64 vcc, -1
    s_nop 1
    s_cbranch_scc1 L_wdn_118
    s_sleep 1
    s_add_u32 s50, s50, 1
    s_cmp_lt_u32 s50, 65536
    s_cbranch_scc1 L_wlp_117
L_wdn_118:
    s_cmp_eq_u32 s80, 0
    s_cbranch_scc1 L_wsk_116
    buffer_inv sc1
    s_waitcnt vmcnt(0)
L_wsk_116:
    s_barrier
    s_add_u32 s8, s94, 26288128
    s_addc_u32 s9, s95, 0
    s_mov_b32 s10, 7340032
    s_mov_b32 s11, 0x00020000
    s_add_u32 s16, s94, 22618112
    s_addc_u32 s17, s95, 0
    s_mov_b32 s18, 1835008
    s_mov_b32 s19, 0x00020000
    s_add_u32 s20, s94, 11608064
    s_addc_u32 s21, s95, 0
    s_mov_b32 s22, 1835008
    s_mov_b32 s23, 0x00020000
    s_add_u32 s24, s94, 40968192
    s_addc_u32 s25, s95, 0
    s_mov_b32 s26, 1835008
    s_mov_b32 s27, 0x00020000
    s_mul_i32 s44, s85, 229376
    s_add_u32 s12, s94, s44
    s_addc_u32 s13, s95, 0
    s_add_u32 s12, s12, 4218880
    s_addc_u32 s13, s13, 0
    s_mov_b32 s14, 229376
    s_mov_b32 s15, 0x00020000
    s_lshr_b32 s44, s3, 1
    s_and_b32 s45, s3, 1
    s_mul_i32 s46, s44, 56
    s_mul_i32 s47, s45, 28
    s_add_u32 s46, s46, s47
    s_lshl_b32 s46, s46, 10
    s_lshl_b32 s47, s3, 12
    s_lshl_b32 s43, s84, 2
    s_add_u32 s43, s43, s88
    s_mul_i32 s43, s43, 56
    s_mul_i32 s45, s89, 28
    s_add_u32 s43, s43, s45
    s_lshl_b32 s43, s43, 10
    s_add_u32 s44, s43, 0
    buffer_load_dwordx4 v[16:19], v2, s[8:11], s44 offen offset:0
    buffer_load_dwordx4 v[20:23], v2, s[8:11], s44 offen offset:1024
    buffer_load_dwordx4 v[24:27], v2, s[8:11], s44 offen offset:2048
    buffer_load_dwordx4 v[28:31], v2, s[8:11], s44 offen offset:3072
    s_add_u32 s44, s43, 4096
    buffer_load_dwordx4 v[32:35], v2, s[8:11], s44 offen offset:0
    buffer_load_dwordx4 v[36:39], v2, s[8:11], s44 offen offset:1024
    buffer_load_dwordx4 v[40:43], v2, s[8:11], s44 offen offset:2048
    buffer_load_dwordx4 v[44:47], v2, s[8:11], s44 offen offset:3072
    s_lshl_b32 s41, s84, 2
    s_add_u32 s41, s41, s88
    s_mul_i32 s41, s41, 14
    s_lshl_b32 s45, s85, 1
    s_add_u32 s41, s41, s45
    s_add_u32 s41, s41, s89
    s_lshl_b32 s41, s41, 10
    buffer_load_dwordx4 v[176:179], v2, s[16:19], s41 offen
    buffer_load_dwordx4 v[180:183], v2, s[20:23], s41 offen
    s_lshl_b32 s44, s89, 12
    v_add_u32 v8, s44, v2
    v_add_u32 v9, 65536, v8
    s_add_u32 s44, s43, 8192
    buffer_load_dwordx4 v[48:51], v2, s[8:11], s44 offen offset:0
    buffer_load_dwordx4 v[52:55], v2, s[8:11], s44 offen offset:1024
    buffer_load_dwordx4 v[56:59], v2, s[8:11], s44 offen offset:2048
    buffer_load_dwordx4 v[60:63], v2, s[8:11], s44 offen offset:3072
    s_waitcnt vmcnt(10)
    s_barrier
    ds_read_b128 v[144:147], v8 offset:0
    ds_read_b128 v[148:151], v8 offset:8192
    ds_read_b128 v[152:155], v8 offset:16384
    ds_read_b128 v[156:159], v8 offset:24576
    ds_read_b128 v[160:163], v8 offset:1024
    ds_read_b128 v[164:167], v8 offset:9216
    ds_read_b128 v[168:171], v8 offset:17408
    ds_read_b128 v[172:175], v8 offset:25600
    s_waitcnt lgkmcnt(4)
    v_mfma_f32_16x16x32_bf16 v[128:131], v[144:147], v[16:19], 0
    v_mfma_f32_16x16x32_bf16 v[132:135], v[148:151], v[16:19], 0
    v_mfma_f32_16x16x32_bf16 v[136:139], v[152:155], v[16:19], 0
    v_mfma_f32_16x16x32_bf16 v[140:143], v[156:159], v[16:19], 0
    ds_read_b128 v[144:147], v8 offset:2048
    ds_read_b128 v[148:151], v8 offset:10240
    ds_read_b128 v[152:155], v8 offset:18432
    ds_read_b128 v[156:159], v8 offset:26624
    s_waitcnt lgkmcnt(4)
    v_mfma_f32_16x16x32_bf16 v[128:131], v[160:163], v[20:23], v[128:131]
    v_mfma_f32_16x16x32_bf16 v[132:135], v[164:167], v[20:23], v[132:135]
    v_mfma_f32_16x16x32_bf16 v[136:139], v[168:171], v[20:23], v[136:139]
    v_mfma_f32_16x16x32_bf16 v[140:143], v[172:175], v[20:23], v[140:143]
    ds_read_b128 v[160:163], v8 offset:3072
    ds_read_b128 v[164:167], v8 offset:11264
    ds_read_b128 v[168:171], v8 offset:19456
    ds_read_b128 v[172:175], v8 offset:27648
    s_waitcnt lgkmcnt(4)
    v_mfma_f32_16x16x32_bf16 v[128:131], v[144:147], v[24:27], v[128:131]
    v_mfma_f32_16x16x32_bf16 v[132:135], v[148:151], v[24:27], v[132:135]
    v_mfma_f32_16x16x32_bf16 v[136:139], v[152:155], v[24:27], v[136:139]
    v_mfma_f32_16x16x32_bf16 v[140:143], v[156:159], v[24:27], v[140:143]
    s_waitcnt lgkmcnt(0)
    v_mfma_f32_16x16x32_bf16 v[128:131], v[160:163], v[28:31], v[128:131]
    v_mfma_f32_16x16x32_bf16 v[132:135], v[164:167], v[28:31], v[132:135]
    v_mfma_f32_16x16x32_bf16 v[136:139], v[168:171], v[28:31], v[136:139]
    v_mfma_f32_16x16x32_bf16 v[140:143], v[172:175], v[28:31], v[140:143]
    s_add_u32 s44, s43, 12288
    buffer_load_dwordx4 v[64:67], v2, s[8:11], s44 offen offset:0
    buffer_load_dwordx4 v[68:71], v2, s[8:11], s44 offen offset:1024
    buffer_load_dwordx4 v[72:75], v2, s[8:11], s44 offen offset:2048
    buffer_load_dwordx4 v[76:79], v2, s[8:11], s44 offen offset:3072
    s_waitcnt vmcnt(10)
    s_barrier
    s_add_u32 s44, s46, 16384
    s_add_u32 s45, s47, 0
    s_mov_b32 m0, s45
    s_nop 0
    buffer_load_dwordx4 v2, s[12:15], s44 offen offset:0 lds
    buffer_load_dwordx4 v2, s[12:15], s44 offen offset:1024 lds
    buffer_load_dwordx4 v2, s[12:15], s44 offen offset:2048 lds
    buffer_load_dwordx4 v2, s[12:15], s44 offen offset:3072 lds
    ds_read_b128 v[144:147], v8 offset:32768
    ds_read_b128 v[148:151], v8 offset:40960
    ds_read_b128 v[152:155], v8 offset:49152
    ds_read_b128 v[156:159], v8 offset:57344
    ds_read_b128 v[160:163], v8 offset:33792
    ds_read_b128 v[164:167], v8 offset:41984
    ds_read_b128 v[168:171], v8 offset:50176
    ds_read_b128 v[172:175], v8 offset:58368
    s_waitcnt lgkmcnt(4)
    v_mfma_f32_16x16x32_bf16 v[128:131], v[144:147], v[32:35], v[128:131]
    v_mfma_f32_16x16x32_bf16 v[132:135], v[148:151], v[32:35], v[132:135]
    v_mfma_f32_16x16x32_bf16 v[136:139], v[152:155], v[32:35], v[136:139]
    v_mfma_f32_16x16x32_bf16 v[140:143], v[156:159], v[32:35], v[140:143]
    ds_read_b128 v[144:147], v8 offset:34816
    ds_read_b128 v[148:151], v8 offset:43008
    ds_read_b128 v[152:155], v8 offset:51200
    ds_read_b128 v[156:159], v8 offset:59392
    s_waitcnt lgkmcnt(4)
    v_mfma_f32_16x16x32_bf16 v[128:131], v[160:163], v[36:39], v[128:131]
    v_mfma_f32_16x16x32_bf16 v[132:135], v[164:167], v[36:39], v[132:135]
    v_mfma_f32_16x16x32_bf16 v[136:139], v[168:171], v[36:39], v[136:139]
    v_mfma_f32_16x16x32_bf16 v[140:143], v[172:175], v[36:39], v[140:143]
    ds_read_b128 v[160:163], v8 offset:35840
    ds_read_b128 v[164:167], v8 offset:44032
    ds_read_b128 v[168:171], v8 offset:52224
    ds_read_b128 v[172:175], v8 offset:60416
    s_waitcnt lgkmcnt(4)
    v_mfma_f32_16x16x32_bf16 v[128:131], v[144:147], v[40:43], v[128:131]
    v_mfma_f32_16x16x32_bf16 v[132:135], v[148:151], v[40:43], v[132:135]
    v_mfma_f32_16x16x32_bf16 v[136:139], v[152:155], v[40:43], v[136:139]
    v_mfma_f32_16x16x32_bf16 v[140:143], v[156:159], v[40:43], v[140:143]
    s_waitcnt lgkmcnt(0)
    v_mfma_f32_16x16x32_bf16 v[128:131], v[160:163], v[44:47], v[128:131]
    v_mfma_f32_16x16x32_bf16 v[132:135], v[164:167], v[44:47], v[132:135]
    v_mfma_f32_16x16x32_bf16 v[136:139], v[168:171], v[44:47], v[136:139]
    v_mfma_f32_16x16x32_bf16 v[140:143], v[172:175], v[44:47], v[140:143]
    s_add_u32 s44, s43, 16384
    buffer_load_dwordx4 v[80:83], v2, s[8:11], s44 offen offset:0
    buffer_load_dwordx4 v[84:87], v2, s[8:11], s44 offen offset:1024
    buffer_load_dwordx4 v[88:91], v2, s[8:11], s44 offen offset:2048
    buffer_load_dwordx4 v[92:95], v2, s[8:11], s44 offen offset:3072
    s_waitcnt vmcnt(12)
    s_barrier
    s_add_u32 s44, s46, 20480
    s_add_u32 s45, s47, 32768
    s_mov_b32 m0, s45
    s_nop 0
    buffer_load_dwordx4 v2, s[12:15], s44 offen offset:0 lds
    buffer_load_dwordx4 v2, s[12:15], s44 offen offset:1024 lds
    buffer_load_dwordx4 v2, s[12:15], s44 offen offset:2048 lds
    buffer_load_dwordx4 v2, s[12:15], s44 offen offset:3072 lds
    ds_read_b128 v[144:147], v9 offset:0
    ds_read_b128 v[148:151], v9 offset:8192
    ds_read_b128 v[152:155], v9 offset:16384
    ds_read_b128 v[156:159], v9 offset:24576
    ds_read_b128 v[160:163], v9 offset:1024
    ds_read_b128 v[164:167], v9 offset:9216
    ds_read_b128 v[168:171], v9 offset:17408
    ds_read_b128 v[172:175], v9 offset:25600
    s_waitcnt lgkmcnt(4)
    v_mfma_f32_16x16x32_bf16 v[128:131], v[144:147], v[48:51], v[128:131]
    v_mfma_f32_16x16x32_bf16 v[132:135], v[148:151], v[48:51], v[132:135]
    v_mfma_f32_16x16x32_bf16 v[136:139], v[152:155], v[48:51], v[136:139]
    v_mfma_f32_16x16x32_bf16 v[140:143], v[156:159], v[48:51], v[140:143]
    ds_read_b128 v[144:147], v9 offset:2048
    ds_read_b128 v[148:151], v9 offset:10240
    ds_read_b128 v[152:155], v9 offset:18432
    ds_read_b128 v[156:159], v9 offset:26624
    s_waitcnt lgkmcnt(4)
    v_mfma_f32_16x16x32_bf16 v[128:131], v[160:163], v[52:55], v[128:131]
    v_mfma_f32_16x16x32_bf16 v[132:135], v[164:167], v[52:55], v[132:135]
    v_mfma_f32_16x16x32_bf16 v[136:139], v[168:171], v[52:55], v[136:139]
    v_mfma_f32_16x16x32_bf16 v[140:143], v[172:175], v[52:55], v[140:143]
    ds_read_b128 v[160:163], v9 offset:3072
    ds_read_b128 v[164:167], v9 offset:11264
    ds_read_b128 v[168:171], v9 offset:19456
    ds_read_b128 v[172:175], v9 offset:27648
    s_waitcnt lgkmcnt(4)
    v_mfma_f32_16x16x32_bf16 v[128:131], v[144:147], v[56:59], v[128:131]
    v_mfma_f32_16x16x32_bf16 v[132:135], v[148:151], v[56:59], v[132:135]
    v_mfma_f32_16x16x32_bf16 v[136:139], v[152:155], v[56:59], v[136:139]
    v_mfma_f32_16x16x32_bf16 v[140:143], v[156:159], v[56:59], v[140:143]
    s_waitcnt lgkmcnt(0)
    v_mfma_f32_16x16x32_bf16 v[128:131], v[160:163], v[60:63], v[128:131]
    v_mfma_f32_16x16x32_bf16 v[132:135], v[164:167], v[60:63], v[132:135]
    v_mfma_f32_16x16x32_bf16 v[136:139], v[168:171], v[60:63], v[136:139]
    v_mfma_f32_16x16x32_bf16 v[140:143], v[172:175], v[60:63], v[140:143]
    s_add_u32 s44, s43, 20480
    buffer_load_dwordx4 v[96:99], v2, s[8:11], s44 offen offset:0
    buffer_load_dwordx4 v[100:103], v2, s[8:11], s44 offen offset:1024
    buffer_load_dwordx4 v[104:107], v2, s[8:11], s44 offen offset:2048
    buffer_load_dwordx4 v[108:111], v2, s[8:11], s44 offen offset:3072
    s_waitcnt vmcnt(16)
    s_barrier
    s_add_u32 s44, s46, 24576
    s_add_u32 s45, s47, 65536
    s_mov_b32 m0, s45
    s_nop 0
    buffer_load_dwordx4 v2, s[12:15], s44 offen offset:0 lds
    buffer_load_dwordx4 v2, s[12:15], s44 offen offset:1024 lds
    buffer_load_dwordx4 v2, s[12:15], s44 offen offset:2048 lds
    buffer_load_dwordx4 v2, s[12:15], s44 offen offset:3072 lds
    ds_read_b128 v[144:147], v9 offset:32768
    ds_read_b128 v[148:151], v9 offset:40960
    ds_read_b128 v[152:155], v9 offset:49152
    ds_read_b128 v[156:159], v9 offset:57344
    ds_read_b128 v[160:163], v9 offset:33792
    ds_read_b128 v[164:167], v9 offset:41984
    ds_read_b128 v[168:171], v9 offset:50176
    ds_read_b128 v[172:175], v9 offset:58368
    s_waitcnt lgkmcnt(4)
    v_mfma_f32_16x16x32_bf16 v[128:131], v[144:147], v[64:67], v[128:131]
    v_mfma_f32_16x16x32_bf16 v[132:135], v[148:151], v[64:67], v[132:135]
    v_mfma_f32_16x16x32_bf16 v[136:139], v[152:155], v[64:67], v[136:139]
    v_mfma_f32_16x16x32_bf16 v[140:143], v[156:159], v[64:67], v[140:143]
    ds_read_b128 v[144:147], v9 offset:34816
    ds_read_b128 v[148:151], v9 offset:43008
    ds_read_b128 v[152:155], v9 offset:51200
    ds_read_b128 v[156:159], v9 offset:59392
    s_waitcnt lgkmcnt(4)
    v_mfma_f32_16x16x32_bf16 v[128:131], v[160:163], v[68:71], v[128:131]
    v_mfma_f32_16x16x32_bf16 v[132:135], v[164:167], v[68:71], v[132:135]
    v_mfma_f32_16x16x32_bf16 v[136:139], v[168:171], v[68:71], v[136:139]
    v_mfma_f32_16x16x32_bf16 v[140:143], v[172:175], v[68:71], v[140:143]
    ds_read_b128 v[160:163], v9 offset:35840
    ds_read_b128 v[164:167], v9 offset:44032
    ds_read_b128 v[168:171], v9 offset:52224
    ds_read_b128 v[172:175], v9 offset:60416
    s_waitcnt lgkmcnt(4)
    v_mfma_f32_16x16x32_bf16 v[128:131], v[144:147], v[72:75], v[128:131]
    v_mfma_f32_16x16x32_bf16 v[132:135], v[148:151], v[72:75], v[132:135]
    v_mfma_f32_16x16x32_bf16 v[136:139], v[152:155], v[72:75], v[136:139]
    v_mfma_f32_16x16x32_bf16 v[140:143], v[156:159], v[72:75], v[140:143]
    s_waitcnt lgkmcnt(0)
    v_mfma_f32_16x16x32_bf16 v[128:131], v[160:163], v[76:79], v[128:131]
    v_mfma_f32_16x16x32_bf16 v[132:135], v[164:167], v[76:79], v[132:135]
    v_mfma_f32_16x16x32_bf16 v[136:139], v[168:171], v[76:79], v[136:139]
    v_mfma_f32_16x16x32_bf16 v[140:143], v[172:175], v[76:79], v[140:143]
    s_add_u32 s44, s43, 24576
    buffer_load_dwordx4 v[112:115], v2, s[8:11], s44 offen offset:0
    buffer_load_dwordx4 v[116:119], v2, s[8:11], s44 offen offset:1024
    buffer_load_dwordx4 v[120:123], v2, s[8:11], s44 offen offset:2048
    buffer_load_dwordx4 v[124:127], v2, s[8:11], s44 offen offset:3072
    s_waitcnt vmcnt(16)
    s_barrier
    ds_read_b128 v[144:147], v8 offset:0
    ds_read_b128 v[148:151], v8 offset:8192
    ds_read_b128 v[152:155], v8 offset:16384
    ds_read_b128 v[156:159], v8 offset:24576
    ds_read_b128 v[160:163], v8 offset:1024
    ds_read_b128 v[164:167], v8 offset:9216
    ds_read_b128 v[168:171], v8 offset:17408
    ds_read_b128 v[172:175], v8 offset:25600
    s_waitcnt lgkmcnt(4)
    v_mfma_f32_16x16x32_bf16 v[128:131], v[144:147], v[80:83], v[128:131]
    v_mfma_f32_16x16x32_bf16 v[132:135], v[148:151], v[80:83], v[132:135]
    v_mfma_f32_16x16x32_bf16 v[136:139], v[152:155], v[80:83], v[136:139]
    v_mfma_f32_16x16x32_bf16 v[140:143], v[156:159], v[80:83], v[140:143]
    ds_read_b128 v[144:147], v8 offset:2048
    ds_read_b128 v[148:151], v8 offset:10240
    ds_read_b128 v[152:155], v8 offset:18432
    ds_read_b128 v[156:159], v8 offset:26624
    s_waitcnt lgkmcnt(4)
    v_mfma_f32_16x16x32_bf16 v[128:131], v[160:163], v[84:87], v[128:131]
    v_mfma_f32_16x16x32_bf16 v[132:135], v[164:167], v[84:87], v[132:135]
    v_mfma_f32_16x16x32_bf16 v[136:139], v[168:171], v[84:87], v[136:139]
    v_mfma_f32_16x16x32_bf16 v[140:143], v[172:175], v[84:87], v[140:143]
    ds_read_b128 v[160:163], v8 offset:3072
    ds_read_b128 v[164:167], v8 offset:11264
    ds_read_b128 v[168:171], v8 offset:19456
    ds_read_b128 v[172:175], v8 offset:27648
    s_waitcnt lgkmcnt(4)
    v_mfma_f32_16x16x32_bf16 v[128:131], v[144:147], v[88:91], v[128:131]
    v_mfma_f32_16x16x32_bf16 v[132:135], v[148:151], v[88:91], v[132:135]
    v_mfma_f32_16x16x32_bf16 v[136:139], v[152:155], v[88:91], v[136:139]
    v_mfma_f32_16x16x32_bf16 v[140:143], v[156:159], v[88:91], v[140:143]
    s_waitcnt lgkmcnt(0)
    v_mfma_f32_16x16x32_bf16 v[128:131], v[160:163], v[92:95], v[128:131]
    v_mfma_f32_16x16x32_bf16 v[132:135], v[164:167], v[92:95], v[132:135]
    v_mfma_f32_16x16x32_bf16 v[136:139], v[168:171], v[92:95], v[136:139]
    v_mfma_f32_16x16x32_bf16 v[140:143], v[172:175], v[92:95], v[140:143]
    s_waitcnt vmcnt(8)
    s_barrier
    ds_read_b128 v[144:147], v8 offset:32768
    ds_read_b128 v[148:151], v8 offset:40960
    ds_read_b128 v[152:155], v8 offset:49152
    ds_read_b128 v[156:159], v8 offset:57344
    ds_read_b128 v[160:163], v8 offset:33792
    ds_read_b128 v[164:167], v8 offset:41984
    ds_read_b128 v[168:171], v8 offset:50176
    ds_read_b128 v[172:175], v8 offset:58368
    s_waitcnt lgkmcnt(4)
    v_mfma_f32_16x16x32_bf16 v[128:131], v[144:147], v[96:99], v[128:131]
    v_mfma_f32_16x16x32_bf16 v[132:135], v[148:151], v[96:99], v[132:135]
    v_mfma_f32_16x16x32_bf16 v[136:139], v[152:155], v[96:99], v[136:139]
    v_mfma_f32_16x16x32_bf16 v[140:143], v[156:159], v[96:99], v[140:143]
    ds_read_b128 v[144:147], v8 offset:34816
    ds_read_b128 v[148:151], v8 offset:43008
    ds_read_b128 v[152:155], v8 offset:51200
    ds_read_b128 v[156:159], v8 offset:59392
    s_waitcnt lgkmcnt(4)
    v_mfma_f32_16x16x32_bf16 v[128:131], v[160:163], v[100:103], v[128:131]
    v_mfma_f32_16x16x32_bf16 v[132:135], v[164:167], v[100:103], v[132:135]
    v_mfma_f32_16x16x32_bf16 v[136:139], v[168:171], v[100:103], v[136:139]
    v_mfma_f32_16x16x32_bf16 v[140:143], v[172:175], v[100:103], v[140:143]
    ds_read_b128 v[160:163], v8 offset:35840
    ds_read_b128 v[164:167], v8 offset:44032
    ds_read_b128 v[168:171], v8 offset:52224
    ds_read_b128 v[172:175], v8 offset:60416
    s_waitcnt lgkmcnt(4)
    v_mfma_f32_16x16x32_bf16 v[128:131], v[144:147], v[104:107], v[128:131]
    v_mfma_f32_16x16x32_bf16 v[132:135], v[148:151], v[104:107], v[132:135]
    v_mfma_f32_16x16x32_bf16 v[136:139], v[152:155], v[104:107], v[136:139]
    v_mfma_f32_16x16x32_bf16 v[140:143], v[156:159], v[104:107], v[140:143]
    s_waitcnt lgkmcnt(0)
    v_mfma_f32_16x16x32_bf16 v[128:131], v[160:163], v[108:111], v[128:131]
    v_mfma_f32_16x16x32_bf16 v[132:135], v[164:167], v[108:111], v[132:135]
    v_mfma_f32_16x16x32_bf16 v[136:139], v[168:171], v[108:111], v[136:139]
    v_mfma_f32_16x16x32_bf16 v[140:143], v[172:175], v[108:111], v[140:143]
    s_waitcnt vmcnt(0)
    s_barrier
    ds_read_b128 v[144:147], v9 offset:0
    ds_read_b128 v[148:151], v9 offset:8192
    ds_read_b128 v[152:155], v9 offset:16384
    ds_read_b128 v[156:159], v9 offset:24576
    ds_read_b128 v[160:163], v9 offset:1024
    ds_read_b128 v[164:167], v9 offset:9216
    ds_read_b128 v[168:171], v9 offset:17408
    ds_read_b128 v[172:175], v9 offset:25600
    s_waitcnt lgkmcnt(4)
    v_mfma_f32_16x16x32_bf16 v[128:131], v[144:147], v[112:115], v[128:131]
    v_mfma_f32_16x16x32_bf16 v[132:135], v[148:151], v[112:115], v[132:135]
    v_mfma_f32_16x16x32_bf16 v[136:139], v[152:155], v[112:115], v[136:139]
    v_mfma_f32_16x16x32_bf16 v[140:143], v[156:159], v[112:115], v[140:143]
    ds_read_b128 v[144:147], v9 offset:2048
    ds_read_b128 v[148:151], v9 offset:10240
    ds_read_b128 v[152:155], v9 offset:18432
    ds_read_b128 v[156:159], v9 offset:26624
    s_waitcnt lgkmcnt(4)
    v_mfma_f32_16x16x32_bf16 v[128:131], v[160:163], v[116:119], v[128:131]
    v_mfma_f32_16x16x32_bf16 v[132:135], v[164:167], v[116:119], v[132:135]
    v_mfma_f32_16x16x32_bf16 v[136:139], v[168:171], v[116:119], v[136:139]
    v_mfma_f32_16x16x32_bf16 v[140:143], v[172:175], v[116:119], v[140:143]
    ds_read_b128 v[160:163], v9 offset:3072
    ds_read_b128 v[164:167], v9 offset:11264
    ds_read_b128 v[168:171], v9 offset:19456
    ds_read_b128 v[172:175], v9 offset:27648
    s_waitcnt lgkmcnt(4)
    v_mfma_f32_16x16x32_bf16 v[128:131], v[144:147], v[120:123], v[128:131]
    v_mfma_f32_16x16x32_bf16 v[132:135], v[148:151], v[120:123], v[132:135]
    v_mfma_f32_16x16x32_bf16 v[136:139], v[152:155], v[120:123], v[136:139]
    v_mfma_f32_16x16x32_bf16 v[140:143], v[156:159], v[120:123], v[140:143]
    s_waitcnt lgkmcnt(0)
    v_mfma_f32_16x16x32_bf16 v[128:131], v[160:163], v[124:127], v[128:131]
    v_mfma_f32_16x16x32_bf16 v[132:135], v[164:167], v[124:127], v[132:135]
    v_mfma_f32_16x16x32_bf16 v[136:139], v[168:171], v[124:127], v[136:139]
    v_mfma_f32_16x16x32_bf16 v[140:143], v[172:175], v[124:127], v[140:143]
    s_lshl_b32 s44, s88, 1
    s_add_u32 s44, s44, s89
    s_lshl_b32 s45, s44, 11
    s_xor_b32 s44, s44, 1
    s_lshl_b32 s44, s44, 11
    s_add_u32 s45, s45, 147456
    s_add_u32 s44, s44, 147456
    v_add_u32 v6, s45, v2
    v_add_u32 v7, s44, v2
    s_cmp_eq_u32 s89, 0
    s_nop 0
    s_cbranch_scc1 L_hx_lo_119
    ds_write_b128 v6, v[128:131]
    ds_write_b128 v6, v[132:135] offset:1024
    v_mov_b32 v16, v136
    v_mov_b32 v17, v137
    v_mov_b32 v18, v138
    v_mov_b32 v19, v139
    v_mov_b32 v20, v140
    v_mov_b32 v21, v141
    v_mov_b32 v22, v142
    v_mov_b32 v23, v143
    s_nop 1
    s_branch L_hx_j1_120
L_hx_lo_119:
    ds_write_b128 v6, v[136:139]
    ds_write_b128 v6, v[140:143] offset:1024
    v_mov_b32 v16, v128
    v_mov_b32 v17, v129
    v_mov_b32 v18, v130
    v_mov_b32 v19, v131
    v_mov_b32 v20, v132
    v_mov_b32 v21, v133
    v_mov_b32 v22, v134
    v_mov_b32 v23, v135
    s_nop 1
L_hx_j1_120:
    s_waitcnt lgkmcnt(0)
    s_barrier
    ds_read_b128 v[128:131], v7
    ds_read_b128 v[132:135], v7 offset:1024
    s_waitcnt lgkmcnt(0)
    v_add_f32 v16, v16, v128
    v_add_f32 v17, v17, v129
    v_add_f32 v18, v18, v130
    v_add_f32 v19, v19, v131
    v_add_f32 v20, v20, v132
    v_add_f32 v21, v21, v133
    v_add_f32 v22, v22, v134
    v_add_f32 v23, v23, v135
    v_cvt_pk_bf16_f32 v17, v16, v17
    v_lshlrev_b32 v16, 16, v17
    v_and_b32 v17, 0xffff0000, v17
    v_cvt_pk_bf16_f32 v19, v18, v19
    v_lshlrev_b32 v18, 16, v19
    v_and_b32 v19, 0xffff0000, v19
    v_cvt_pk_bf16_f32 v21, v20, v21
    v_lshlrev_b32 v20, 16, v21
    v_and_b32 v21, 0xffff0000, v21
    v_cvt_pk_bf16_f32 v23, v22, v23
    v_lshlrev_b32 v22, 16, v23
    v_and_b32 v23, 0xffff0000, v23
    v_lshlrev_b32 v8, 16, v176
    v_and_b32 v9, 0xffff0000, v176
    v_add_f32 v16, v16, v8
    v_add_f32 v17, v17, v9
    v_lshlrev_b32 v8, 16, v177
    v_and_b32 v9, 0xffff0000, v177
    v_add_f32 v18, v18, v8
    v_add_f32 v19, v19, v9
    v_lshlrev_b32 v8, 16, v178
    v_and_b32 v9, 0xffff0000, v178
    v_add_f32 v20, v20, v8
    v_add_f32 v21, v21, v9
    v_lshlrev_b32 v8, 16, v179
    v_and_b32 v9, 0xffff0000, v179
    v_add_f32 v22, v22, v8
    v_add_f32 v23, v23, v9
    v_cvt_pk_bf16_f32 v17, v16, v17
    v_lshlrev_b32 v16, 16, v17
    v_and_b32 v17, 0xffff0000, v17
    v_cvt_pk_bf16_f32 v19, v18, v19
    v_lshlrev_b32 v18, 16, v19
    v_and_b32 v19, 0xffff0000, v19
    v_cvt_pk_bf16_f32 v21, v20, v21
    v_lshlrev_b32 v20, 16, v21
    v_and_b32 v21, 0xffff0000, v21
    v_cvt_pk_bf16_f32 v23, v22, v23
    v_lshlrev_b32 v22, 16, v23
    v_and_b32 v23, 0xffff0000, v23
    v_lshlrev_b32 v8, 16, v180
    v_and_b32 v9, 0xffff0000, v180
    v_add_f32 v16, v16, v8
    v_add_f32 v17, v17, v9
    v_lshlrev_b32 v8, 16, v181
    v_and_b32 v9, 0xffff0000, v181
    v_add_f32 v18, v18, v8
    v_add_f32 v19, v19, v9
    v_lshlrev_b32 v8, 16, v182
    v_and_b32 v9, 0xffff0000, v182
    v_add_f32 v20, v20, v8
    v_add_f32 v21, v21, v9
    v_lshlrev_b32 v8, 16, v183
    v_and_b32 v9, 0xffff0000, v183
    v_add_f32 v22, v22, v8
    v_add_f32 v23, v23, v9
    v_cvt_pk_bf16_f32 v24, v16, v17
    v_cvt_pk_bf16_f32 v25, v18, v19
    v_cvt_pk_bf16_f32 v26, v20, v21
    v_cvt_pk_bf16_f32 v27, v22, v23
    buffer_store_dwordx4 v[24:27], v2, s[24:27], s41 offen
    s_lshl_b32 s40, s84, 3
    s_add_u32 s40, s40, s85
    s_add_u32 s40, s40, 1536
    s_waitcnt vmcnt(0)
    s_barrier
    s_cmp_lg_u32 s3, 0
    s_cbranch_scc1 L_sig_121
    s_add_u32 s28, s94, 7921664
    s_addc_u32 s29, s95, 0
    s_mov_b32 s30, 16384
    s_mov_b32 s31, 0x00020000
    s_lshl_b32 s48, s40, 2
    v_mov_b32 v6, 1
    v_mov_b32 v7, s48
    s_mov_b64 exec, 1
    s_cmp_lg_u32 s80, 0
    s_cbranch_scc1 L_sigfb_122
    buffer_store_dword v6, v7, s[28:31], 0 offen
    s_nop 1
    s_branch L_sigj_123
L_sigfb_122:
    buffer_wbl2 sc1
    s_waitcnt vmcnt(0)
    buffer_store_dword v6, v7, s[28:31], 0 offen sc1
    s_nop 1
L_sigj_123:
    s_mov_b64 exec, -1
L_sig_121:
    s_mul_i32 s42, s87, 88064
    s_add_u32 s12, s94, s42
    s_addc_u32 s13, s95, 0
    s_mov_b32 s14, 88064
    s_mov_b32 s15, 0x00020000
    s_mul_i32 s43, s3, 11
    s_lshl_b32 s44, s43, 10
    s_add_u32 s45, s44, 0
    s_mov_b32 m0, s45
    s_nop 0
    buffer_load_dwordx4 v2, s[12:15], s44 offen offset:0 lds
    buffer_load_dwordx4 v2, s[12:15], s44 offen offset:1024 lds
    buffer_load_dwordx4 v2, s[12:15], s44 offen offset:2048 lds
    buffer_load_dwordx4 v2, s[12:15], s44 offen offset:3072 lds
    s_add_u32 s44, s44, 4096
    s_add_u32 s45, s45, 4096
    s_mov_b32 m0, s45
    s_nop 0
    buffer_load_dwordx4 v2, s[12:15], s44 offen offset:0 lds
    buffer_load_dwordx4 v2, s[12:15], s44 offen offset:1024 lds
    buffer_load_dwordx4 v2, s[12:15], s44 offen offset:2048 lds
    buffer_load_dwordx4 v2, s[12:15], s44 offen offset:3072 lds
    s_add_u32 s44, s44, 4096
    s_add_u32 s45, s45, 4096
    s_mov_b32 m0, s45
    s_nop 0
    buffer_load_dwordx4 v2, s[12:15], s44 offen offset:0 lds
    s_cmp_eq_u32 s3, 7
    s_cbranch_scc1 L_k1skip_124
    s_add_u32 s43, s43, 9
    s_lshl_b32 s44, s43, 10
    s_add_u32 s45, s44, 0
    s_mov_b32 m0, s45
    s_nop 0
    buffer_load_dwordx4 v2, s[12:15], s44 offen offset:0 lds
    buffer_load_dwordx4 v2, s[12:15], s44 offen offset:1024 lds
L_k1skip_124:
    s_branch L_join_72
L_idle_70:
    s_sub_u32 s40, s81, 224
    s_lshr_b32 s40, s40, 3
    s_lshl_b32 s40, s40, 3
    s_add_u32 s40, s40, s3
    s_add_u32 s12, s94, 1409024
    s_addc_u32 s13, s95, 0
    s_mov_b32 s14, 4415488
    s_mov_b32 s15, 0x00020000
    s_lshl_b32 s44, s40, 12
L_pf_125:
    s_cmp_ge_u32 s44, 4415488
    s_cbranch_scc1 L_pfd_126
    buffer_load_dwordx4 v[16:19], v2, s[12:15], s44 offen offset:0
    buffer_load_dwordx4 v[20:23], v2, s[12:15], s44 offen offset:1024
    buffer_load_dwordx4 v[24:27], v2, s[12:15], s44 offen offset:2048
    buffer_load_dwordx4 v[28:31], v2, s[12:15], s44 offen offset:3072
    s_add_u32 s44, s44, 131072
    buffer_load_dwordx4 v[32:35], v2, s[12:15], s44 offen offset:0
    buffer_load_dwordx4 v[36:39], v2, s[12:15], s44 offen offset:1024
    buffer_load_dwordx4 v[40:43], v2, s[12:15], s44 offen offset:2048
    buffer_load_dwordx4 v[44:47], v2, s[12:15], s44 offen offset:3072
    s_add_u32 s44, s44, 131072
    s_waitcnt vmcnt(4)
    s_branch L_pf_125
L_pfd_126:
    s_waitcnt vmcnt(0)
    s_mov_b32 s12, s94
    s_mov_b32 s13, s95
    s_mov_b32 s14, 1409024
    s_mov_b32 s15, 0x00020000
    s_lshl_b32 s44, s40, 12
L_pf_127:
    s_cmp_ge_u32 s44, 1409024
    s_cbranch_scc1 L_pfd_128
    buffer_load_dwordx4 v[16:19], v2, s[12:15], s44 offen offset:0
    buffer_load_dwordx4 v[20:23], v2, s[12:15], s44 offen offset:1024
    buffer_load_dwordx4 v[24:27], v2, s[12:15], s44 offen offset:2048
    buffer_load_dwordx4 v[28:31], v2, s[12:15], s44 offen offset:3072
    s_add_u32 s44, s44, 131072
    buffer_load_dwordx4 v[32:35], v2, s[12:15], s44 offen offset:0
    buffer_load_dwordx4 v[36:39], v2, s[12:15], s44 offen offset:1024
    buffer_load_dwordx4 v[40:43], v2, s[12:15], s44 offen offset:2048
    buffer_load_dwordx4 v[44:47], v2, s[12:15], s44 offen offset:3072
    s_add_u32 s44, s44, 131072
    s_waitcnt vmcnt(4)
    s_branch L_pf_127
L_pfd_128:
    s_waitcnt vmcnt(0)
    s_mul_i32 s42, s87, 88064
    s_add_u32 s12, s94, s42
    s_addc_u32 s13, s95, 0
    s_mov_b32 s14, 88064
    s_mov_b32 s15, 0x00020000
    s_mul_i32 s43, s3, 11
    s_lshl_b32 s44, s43, 10
    s_add_u32 s45, s44, 0
    s_mov_b32 m0, s45
    s_nop 0
    buffer_load_dwordx4 v2, s[12:15], s44 offen offset:0 lds
    buffer_load_dwordx4 v2, s[12:15], s44 offen offset:1024 lds
    buffer_load_dwordx4 v2, s[12:15], s44 offen offset:2048 lds
    buffer_load_dwordx4 v2, s[12:15], s44 offen offset:3072 lds
    s_add_u32 s44, s44, 4096
    s_add_u32 s45, s45, 4096
    s_mov_b32 m0, s45
    s_nop 0
    buffer_load_dwordx4 v2, s[12:15], s44 offen offset:0 lds
    buffer_load_dwordx4 v2, s[12:15], s44 offen offset:1024 lds
    buffer_load_dwordx4 v2, s[12:15], s44 offen offset:2048 lds
    buffer_load_dwordx4 v2, s[12:15], s44 offen offset:3072 lds
    s_add_u32 s44, s44, 4096
    s_add_u32 s45, s45, 4096
    s_mov_b32 m0, s45
    s_nop 0
    buffer_load_dwordx4 v2, s[12:15], s44 offen offset:0 lds
    s_cmp_eq_u32 s3, 7
    s_cbranch_scc1 L_k1skip_129
    s_add_u32 s43, s43, 9
    s_lshl_b32 s44, s43, 10
    s_add_u32 s45, s44, 0
    s_mov_b32 m0, s45
    s_nop 0
    buffer_load_dwordx4 v2, s[12:15], s44 offen offset:0 lds
    buffer_load_dwordx4 v2, s[12:15], s44 offen offset:1024 lds
L_k1skip_129:
L_join_72:
    s_lshl_b32 s40, s86, 4
    s_add_u32 s40, s40, 1536
    s_cmp_lg_u32 s3, 0
    s_cbranch_scc1 L_wsk_130
    s_add_u32 s28, s94, 7921664
    s_addc_u32 s29, s95, 0
    s_mov_b32 s30, 16384
    s_mov_b32 s31, 0x00020000
    s_mov_b32 s50, 0
    v_add_u32 v6, s40, v1
    v_and_b32 v7, 7, v1
    v_cmp_eq_u32 s[48:49], 7, v7
    v_cmp_le_u32 vcc, 16, v1
    s_nop 0
    s_or_b64 s[48:49], s[48:49], vcc
    v_lshlrev_b32 v6, 2, v6
    v_cndmask_b32 v6, v6, 0, s[48:49]
    s_nop 1
L_wlp_131:
    buffer_load_dword v8, v6, s[28:31], 0 offen sc1
    s_waitcnt vmcnt(0)
    v_cmp_ne_u32 vcc, 0, v8
    s_nop 0
    s_or_b64 vcc, vcc, s[48:49]
    s_cmp_eq_u64 vcc, -1
    s_nop 1
    s_cbranch_scc1 L_wdn_132
    s_sleep 1
    s_add_u32 s50, s50, 1
    s_cmp_lt_u32 s50, 65536
    s_cbranch_scc1 L_wlp_131
L_wdn_132:
    s_cmp_eq_u32 s80, 0
    s_cbranch_scc1 L_wsk_130
    buffer_inv sc1
    s_waitcnt vmcnt(0)
L_wsk_130:
    s_barrier
    s_add_u32 s8, s94, 40968192
    s_addc_u32 s9, s95, 0
    s_mov_b32 s10, 1835008
    s_mov_b32 s11, 0x00020000
    s_lshl_b32 s47, s86, 3
    s_add_u32 s47, s47, s3
    s_mul_i32 s44, s47, 14336
    buffer_load_dwordx4 v[16:19], v2, s[8:11], s44 offen offset:0
    buffer_load_dwordx4 v[20:23], v2, s[8:11], s44 offen offset:1024
    buffer_load_dwordx4 v[24:27], v2, s[8:11], s44 offen offset:2048
    buffer_load_dwordx4 v[28:31], v2, s[8:11], s44 offen offset:3072
    s_add_u32 s44, s44, 4096
    buffer_load_dwordx4 v[32:35], v2, s[8:11], s44 offen offset:0
    buffer_load_dwordx4 v[36:39], v2, s[8:11], s44 offen offset:1024
    buffer_load_dwordx4 v[40:43], v2, s[8:11], s44 offen offset:2048
    buffer_load_dwordx4 v[44:47], v2, s[8:11], s44 offen offset:3072
    s_add_u32 s44, s44, 4096
    buffer_load_dwordx4 v[48:51], v2, s[8:11], s44 offen offset:0
    buffer_load_dwordx4 v[52:55], v2, s[8:11], s44 offen offset:1024
    buffer_load_dwordx4 v[56:59], v2, s[8:11], s44 offen offset:2048
    buffer_load_dwordx4 v[60:63], v2, s[8:11], s44 offen offset:3072
    s_add_u32 s44, s44, 4096
    buffer_load_dwordx4 v[64:67], v2, s[8:11], s44 offen offset:0
    buffer_load_dwordx4 v[68:71], v2, s[8:11], s44 offen offset:1024
    s_waitcnt vmcnt(0)
    v_mov_b32 v8, 0
    v_mov_b32 v9, 0
    v_mov_b32 v10, 0
    v_mov_b32 v11, 0
    v_dot2_f32_bf16 v8, v16, s60, v8
    v_dot2_f32_bf16 v9, v16, v16, v9
    v_dot2_f32_bf16 v10, v17, s60, v10
    v_dot2_f32_bf16 v11, v17, v17, v11
    v_dot2_f32_bf16 v8, v18, s60, v8
    v_dot2_f32_bf16 v9, v18, v18, v9
    v_dot2_f32_bf16 v10, v19, s60, v10
    v_dot2_f32_bf16 v11, v19, v19, v11
    v_dot2_f32_bf16 v8, v20, s60, v8
    v_dot2_f32_bf16 v9, v20, v20, v9
    v_dot2_f32_bf16 v10, v21, s60, v10
    v_dot2_f32_bf16 v11, v21, v21, v11
    v_dot2_f32_bf16 v8, v22, s60, v8
    v_dot2_f32_bf16 v9, v22, v22, v9
    v_dot2_f32_bf16 v10, v23, s60, v10
    v_dot2_f32_bf16 v11, v23, v23, v11
    v_dot2_f32_bf16 v8, v24, s60, v8
    v_dot2_f32_bf16 v9, v24, v24, v9
    v_dot2_f32_bf16 v10, v25, s60, v10
    v_dot2_f32_bf16 v11, v25, v25, v11
    v_dot2_f32_bf16 v8, v26, s60, v8
    v_dot2_f32_bf16 v9, v26, v26, v9
    v_dot2_f32_bf16 v10, v27, s60, v10
    v_dot2_f32_bf16 v11, v27, v27, v11
    v_dot2_f32_bf16 v8, v28, s60, v8
    v_dot2_f32_bf16 v9, v28, v28, v9
    v_dot2_f32_bf16 v10, v29, s60, v10
    v_dot2_f32_bf16 v11, v29, v29, v11
    v_dot2_f32_bf16 v8, v30, s60, v8
    v_dot2_f32_bf16 v9, v30, v30, v9
    v_dot2_f32_bf16 v10, v31, s60, v10
    v_dot2_f32_bf16 v11, v31, v31, v11
    v_dot2_f32_bf16 v8, v32, s60, v8
    v_dot2_f32_bf16 v9, v32, v32, v9
    v_dot2_f32_bf16 v10, v33, s60, v10
    v_dot2_f32_bf16 v11, v33, v33, v11
    v_dot2_f32_bf16 v8, v34, s60, v8
    v_dot2_f32_bf16 v9, v34, v34, v9
    v_dot2_f32_bf16 v10, v35, s60, v10
    v_dot2_f32_bf16 v11, v35, v35, v11
    v_dot2_f32_bf16 v8, v36, s60, v8
    v_dot2_f32_bf16 v9, v36, v36, v9
    v_dot2_f32_bf16 v10, v37, s60, v10
    v_dot2_f32_bf16 v11, v37, v37, v11
    v_dot2_f32_bf16 v8, v38, s60, v8
    v_dot2_f32_bf16 v9, v38, v38, v9
    v_dot2_f32_bf16 v10, v39, s60, v10
    v_dot2_f32_bf16 v11, v39, v39, v11
    v_dot2_f32_bf16 v8, v40, s60, v8
    v_dot2_f32_bf16 v9, v40, v40, v9
    v_dot2_f32_bf16 v10, v41, s60, v10
    v_dot2_f32_bf16 v11, v41, v41, v11
    v_dot2_f32_bf16 v8, v42, s60, v8
    v_dot2_f32_bf16 v9, v42, v42, v9
    v_dot2_f32_bf16 v10, v43, s60, v10
    v_dot2_f32_bf16 v11, v43, v43, v11
    v_dot2_f32_bf16 v8, v44, s60, v8
    v_dot2_f32_bf16 v9, v44, v44, v9
    v_dot2_f32_bf16 v10, v45, s60, v10
    v_dot2_f32_bf16 v11, v45, v45, v11
    v_dot2_f32_bf16 v8, v46, s60, v8
    v_dot2_f32_bf16 v9, v46, v46, v9
    v_dot2_f32_bf16 v10, v47, s60, v10
    v_dot2_f32_bf16 v11, v47, v47, v11
    v_dot2_f32_bf16 v8, v48, s60, v8
    v_dot2_f32_bf16 v9, v48, v48, v9
    v_dot2_f32_bf16 v10, v49, s60, v10
    v_dot2_f32_bf16 v11, v49, v49, v11
    v_dot2_f32_bf16 v8, v50, s60, v8
    v_dot2_f32_bf16 v9, v50, v50, v9
    v_dot2_f32_bf16 v10, v51, s60, v10
    v_dot2_f32_bf16 v11, v51, v51, v11
    v_dot2_f32_bf16 v8, v52, s60, v8
    v_dot2_f32_bf16 v9, v52, v52, v9
    v_dot2_f32_bf16 v10, v53, s60, v10
    v_dot2_f32_bf16 v11, v53, v53, v11
    v_dot2_f32_bf16 v8, v54, s60, v8
    v_dot2_f32_bf16 v9, v54, v54, v9
    v_dot2_f32_bf16 v10, v55, s60, v10
    v_dot2_f32_bf16 v11, v55, v55, v11
    v_dot2_f32_bf16 v8, v56, s60, v8
    v_dot2_f32_bf16 v9, v56, v56, v9
    v_dot2_f32_bf16 v10, v57, s60, v10
    v_dot2_f32_bf16 v11, v57, v57, v11
    v_dot2_f32_bf16 v8, v58, s60, v8
    v_dot2_f32_bf16 v9, v58, v58, v9
    v_dot2_f32_bf16 v10, v59, s60, v10
    v_dot2_f32_bf16 v11, v59, v59, v11
    v_dot2_f32_bf16 v8, v60, s60, v8
    v_dot2_f32_bf16 v9, v60, v60, v9
    v_dot2_f32_bf16 v10, v61, s60, v10
    v_dot2_f32_bf16 v11, v61, v61, v11
    v_dot2_f32_bf16 v8, v62, s60, v8
    v_dot2_f32_bf16 v9, v62, v62, v9
    v_dot2_f32_bf16 v10, v63, s60, v10
    v_dot2_f32_bf16 v11, v63, v63, v11
    v_dot2_f32_bf16 v8, v64, s60, v8
    v_dot2_f32_bf16 v9, v64, v64, v9
    v_dot2_f32_bf16 v10, v65, s60, v10
    v_dot2_f32_bf16 v11, v65, v65, v11
    v_dot2_f32_bf16 v8, v66, s60, v8
    v_dot2_f32_bf16 v9, v66, v66, v9
    v_dot2_f32_bf16 v10, v67, s60, v10
    v_dot2_f32_bf16 v11, v67, v67, v11
    v_dot2_f32_bf16 v8, v68, s60, v8
    v_dot2_f32_bf16 v9, v68, v68, v9
    v_dot2_f32_bf16 v10, v69, s60, v10
    v_dot2_f32_bf16 v11, v69, v69, v11
    v_dot2_f32_bf16 v8, v70, s60, v8
    v_dot2_f32_bf16 v9, v70, v70, v9
    v_dot2_f32_bf16 v10, v71, s60, v10
    v_dot2_f32_bf16 v11, v71, v71, v11
    s_nop 1
    v_add_f32 v8, v8, v10
    v_add_f32 v9, v9, v11
    v_mov_b32 v10, v8
    s_nop 1
    v_permlane32_swap_b32 v8, v10
    v_add_f32 v8, v8, v10
    v_mov_b32 v10, v8
    s_nop 1
    v_permlane16_swap_b32 v8, v10
    v_add_f32 v8, v8, v10
    v_mov_b32 v11, v9
    s_nop 1
    v_permlane32_swap_b32 v9, v11
    v_add_f32 v9, v9, v11
    v_mov_b32 v11, v9
    s_nop 1
    v_permlane16_swap_b32 v9, v11
    v_add_f32 v9, v9, v11
    v_mul_f32 v8, 0x3b124925, v8
    v_mul_f32 v9, 0x3b124925, v9
    v_fma_f32 v9, -v8, v8, v9
    v_max_f32 v9, 0, v9
    v_cvt_pk_bf16_f32 v8, v8, v8
    v_and_b32 v8, 0xffff0000, v8
    v_cvt_pk_bf16_f32 v9, v9, v9
    v_and_b32 v9, 0xffff0000, v9
    v_add_f32 v9, 0x3727c5ac, v9
    v_cvt_pk_bf16_f32 v9, v9, v9
    v_and_b32 v9, 0xffff0000, v9
    v_sqrt_f32 v9, v9
    s_nop 0
    v_cvt_pk_bf16_f32 v9, v9, v9
    v_and_b32 v9, 0xffff0000, v9
    v_rcp_f32 v72, v9
    s_nop 0
    v_mul_f32 v74, v8, v72
    v_sub_f32 v74, 0, v74
    v_lshlrev_b32 v76, 16, v16
    v_and_b32 v77, 0xffff0000, v16
    v_pk_fma_f32 v[76:77], v[76:77], v[72:73], v[74:75] op_sel_hi:[1,0,0]
    v_cvt_pk_bf16_f32 v16, v76, v77
    v_lshlrev_b32 v78, 16, v17
    v_and_b32 v79, 0xffff0000, v17
    v_pk_fma_f32 v[78:79], v[78:79], v[72:73], v[74:75] op_sel_hi:[1,0,0]
    v_cvt_pk_bf16_f32 v17, v78, v79
    v_lshlrev_b32 v80, 16, v18
    v_and_b32 v81, 0xffff0000, v18
    v_pk_fma_f32 v[80:81], v[80:81], v[72:73], v[74:75] op_sel_hi:[1,0,0]
    v_cvt_pk_bf16_f32 v18, v80, v81
    v_lshlrev_b32 v82, 16, v19
    v_and_b32 v83, 0xffff0000, v19
    v_pk_fma_f32 v[82:83], v[82:83], v[72:73], v[74:75] op_sel_hi:[1,0,0]
    v_cvt_pk_bf16_f32 v19, v82, v83
    v_lshlrev_b32 v76, 16, v20
    v_and_b32 v77, 0xffff0000, v20
    v_pk_fma_f32 v[76:77], v[76:77], v[72:73], v[74:75] op_sel_hi:[1,0,0]
    v_cvt_pk_bf16_f32 v20, v76, v77
    v_lshlrev_b32 v78, 16, v21
    v_and_b32 v79, 0xffff0000, v21
    v_pk_fma_f32 v[78:79], v[78:79], v[72:73], v[74:75] op_sel_hi:[1,0,0]
    v_cvt_pk_bf16_f32 v21, v78, v79
    v_lshlrev_b32 v80, 16, v22
    v_and_b32 v81, 0xffff0000, v22
    v_pk_fma_f32 v[80:81], v[80:81], v[72:73], v[74:75] op_sel_hi:[1,0,0]
    v_cvt_pk_bf16_f32 v22, v80, v81
    v_lshlrev_b32 v82, 16, v23
    v_and_b32 v83, 0xffff0000, v23
    v_pk_fma_f32 v[82:83], v[82:83], v[72:73], v[74:75] op_sel_hi:[1,0,0]
    v_cvt_pk_bf16_f32 v23, v82, v83
    v_lshlrev_b32 v76, 16, v24
    v_and_b32 v77, 0xffff0000, v24
    v_pk_fma_f32 v[76:77], v[76:77], v[72:73], v[74:75] op_sel_hi:[1,0,0]
    v_cvt_pk_bf16_f32 v24, v76, v77
    v_lshlrev_b32 v78, 16, v25
    v_and_b32 v79, 0xffff0000, v25
    v_pk_fma_f32 v[78:79], v[78:79], v[72:73], v[74:75] op_sel_hi:[1,0,0]
    v_cvt_pk_bf16_f32 v25, v78, v79
    v_lshlrev_b32 v80, 16, v26
    v_and_b32 v81, 0xffff0000, v26
    v_pk_fma_f32 v[80:81], v[80:81], v[72:73], v[74:75] op_sel_hi:[1,0,0]
    v_cvt_pk_bf16_f32 v26, v80, v81
    v_lshlrev_b32 v82, 16, v27
    v_and_b32 v83, 0xffff0000, v27
    v_pk_fma_f32 v[82:83], v[82:83], v[72:73], v[74:75] op_sel_hi:[1,0,0]
    v_cvt_pk_bf16_f32 v27, v82, v83
    v_lshlrev_b32 v76, 16, v28
    v_and_b32 v77, 0xffff0000, v28
    v_pk_fma_f32 v[76:77], v[76:77], v[72:73], v[74:75] op_sel_hi:[1,0,0]
    v_cvt_pk_bf16_f32 v28, v76, v77
    v_lshlrev_b32 v78, 16, v29
    v_and_b32 v79, 0xffff0000, v29
    v_pk_fma_f32 v[78:79], v[78:79], v[72:73], v[74:75] op_sel_hi:[1,0,0]
    v_cvt_pk_bf16_f32 v29, v78, v79
    v_lshlrev_b32 v80, 16, v30
    v_and_b32 v81, 0xffff0000, v30
    v_pk_fma_f32 v[80:81], v[80:81], v[72:73], v[74:75] op_sel_hi:[1,0,0]
    v_cvt_pk_bf16_f32 v30, v80, v81
    v_lshlrev_b32 v82, 16, v31
    v_and_b32 v83, 0xffff0000, v31
    v_pk_fma_f32 v[82:83], v[82:83], v[72:73], v[74:75] op_sel_hi:[1,0,0]
    v_cvt_pk_bf16_f32 v31, v82, v83
    v_lshlrev_b32 v76, 16, v32
    v_and_b32 v77, 0xffff0000, v32
    v_pk_fma_f32 v[76:77], v[76:77], v[72:73], v[74:75] op_sel_hi:[1,0,0]
    v_cvt_pk_bf16_f32 v32, v76, v77
    v_lshlrev_b32 v78, 16, v33
    v_and_b32 v79, 0xffff0000, v33
    v_pk_fma_f32 v[78:79], v[78:79], v[72:73], v[74:75] op_sel_hi:[1,0,0]
    v_cvt_pk_bf16_f32 v33, v78, v79
    v_lshlrev_b32 v80, 16, v34
    v_and_b32 v81, 0xffff0000, v34
    v_pk_fma_f32 v[80:81], v[80:81], v[72:73], v[74:75] op_sel_hi:[1,0,0]
    v_cvt_pk_bf16_f32 v34, v80, v81
    v_lshlrev_b32 v82, 16, v35
    v_and_b32 v83, 0xffff0000, v35
    v_pk_fma_f32 v[82:83], v[82:83], v[72:73], v[74:75] op_sel_hi:[1,0,0]
    v_cvt_pk_bf16_f32 v35, v82, v83
    v_lshlrev_b32 v76, 16, v36
    v_and_b32 v77, 0xffff0000, v36
    v_pk_fma_f32 v[76:77], v[76:77], v[72:73], v[74:75] op_sel_hi:[1,0,0]
    v_cvt_pk_bf16_f32 v36, v76, v77
    v_lshlrev_b32 v78, 16, v37
    v_and_b32 v79, 0xffff0000, v37
    v_pk_fma_f32 v[78:79], v[78:79], v[72:73], v[74:75] op_sel_hi:[1,0,0]
    v_cvt_pk_bf16_f32 v37, v78, v79
    v_lshlrev_b32 v80, 16, v38
    v_and_b32 v81, 0xffff0000, v38
    v_pk_fma_f32 v[80:81], v[80:81], v[72:73], v[74:75] op_sel_hi:[1,0,0]
    v_cvt_pk_bf16_f32 v38, v80, v81
    v_lshlrev_b32 v82, 16, v39
    v_and_b32 v83, 0xffff0000, v39
    v_pk_fma_f32 v[82:83], v[82:83], v[72:73], v[74:75] op_sel_hi:[1,0,0]
    v_cvt_pk_bf16_f32 v39, v82, v83
    v_lshlrev_b32 v76, 16, v40
    v_and_b32 v77, 0xffff0000, v40
    v_pk_fma_f32 v[76:77], v[76:77], v[72:73], v[74:75] op_sel_hi:[1,0,0]
    v_cvt_pk_bf16_f32 v40, v76, v77
    v_lshlrev_b32 v78, 16, v41
    v_and_b32 v79, 0xffff0000, v41
    v_pk_fma_f32 v[78:79], v[78:79], v[72:73], v[74:75] op_sel_hi:[1,0,0]
    v_cvt_pk_bf16_f32 v41, v78, v79
    v_lshlrev_b32 v80, 16, v42
    v_and_b32 v81, 0xffff0000, v42
    v_pk_fma_f32 v[80:81], v[80:81], v[72:73], v[74:75] op_sel_hi:[1,0,0]
    v_cvt_pk_bf16_f32 v42, v80, v81
    v_lshlrev_b32 v82, 16, v43
    v_and_b32 v83, 0xffff0000, v43
    v_pk_fma_f32 v[82:83], v[82:83], v[72:73], v[74:75] op_sel_hi:[1,0,0]
    v_cvt_pk_bf16_f32 v43, v82, v83
    v_lshlrev_b32 v76, 16, v44
    v_and_b32 v77, 0xffff0000, v44
    v_pk_fma_f32 v[76:77], v[76:77], v[72:73], v[74:75] op_sel_hi:[1,0,0]
    v_cvt_pk_bf16_f32 v44, v76, v77
    v_lshlrev_b32 v78, 16, v45
    v_and_b32 v79, 0xffff0000, v45
    v_pk_fma_f32 v[78:79], v[78:79], v[72:73], v[74:75] op_sel_hi:[1,0,0]
    v_cvt_pk_bf16_f32 v45, v78, v79
    v_lshlrev_b32 v80, 16, v46
    v_and_b32 v81, 0xffff0000, v46
    v_pk_fma_f32 v[80:81], v[80:81], v[72:73], v[74:75] op_sel_hi:[1,0,0]
    v_cvt_pk_bf16_f32 v46, v80, v81
    v_lshlrev_b32 v82, 16, v47
    v_and_b32 v83, 0xffff0000, v47
    v_pk_fma_f32 v[82:83], v[82:83], v[72:73], v[74:75] op_sel_hi:[1,0,0]
    v_cvt_pk_bf16_f32 v47, v82, v83
    v_lshlrev_b32 v76, 16, v48
    v_and_b32 v77, 0xffff0000, v48
    v_pk_fma_f32 v[76:77], v[76:77], v[72:73], v[74:75] op_sel_hi:[1,0,0]
    v_cvt_pk_bf16_f32 v48, v76, v77
    v_lshlrev_b32 v78, 16, v49
    v_and_b32 v79, 0xffff0000, v49
    v_pk_fma_f32 v[78:79], v[78:79], v[72:73], v[74:75] op_sel_hi:[1,0,0]
    v_cvt_pk_bf16_f32 v49, v78, v79
    v_lshlrev_b32 v80, 16, v50
    v_and_b32 v81, 0xffff0000, v50
    v_pk_fma_f32 v[80:81], v[80:81], v[72:73], v[74:75] op_sel_hi:[1,0,0]
    v_cvt_pk_bf16_f32 v50, v80, v81
    v_lshlrev_b32 v82, 16, v51
    v_and_b32 v83, 0xffff0000, v51
    v_pk_fma_f32 v[82:83], v[82:83], v[72:73], v[74:75] op_sel_hi:[1,0,0]
    v_cvt_pk_bf16_f32 v51, v82, v83
    v_lshlrev_b32 v76, 16, v52
    v_and_b32 v77, 0xffff0000, v52
    v_pk_fma_f32 v[76:77], v[76:77], v[72:73], v[74:75] op_sel_hi:[1,0,0]
    v_cvt_pk_bf16_f32 v52, v76, v77
    v_lshlrev_b32 v78, 16, v53
    v_and_b32 v79, 0xffff0000, v53
    v_pk_fma_f32 v[78:79], v[78:79], v[72:73], v[74:75] op_sel_hi:[1,0,0]
    v_cvt_pk_bf16_f32 v53, v78, v79
    v_lshlrev_b32 v80, 16, v54
    v_and_b32 v81, 0xffff0000, v54
    v_pk_fma_f32 v[80:81], v[80:81], v[72:73], v[74:75] op_sel_hi:[1,0,0]
    v_cvt_pk_bf16_f32 v54, v80, v81
    v_lshlrev_b32 v82, 16, v55
    v_and_b32 v83, 0xffff0000, v55
    v_pk_fma_f32 v[82:83], v[82:83], v[72:73], v[74:75] op_sel_hi:[1,0,0]
    v_cvt_pk_bf16_f32 v55, v82, v83
    v_lshlrev_b32 v76, 16, v56
    v_and_b32 v77, 0xffff0000, v56
    v_pk_fma_f32 v[76:77], v[76:77], v[72:73], v[74:75] op_sel_hi:[1,0,0]
    v_cvt_pk_bf16_f32 v56, v76, v77
    v_lshlrev_b32 v78, 16, v57
    v_and_b32 v79, 0xffff0000, v57
    v_pk_fma_f32 v[78:79], v[78:79], v[72:73], v[74:75] op_sel_hi:[1,0,0]
    v_cvt_pk_bf16_f32 v57, v78, v79
    v_lshlrev_b32 v80, 16, v58
    v_and_b32 v81, 0xffff0000, v58
    v_pk_fma_f32 v[80:81], v[80:81], v[72:73], v[74:75] op_sel_hi:[1,0,0]
    v_cvt_pk_bf16_f32 v58, v80, v81
    v_lshlrev_b32 v82, 16, v59
    v_and_b32 v83, 0xffff0000, v59
    v_pk_fma_f32 v[82:83], v[82:83], v[72:73], v[74:75] op_sel_hi:[1,0,0]
    v_cvt_pk_bf16_f32 v59, v82, v83
    v_lshlrev_b32 v76, 16, v60
    v_and_b32 v77, 0xffff0000, v60
    v_pk_fma_f32 v[76:77], v[76:77], v[72:73], v[74:75] op_sel_hi:[1,0,0]
    v_cvt_pk_bf16_f32 v60, v76, v77
    v_lshlrev_b32 v78, 16, v61
    v_and_b32 v79, 0xffff0000, v61
    v_pk_fma_f32 v[78:79], v[78:79], v[72:73], v[74:75] op_sel_hi:[1,0,0]
    v_cvt_pk_bf16_f32 v61, v78, v79
    v_lshlrev_b32 v80, 16, v62
    v_and_b32 v81, 0xffff0000, v62
    v_pk_fma_f32 v[80:81], v[80:81], v[72:73], v[74:75] op_sel_hi:[1,0,0]
    v_cvt_pk_bf16_f32 v62, v80, v81
    v_lshlrev_b32 v82, 16, v63
    v_and_b32 v83, 0xffff0000, v63
    v_pk_fma_f32 v[82:83], v[82:83], v[72:73], v[74:75] op_sel_hi:[1,0,0]
    v_cvt_pk_bf16_f32 v63, v82, v83
    v_lshlrev_b32 v76, 16, v64
    v_and_b32 v77, 0xffff0000, v64
    v_pk_fma_f32 v[76:77], v[76:77], v[72:73], v[74:75] op_sel_hi:[1,0,0]
    v_cvt_pk_bf16_f32 v64, v76, v77
    v_lshlrev_b32 v78, 16, v65
    v_and_b32 v79, 0xffff0000, v65
    v_pk_fma_f32 v[78:79], v[78:79], v[72:73], v[74:75] op_sel_hi:[1,0,0]
    v_cvt_pk_bf16_f32 v65, v78, v79
    v_lshlrev_b32 v80, 16, v66
    v_and_b32 v81, 0xffff0000, v66
    v_pk_fma_f32 v[80:81], v[80:81], v[72:73], v[74:75] op_sel_hi:[1,0,0]
    v_cvt_pk_bf16_f32 v66, v80, v81
    v_lshlrev_b32 v82, 16, v67
    v_and_b32 v83, 0xffff0000, v67
    v_pk_fma_f32 v[82:83], v[82:83], v[72:73], v[74:75] op_sel_hi:[1,0,0]
    v_cvt_pk_bf16_f32 v67, v82, v83
    v_lshlrev_b32 v76, 16, v68
    v_and_b32 v77, 0xffff0000, v68
    v_pk_fma_f32 v[76:77], v[76:77], v[72:73], v[74:75] op_sel_hi:[1,0,0]
    v_cvt_pk_bf16_f32 v68, v76, v77
    v_lshlrev_b32 v78, 16, v69
    v_and_b32 v79, 0xffff0000, v69
    v_pk_fma_f32 v[78:79], v[78:79], v[72:73], v[74:75] op_sel_hi:[1,0,0]
    v_cvt_pk_bf16_f32 v69, v78, v79
    v_lshlrev_b32 v80, 16, v70
    v_and_b32 v81, 0xffff0000, v70
    v_pk_fma_f32 v[80:81], v[80:81], v[72:73], v[74:75] op_sel_hi:[1,0,0]
    v_cvt_pk_bf16_f32 v70, v80, v81
    v_lshlrev_b32 v82, 16, v71
    v_and_b32 v83, 0xffff0000, v71
    v_pk_fma_f32 v[82:83], v[82:83], v[72:73], v[74:75] op_sel_hi:[1,0,0]
    v_cvt_pk_bf16_f32 v71, v82, v83
    s_barrier
    ds_read_b128 v[80:83], v2 offset:28672
    ds_read_b128 v[84:87], v2 offset:43008
    ds_read_b128 v[88:91], v2 offset:57344
    ds_read_b128 v[92:95], v5 offset:6144
    ds_read_b128 v[104:107], v2 offset:29696
    ds_read_b128 v[108:111], v2 offset:44032
    ds_read_b128 v[112:115], v2 offset:58368
    ds_read_b128 v[116:119], v5 offset:7168
    s_waitcnt lgkmcnt(4)
    v_mfma_f32_16x16x32_bf16 v[136:139], v[80:83], v[16:19], 0
    v_mfma_f32_16x16x32_bf16 v[140:143], v[84:87], v[16:19], 0
    v_mfma_f32_16x16x32_bf16 v[144:147], v[16:19], v[88:91], 0
    v_mfma_f32_16x16x32_bf16 v[148:151], v[16:19], v[92:95], 0
    ds_read_b128 v[80:83], v2 offset:30720
    ds_read_b128 v[84:87], v2 offset:45056
    ds_read_b128 v[88:91], v2 offset:59392
    ds_read_b128 v[92:95], v5 offset:8192
    s_waitcnt lgkmcnt(4)
    v_mfma_f32_16x16x32_bf16 v[136:139], v[104:107], v[20:23], v[136:139]
    v_mfma_f32_16x16x32_bf16 v[140:143], v[108:111], v[20:23], v[140:143]
    v_mfma_f32_16x16x32_bf16 v[144:147], v[20:23], v[112:115], v[144:147]
    v_mfma_f32_16x16x32_bf16 v[148:151], v[20:23], v[116:119], v[148:151]
    ds_read_b128 v[104:107], v2 offset:31744
    ds_read_b128 v[108:111], v2 offset:46080
    ds_read_b128 v[112:115], v2 offset:60416
    ds_read_b128 v[116:119], v5 offset:9216
    s_waitcnt lgkmcnt(4)
    v_mfma_f32_16x16x32_bf16 v[136:139], v[80:83], v[24:27], v[136:139]
    v_mfma_f32_16x16x32_bf16 v[140:143], v[84:87], v[24:27], v[140:143]
    v_mfma_f32_16x16x32_bf16 v[144:147], v[24:27], v[88:91], v[144:147]
    v_mfma_f32_16x16x32_bf16 v[148:151], v[24:27], v[92:95], v[148:151]
    ds_read_b128 v[80:83], v2 offset:32768
    ds_read_b128 v[84:87], v2 offset:47104
    ds_read_b128 v[88:91], v2 offset:61440
    ds_read_b128 v[92:95], v5 offset:10240
    s_waitcnt lgkmcnt(4)
    v_mfma_f32_16x16x32_bf16 v[136:139], v[104:107], v[28:31], v[136:139]
    v_mfma_f32_16x16x32_bf16 v[140:143], v[108:111], v[28:31], v[140:143]
    v_mfma_f32_16x16x32_bf16 v[144:147], v[28:31], v[112:115], v[144:147]
    v_mfma_f32_16x16x32_bf16 v[148:151], v[28:31], v[116:119], v[148:151]
    ds_read_b128 v[104:107], v2 offset:33792
    ds_read_b128 v[108:111], v2 offset:48128
    ds_read_b128 v[112:115], v2 offset:62464
    ds_read_b128 v[116:119], v5 offset:11264
    s_waitcnt lgkmcnt(4)
    v_mfma_f32_16x16x32_bf16 v[136:139], v[80:83], v[32:35], v[136:139]
    v_mfma_f32_16x16x32_bf16 v[140:143], v[84:87], v[32:35], v[140:143]
    v_mfma_f32_16x16x32_bf16 v[144:147], v[32:35], v[88:91], v[144:147]
    v_mfma_f32_16x16x32_bf16 v[148:151], v[32:35], v[92:95], v[148:151]
    ds_read_b128 v[80:83], v2 offset:34816
    ds_read_b128 v[84:87], v2 offset:49152
    ds_read_b128 v[88:91], v2 offset:63488
    ds_read_b128 v[92:95], v5 offset:12288
    s_waitcnt lgkmcnt(4)
    v_mfma_f32_16x16x32_bf16 v[136:139], v[104:107], v[36:39], v[136:139]
    v_mfma_f32_16x16x32_bf16 v[140:143], v[108:111], v[36:39], v[140:143]
    v_mfma_f32_16x16x32_bf16 v[144:147], v[36:39], v[112:115], v[144:147]
    v_mfma_f32_16x16x32_bf16 v[148:151], v[36:39], v[116:119], v[148:151]
    ds_read_b128 v[104:107], v2 offset:35840
    ds_read_b128 v[108:111], v2 offset:50176
    ds_read_b128 v[112:115], v2 offset:64512
    ds_read_b128 v[116:119], v5 offset:13312
    s_waitcnt lgkmcnt(4)
    v_mfma_f32_16x16x32_bf16 v[136:139], v[80:83], v[40:43], v[136:139]
    v_mfma_f32_16x16x32_bf16 v[140:143], v[84:87], v[40:43], v[140:143]
    v_mfma_f32_16x16x32_bf16 v[144:147], v[40:43], v[88:91], v[144:147]
    v_mfma_f32_16x16x32_bf16 v[148:151], v[40:43], v[92:95], v[148:151]
    ds_read_b128 v[80:83], v2 offset:36864
    ds_read_b128 v[84:87], v2 offset:51200
    ds_read_b128 v[88:91], v5 offset:0
    ds_read_b128 v[92:95], v5 offset:14336
    s_waitcnt lgkmcnt(4)
    v_mfma_f32_16x16x32_bf16 v[136:139], v[104:107], v[44:47], v[136:139]
    v_mfma_f32_16x16x32_bf16 v[140:143], v[108:111], v[44:47], v[140:143]
    v_mfma_f32_16x16x32_bf16 v[144:147], v[44:47], v[112:115], v[144:147]
    v_mfma_f32_16x16x32_bf16 v[148:151], v[44:47], v[116:119], v[148:151]
    ds_read_b128 v[104:107], v2 offset:37888
    ds_read_b128 v[108:111], v2 offset:52224
    ds_read_b128 v[112:115], v5 offset:1024
    ds_read_b128 v[116:119], v5 offset:15360
    s_waitcnt lgkmcnt(4)
    v_mfma_f32_16x16x32_bf16 v[136:139], v[80:83], v[48:51], v[136:139]
    v_mfma_f32_16x16x32_bf16 v[140:143], v[84:87], v[48:51], v[140:143]
    v_mfma_f32_16x16x32_bf16 v[144:147], v[48:51], v[88:91], v[144:147]
    v_mfma_f32_16x16x32_bf16 v[148:151], v[48:51], v[92:95], v[148:151]
    ds_read_b128 v[80:83], v2 offset:38912
    ds_read_b128 v[84:87], v2 offset:53248
    ds_read_b128 v[88:91], v5 offset:2048
    ds_read_b128 v[92:95], v5 offset:16384
    s_waitcnt lgkmcnt(4)
    v_mfma_f32_16x16x32_bf16 v[136:139], v[104:107], v[52:55], v[136:139]
    v_mfma_f32_16x16x32_bf16 v[140:143], v[108:111], v[52:55], v[140:143]
    v_mfma_f32_16x16x32_bf16 v[144:147], v[52:55], v[112:115], v[144:147]
    v_mfma_f32_16x16x32_bf16 v[148:151], v[52:55], v[116:119], v[148:151]
    ds_read_b128 v[104:107], v2 offset:39936
    ds_read_b128 v[108:111], v2 offset:54272
    ds_read_b128 v[112:115], v5 offset:3072
    ds_read_b128 v[116:119], v5 offset:17408
    s_waitcnt lgkmcnt(4)
    v_mfma_f32_16x16x32_bf16 v[136:139], v[80:83], v[56:59], v[136:139]
    v_mfma_f32_16x16x32_bf16 v[140:143], v[84:87], v[56:59], v[140:143]
    v_mfma_f32_16x16x32_bf16 v[144:147], v[56:59], v[88:91], v[144:147]
    v_mfma_f32_16x16x32_bf16 v[148:151], v[56:59], v[92:95], v[148:151]
    ds_read_b128 v[80:83], v2 offset:40960
    ds_read_b128 v[84:87], v2 offset:55296
    ds_read_b128 v[88:91], v5 offset:4096
    ds_read_b128 v[92:95], v5 offset:18432
    s_waitcnt lgkmcnt(4)
    v_mfma_f32_16x16x32_bf16 v[136:139], v[104:107], v[60:63], v[136:139]
    v_mfma_f32_16x16x32_bf16 v[140:143], v[108:111], v[60:63], v[140:143]
    v_mfma_f32_16x16x32_bf16 v[144:147], v[60:63], v[112:115], v[144:147]
    v_mfma_f32_16x16x32_bf16 v[148:151], v[60:63], v[116:119], v[148:151]
    ds_read_b128 v[104:107], v2 offset:41984
    ds_read_b128 v[108:111], v2 offset:56320
    ds_read_b128 v[112:115], v5 offset:5120
    ds_read_b128 v[116:119], v5 offset:19456
    s_waitcnt lgkmcnt(4)
    v_mfma_f32_16x16x32_bf16 v[136:139], v[80:83], v[64:67], v[136:139]
    v_mfma_f32_16x16x32_bf16 v[140:143], v[84:87], v[64:67], v[140:143]
    v_mfma_f32_16x16x32_bf16 v[144:147], v[64:67], v[88:91], v[144:147]
    v_mfma_f32_16x16x32_bf16 v[148:151], v[64:67], v[92:95], v[148:151]
    s_waitcnt lgkmcnt(0)
    v_mfma_f32_16x16x32_bf16 v[136:139], v[104:107], v[68:71], v[136:139]
    v_mfma_f32_16x16x32_bf16 v[140:143], v[108:111], v[68:71], v[140:143]
    v_mfma_f32_16x16x32_bf16 v[144:147], v[68:71], v[112:115], v[144:147]
    v_mfma_f32_16x16x32_bf16 v[148:151], v[68:71], v[116:119], v[148:151]
    ds_read_b128 v[80:83], v5 offset:20480
    ds_read_b128 v[84:87], v5 offset:21504
    s_nop 2
    v_cvt_pk_bf16_f32 v92, v136, v137
    v_cvt_pk_bf16_f32 v93, v138, v139
    v_cvt_pk_bf16_f32 v94, v140, v141
    v_cvt_pk_bf16_f32 v95, v142, v143
    s_waitcnt lgkmcnt(0)
    s_nop 0
    v_mfma_f32_16x16x32_bf16 v[104:107], v[92:95], v[80:83], 0
    v_mfma_f32_16x16x32_bf16 v[108:111], v[92:95], v[84:87], 0
    v_cndmask_b32 v148, v148, 1.0, s[56:57]
    v_cndmask_b32 v149, v149, 1.0, s[56:57]
    v_cndmask_b32 v150, v150, 1.0, s[56:57]
    v_cndmask_b32 v151, v151, 1.0, s[56:57]
    v_cvt_pk_bf16_f32 v112, v144, v145
    v_cvt_pk_bf16_f32 v113, v146, v147
    v_cvt_pk_bf16_f32 v114, v148, v149
    v_cvt_pk_bf16_f32 v115, v150, v151
    v_cvt_pk_bf16_f32 v105, v104, v105
    v_lshlrev_b32 v104, 16, v105
    v_and_b32 v105, 0xffff0000, v105
    v_cvt_pk_bf16_f32 v107, v106, v107
    v_lshlrev_b32 v106, 16, v107
    v_and_b32 v107, 0xffff0000, v107
    v_cvt_pk_bf16_f32 v109, v108, v109
    v_lshlrev_b32 v108, 16, v109
    v_and_b32 v109, 0xffff0000, v109
    v_cvt_pk_bf16_f32 v111, v110, v111
    v_lshlrev_b32 v110, 16, v111
    v_and_b32 v111, 0xffff0000, v111
    v_max_f32 v184, v104, v108
    v_min_f32 v188, v104, v108
    v_max_f32 v185, v105, v109
    v_min_f32 v189, v105, v109
    v_max_f32 v186, v106, v110
    v_min_f32 v190, v106, v110
    v_max_f32 v187, v107, v111
    v_min_f32 v191, v107, v111
    v_cndmask_b32 v184, v184, v104, s[54:55]
    v_cndmask_b32 v188, v188, v104, s[54:55]
    v_cndmask_b32 v185, v185, v105, s[54:55]
    v_cndmask_b32 v189, v189, v105, s[54:55]
    v_cndmask_b32 v186, v186, v106, s[54:55]
    v_cndmask_b32 v190, v190, v106, s[54:55]
    v_cndmask_b32 v187, v187, v107, s[54:55]
    v_cndmask_b32 v191, v191, v107, s[54:55]
    v_max_f32_dpp v184, v184, v184 row_ror:8 row_mask:0xf bank_mask:0xf
    v_min_f32_dpp v188, v188, v188 row_ror:8 row_mask:0xf bank_mask:0xf
    v_max_f32_dpp v185, v185, v185 row_ror:8 row_mask:0xf bank_mask:0xf
    v_min_f32_dpp v189, v189, v189 row_ror:8 row_mask:0xf bank_mask:0xf
    v_max_f32_dpp v186, v186, v186 row_ror:8 row_mask:0xf bank_mask:0xf
    v_min_f32_dpp v190, v190, v190 row_ror:8 row_mask:0xf bank_mask:0xf
    v_max_f32_dpp v187, v187, v187 row_ror:8 row_mask:0xf bank_mask:0xf
    v_min_f32_dpp v191, v191, v191 row_ror:8 row_mask:0xf bank_mask:0xf
    v_max_f32_dpp v184, v184, v184 row_ror:4 row_mask:0xf bank_mask:0xf
    v_min_f32_dpp v188, v188, v188 row_ror:4 row_mask:0xf bank_mask:0xf
    v_max_f32_dpp v185, v185, v185 row_ror:4 row_mask:0xf bank_mask:0xf
    v_min_f32_dpp v189, v189, v189 row_ror:4 row_mask:0xf bank_mask:0xf
    v_max_f32_dpp v186, v186, v186 row_ror:4 row_mask:0xf bank_mask:0xf
    v_min_f32_dpp v190, v190, v190 row_ror:4 row_mask:0xf bank_mask:0xf
    v_max_f32_dpp v187, v187, v187 row_ror:4 row_mask:0xf bank_mask:0xf
    v_min_f32_dpp v191, v191, v191 row_ror:4 row_mask:0xf bank_mask:0xf
    v_max_f32_dpp v184, v184, v184 row_ror:2 row_mask:0xf bank_mask:0xf
    v_min_f32_dpp v188, v188, v188 row_ror:2 row_mask:0xf bank_mask:0xf
    v_max_f32_dpp v185, v185, v185 row_ror:2 row_mask:0xf bank_mask:0xf
    v_min_f32_dpp v189, v189, v189 row_ror:2 row_mask:0xf bank_mask:0xf
    v_max_f32_dpp v186, v186, v186 row_ror:2 row_mask:0xf bank_mask:0xf
    v_min_f32_dpp v190, v190, v190 row_ror:2 row_mask:0xf bank_mask:0xf
    v_max_f32_dpp v187, v187, v187 row_ror:2 row_mask:0xf bank_mask:0xf
    v_min_f32_dpp v191, v191, v191 row_ror:2 row_mask:0xf bank_mask:0xf
    v_max_f32_dpp v184, v184, v184 row_ror:1 row_mask:0xf bank_mask:0xf
    v_min_f32_dpp v188, v188, v188 row_ror:1 row_mask:0xf bank_mask:0xf
    v_max_f32_dpp v185, v185, v185 row_ror:1 row_mask:0xf bank_mask:0xf
    v_min_f32_dpp v189, v189, v189 row_ror:1 row_mask:0xf bank_mask:0xf
    v_max_f32_dpp v186, v186, v186 row_ror:1 row_mask:0xf bank_mask:0xf
    v_min_f32_dpp v190, v190, v190 row_ror:1 row_mask:0xf bank_mask:0xf
    v_max_f32_dpp v187, v187, v187 row_ror:1 row_mask:0xf bank_mask:0xf
    v_min_f32_dpp v191, v191, v191 row_ror:1 row_mask:0xf bank_mask:0xf
    v_mul_f32 v184, s61, v184
    v_mul_f32 v188, s61, v188
    v_mul_f32 v185, s61, v185
    v_mul_f32 v189, s61, v189
    v_mul_f32 v186, s61, v186
    v_mul_f32 v190, s61, v190
    v_mul_f32 v187, s61, v187
    v_mul_f32 v191, s61, v191
    v_fma_f32 v192, v104, s61, -v184
    v_fma_f32 v200, -v104, s61, v188
    v_fma_f32 v193, v105, s61, -v185
    v_fma_f32 v201, -v105, s61, v189
    v_fma_f32 v194, v106, s61, -v186
    v_fma_f32 v202, -v106, s61, v190
    v_fma_f32 v195, v107, s61, -v187
    v_fma_f32 v203, -v107, s61, v191
    v_fma_f32 v196, v108, s61, -v184
    v_fma_f32 v204, -v108, s61, v188
    v_fma_f32 v197, v109, s61, -v185
    v_fma_f32 v205, -v109, s61, v189
    v_fma_f32 v198, v110, s61, -v186
    v_fma_f32 v206, -v110, s61, v190
    v_fma_f32 v199, v111, s61, -v187
    v_fma_f32 v207, -v111, s61, v191
    v_exp_f32 v192, v192
    v_exp_f32 v200, v200
    v_exp_f32 v193, v193
    v_exp_f32 v201, v201
    v_exp_f32 v194, v194
    v_exp_f32 v202, v202
    v_exp_f32 v195, v195
    v_exp_f32 v203, v203
    v_exp_f32 v196, v196
    v_exp_f32 v204, v204
    v_exp_f32 v197, v197
    v_exp_f32 v205, v205
    v_exp_f32 v198, v198
    v_exp_f32 v206, v206
    v_exp_f32 v199, v199
    v_exp_f32 v207, v207
    v_cndmask_b32 v196, v196, 0, s[54:55]
    v_cndmask_b32 v204, v204, 0, s[54:55]
    v_cndmask_b32 v197, v197, 0, s[54:55]
    v_cndmask_b32 v205, v205, 0, s[54:55]
    v_cndmask_b32 v198, v198, 0, s[54:55]
    v_cndmask_b32 v206, v206, 0, s[54:55]
    v_cndmask_b32 v199, v199, 0, s[54:55]
    v_cndmask_b32 v207, v207, 0, s[54:55]
    v_add_f32 v184, v192, v196
    v_add_f32 v188, v200, v204
    v_add_f32 v185, v193, v197
    v_add_f32 v189, v201, v205
    v_add_f32 v186, v194, v198
    v_add_f32 v190, v202, v206
    v_add_f32 v187, v195, v199
    v_add_f32 v191, v203, v207
    v_add_f32_dpp v184, v184, v184 row_ror:8 row_mask:0xf bank_mask:0xf
    v_add_f32_dpp v185, v185, v185 row_ror:8 row_mask:0xf bank_mask:0xf
    v_add_f32_dpp v186, v186, v186 row_ror:8 row_mask:0xf bank_mask:0xf
    v_add_f32_dpp v187, v187, v187 row_ror:8 row_mask:0xf bank_mask:0xf
    v_add_f32_dpp v188, v188, v188 row_ror:8 row_mask:0xf bank_mask:0xf
    v_add_f32_dpp v189, v189, v189 row_ror:8 row_mask:0xf bank_mask:0xf
    v_add_f32_dpp v190, v190, v190 row_ror:8 row_mask:0xf bank_mask:0xf
    v_add_f32_dpp v191, v191, v191 row_ror:8 row_mask:0xf bank_mask:0xf
    v_add_f32_dpp v184, v184, v184 row_ror:4 row_mask:0xf bank_mask:0xf
    v_add_f32_dpp v185, v185, v185 row_ror:4 row_mask:0xf bank_mask:0xf
    v_add_f32_dpp v186, v186, v186 row_ror:4 row_mask:0xf bank_mask:0xf
    v_add_f32_dpp v187, v187, v187 row_ror:4 row_mask:0xf bank_mask:0xf
    v_add_f32_dpp v188, v188, v188 row_ror:4 row_mask:0xf bank_mask:0xf
    v_add_f32_dpp v189, v189, v189 row_ror:4 row_mask:0xf bank_mask:0xf
    v_add_f32_dpp v190, v190, v190 row_ror:4 row_mask:0xf bank_mask:0xf
    v_add_f32_dpp v191, v191, v191 row_ror:4 row_mask:0xf bank_mask:0xf
    v_add_f32_dpp v184, v184, v184 row_ror:2 row_mask:0xf bank_mask:0xf
    v_add_f32_dpp v185, v185, v185 row_ror:2 row_mask:0xf bank_mask:0xf
    v_add_f32_dpp v186, v186, v186 row_ror:2 row_mask:0xf bank_mask:0xf
    v_add_f32_dpp v187, v187, v187 row_ror:2 row_mask:0xf bank_mask:0xf
    v_add_f32_dpp v188, v188, v188 row_ror:2 row_mask:0xf bank_mask:0xf
    v_add_f32_dpp v189, v189, v189 row_ror:2 row_mask:0xf bank_mask:0xf
    v_add_f32_dpp v190, v190, v190 row_ror:2 row_mask:0xf bank_mask:0xf
    v_add_f32_dpp v191, v191, v191 row_ror:2 row_mask:0xf bank_mask:0xf
    v_add_f32_dpp v184, v184, v184 row_ror:1 row_mask:0xf bank_mask:0xf
    v_add_f32_dpp v185, v185, v185 row_ror:1 row_mask:0xf bank_mask:0xf
    v_add_f32_dpp v186, v186, v186 row_ror:1 row_mask:0xf bank_mask:0xf
    v_add_f32_dpp v187, v187, v187 row_ror:1 row_mask:0xf bank_mask:0xf
    v_add_f32_dpp v188, v188, v188 row_ror:1 row_mask:0xf bank_mask:0xf
    v_add_f32_dpp v189, v189, v189 row_ror:1 row_mask:0xf bank_mask:0xf
    v_add_f32_dpp v190, v190, v190 row_ror:1 row_mask:0xf bank_mask:0xf
    v_add_f32_dpp v191, v191, v191 row_ror:1 row_mask:0xf bank_mask:0xf
    v_rcp_f32 v184, v184
    v_rcp_f32 v188, v188
    v_rcp_f32 v185, v185
    v_rcp_f32 v189, v189
    v_rcp_f32 v186, v186
    v_rcp_f32 v190, v190
    v_rcp_f32 v187, v187
    v_rcp_f32 v191, v191
    v_mul_f32 v192, v192, v184
    v_mul_f32 v200, v200, v188
    v_mul_f32 v193, v193, v185
    v_mul_f32 v201, v201, v189
    v_mul_f32 v194, v194, v186
    v_mul_f32 v202, v202, v190
    v_mul_f32 v195, v195, v187
    v_mul_f32 v203, v203, v191
    v_mul_f32 v196, v196, v184
    v_mul_f32 v204, v204, v188
    v_mul_f32 v197, v197, v185
    v_mul_f32 v205, v205, v189
    v_mul_f32 v198, v198, v186
    v_mul_f32 v206, v206, v190
    v_mul_f32 v199, v199, v187
    v_mul_f32 v207, v207, v191
    v_cvt_pk_bf16_f32 v208, v192, v193
    v_cvt_pk_bf16_f32 v209, v194, v195
    v_cvt_pk_bf16_f32 v210, v196, v197
    v_cvt_pk_bf16_f32 v211, v198, v199
    v_cvt_pk_bf16_f32 v212, v200, v201
    v_cvt_pk_bf16_f32 v213, v202, v203
    v_cvt_pk_bf16_f32 v214, v204, v205
    v_cvt_pk_bf16_f32 v215, v206, v207
    v_mfma_f32_16x16x16_bf16 v[216:219], v[208:209], v[112:113], 0
    v_mfma_f32_16x16x16_bf16 v[220:223], v[210:211], v[112:113], 0
    v_mfma_f32_16x16x16_bf16 v[224:227], v[208:209], v[114:115], 0
    v_mfma_f32_16x16x16_bf16 v[228:231], v[210:211], v[114:115], 0
    v_mfma_f32_16x16x16_bf16 v[232:235], v[212:213], v[112:113], 0
    v_mfma_f32_16x16x16_bf16 v[236:239], v[214:215], v[112:113], 0
    v_mfma_f32_16x16x16_bf16 v[240:243], v[212:213], v[114:115], 0
    v_mfma_f32_16x16x16_bf16 v[244:247], v[214:215], v[114:115], 0
    v_lshlrev_b32 v6, 2, v1
    s_lshl_b32 s44, s3, 13
    s_add_u32 s44, s44, 88064
    v_add_u32 v7, s44, v6
    ds_write_b32 v7, v216 offset:0
    ds_write_b32 v7, v217 offset:256
    ds_write_b32 v7, v218 offset:512
    ds_write_b32 v7, v219 offset:768
    ds_write_b32 v7, v220 offset:1024
    ds_write_b32 v7, v221 offset:1280
    ds_write_b32 v7, v222 offset:1536
    ds_write_b32 v7, v223 offset:1792
    ds_write_b32 v7, v224 offset:2048
    ds_write_b32 v7, v225 offset:2304
    ds_write_b32 v7, v226 offset:2560
    ds_write_b32 v7, v227 offset:2816
    ds_write_b32 v7, v228 offset:3072
    ds_write_b32 v7, v229 offset:3328
    ds_write_b32 v7, v230 offset:3584
    ds_write_b32 v7, v231 offset:3840
    ds_write_b32 v7, v232 offset:4096
    ds_write_b32 v7, v233 offset:4352
    ds_write_b32 v7, v234 offset:4608
    ds_write_b32 v7, v235 offset:4864
    ds_write_b32 v7, v236 offset:5120
    ds_write_b32 v7, v237 offset:5376
    ds_write_b32 v7, v238 offset:5632
    ds_write_b32 v7, v239 offset:5888
    ds_write_b32 v7, v240 offset:6144
    ds_write_b32 v7, v241 offset:6400
    ds_write_b32 v7, v242 offset:6656
    ds_write_b32 v7, v243 offset:6912
    ds_write_b32 v7, v244 offset:7168
    ds_write_b32 v7, v245 offset:7424
    ds_write_b32 v7, v246 offset:7680
    ds_write_b32 v7, v247 offset:7936
    s_waitcnt lgkmcnt(0)
    s_barrier
    s_lshl_b32 s44, s3, 10
    s_add_u32 s44, s44, 88064
    v_add_u32 v7, s44, v6
    ds_read_b32 v216, v7 offset:0
    ds_read_b32 v217, v7 offset:8192
    ds_read_b32 v218, v7 offset:16384
    ds_read_b32 v219, v7 offset:24576
    ds_read_b32 v220, v7 offset:32768
    ds_read_b32 v221, v7 offset:40960
    ds_read_b32 v222, v7 offset:49152
    ds_read_b32 v223, v7 offset:57344
    ds_read_b32 v224, v7 offset:256
    ds_read_b32 v225, v7 offset:8448
    ds_read_b32 v226, v7 offset:16640
    ds_read_b32 v227, v7 offset:24832
    ds_read_b32 v228, v7 offset:33024
    ds_read_b32 v229, v7 offset:41216
    ds_read_b32 v230, v7 offset:49408
    ds_read_b32 v231, v7 offset:57600
    ds_read_b32 v232, v7 offset:512
    ds_read_b32 v233, v7 offset:8704
    ds_read_b32 v234, v7 offset:16896
    ds_read_b32 v235, v7 offset:25088
    ds_read_b32 v236, v7 offset:33280
    ds_read_b32 v237, v7 offset:41472
    ds_read_b32 v238, v7 offset:49664
    ds_read_b32 v239, v7 offset:57856
    ds_read_b32 v240, v7 offset:768
    ds_read_b32 v241, v7 offset:8960
    ds_read_b32 v242, v7 offset:17152
    ds_read_b32 v243, v7 offset:25344
    ds_read_b32 v244, v7 offset:33536
    ds_read_b32 v245, v7 offset:41728
    ds_read_b32 v246, v7 offset:49920
    ds_read_b32 v247, v7 offset:58112
    s_waitcnt lgkmcnt(0)
    v_add_f32 v216, v216, v217
    v_add_f32 v218, v218, v219
    v_add_f32 v220, v220, v221
    v_add_f32 v222, v222, v223
    v_add_f32 v216, v216, v218
    v_add_f32 v220, v220, v222
    v_add_f32 v216, v216, v220
    v_add_f32 v224, v224, v225
    v_add_f32 v226, v226, v227
    v_add_f32 v228, v228, v229
    v_add_f32 v230, v230, v231
    v_add_f32 v224, v224, v226
    v_add_f32 v228, v228, v230
    v_add_f32 v224, v224, v228
    v_add_f32 v232, v232, v233
    v_add_f32 v234, v234, v235
    v_add_f32 v236, v236, v237
    v_add_f32 v238, v238, v239
    v_add_f32 v232, v232, v234
    v_add_f32 v236, v236, v238
    v_add_f32 v232, v232, v236
    v_add_f32 v240, v240, v241
    v_add_f32 v242, v242, v243
    v_add_f32 v244, v244, v245
    v_add_f32 v246, v246, v247
    v_add_f32 v240, v240, v242
    v_add_f32 v244, v244, v246
    v_add_f32 v240, v240, v244
    s_add_u32 s20, s94, 7790592
    s_addc_u32 s21, s95, 0
    s_mov_b32 s22, 131072
    s_mov_b32 s23, 0x00020000
    s_lshl_b32 s44, s87, 13
    s_lshl_b32 s45, s3, 10
    s_add_u32 s44, s44, s45
    buffer_atomic_add_f32 v216, v6, s[20:23], s44 offen offset:0 sc1
    buffer_atomic_add_f32 v224, v6, s[20:23], s44 offen offset:256 sc1
    buffer_atomic_add_f32 v232, v6, s[20:23], s44 offen offset:512 sc1
    buffer_atomic_add_f32 v240, v6, s[20:23], s44 offen offset:768 sc1
    s_add_u32 s40, s2, 2048
    s_waitcnt vmcnt(0)
    s_barrier
    s_cmp_lg_u32 s3, 0
    s_cbranch_scc1 L_sig_133
    s_add_u32 s28, s94, 7921664
    s_addc_u32 s29, s95, 0
    s_mov_b32 s30, 16384
    s_mov_b32 s31, 0x00020000
    s_lshl_b32 s48, s40, 2
    v_mov_b32 v6, 1
    v_mov_b32 v7, s48
    s_mov_b64 exec, 1
    buffer_store_dword v6, v7, s[28:31], 0 offen sc1
    s_mov_b64 exec, -1
    s_nop 0
L_sig_133:
    ds_read_b128 v[80:83], v2 offset:0
    ds_read_b128 v[84:87], v2 offset:14336
    ds_read_b128 v[104:107], v2 offset:1024
    ds_read_b128 v[108:111], v2 offset:15360
    s_waitcnt lgkmcnt(2)
    v_mfma_f32_16x16x32_bf16 v[128:131], v[80:83], v[16:19], 0
    v_mfma_f32_16x16x32_bf16 v[132:135], v[84:87], v[16:19], 0
    ds_read_b128 v[80:83], v2 offset:2048
    ds_read_b128 v[84:87], v2 offset:16384
    s_waitcnt lgkmcnt(2)
    v_mfma_f32_16x16x32_bf16 v[128:131], v[104:107], v[20:23], v[128:131]
    v_mfma_f32_16x16x32_bf16 v[132:135], v[108:111], v[20:23], v[132:135]
    ds_read_b128 v[104:107], v2 offset:3072
    ds_read_b128 v[108:111], v2 offset:17408
    s_waitcnt lgkmcnt(2)
    v_mfma_f32_16x16x32_bf16 v[128:131], v[80:83], v[24:27], v[128:131]
    v_mfma_f32_16x16x32_bf16 v[132:135], v[84:87], v[24:27], v[132:135]
    ds_read_b128 v[80:83], v2 offset:4096
    ds_read_b128 v[84:87], v2 offset:18432
    s_waitcnt lgkmcnt(2)
    v_mfma_f32_16x16x32_bf16 v[128:131], v[104:107], v[28:31], v[128:131]
    v_mfma_f32_16x16x32_bf16 v[132:135], v[108:111], v[28:31], v[132:135]
    ds_read_b128 v[104:107], v2 offset:5120
    ds_read_b128 v[108:111], v2 offset:19456
    s_waitcnt lgkmcnt(2)
    v_mfma_f32_16x16x32_bf16 v[128:131], v[80:83], v[32:35], v[128:131]
    v_mfma_f32_16x16x32_bf16 v[132:135], v[84:87], v[32:35], v[132:135]
    ds_read_b128 v[80:83], v2 offset:6144
    ds_read_b128 v[84:87], v2 offset:20480
    s_waitcnt lgkmcnt(2)
    v_mfma_f32_16x16x32_bf16 v[128:131], v[104:107], v[36:39], v[128:131]
    v_mfma_f32_16x16x32_bf16 v[132:135], v[108:111], v[36:39], v[132:135]
    ds_read_b128 v[104:107], v2 offset:7168
    ds_read_b128 v[108:111], v2 offset:21504
    s_waitcnt lgkmcnt(2)
    v_mfma_f32_16x16x32_bf16 v[128:131], v[80:83], v[40:43], v[128:131]
    v_mfma_f32_16x16x32_bf16 v[132:135], v[84:87], v[40:43], v[132:135]
    ds_read_b128 v[80:83], v2 offset:8192
    ds_read_b128 v[84:87], v2 offset:22528
    s_waitcnt lgkmcnt(2)
    v_mfma_f32_16x16x32_bf16 v[128:131], v[104:107], v[44:47], v[128:131]
    v_mfma_f32_16x16x32_bf16 v[132:135], v[108:111], v[44:47], v[132:135]
    ds_read_b128 v[104:107], v2 offset:9216
    ds_read_b128 v[108:111], v2 offset:23552
    s_waitcnt lgkmcnt(2)
    v_mfma_f32_16x16x32_bf16 v[128:131], v[80:83], v[48:51], v[128:131]
    v_mfma_f32_16x16x32_bf16 v[132:135], v[84:87], v[48:51], v[132:135]
    ds_read_b128 v[80:83], v2 offset:10240
    ds_read_b128 v[84:87], v2 offset:24576
    s_waitcnt lgkmcnt(2)
    v_mfma_f32_16x16x32_bf16 v[128:131], v[104:107], v[52:55], v[128:131]
    v_mfma_f32_16x16x32_bf16 v[132:135], v[108:111], v[52:55], v[132:135]
    ds_read_b128 v[104:107], v2 offset:11264
    ds_read_b128 v[108:111], v2 offset:25600
    s_waitcnt lgkmcnt(2)
    v_mfma_f32_16x16x32_bf16 v[128:131], v[80:83], v[56:59], v[128:131]
    v_mfma_f32_16x16x32_bf16 v[132:135], v[84:87], v[56:59], v[132:135]
    ds_read_b128 v[80:83], v2 offset:12288
    ds_read_b128 v[84:87], v2 offset:26624
    s_waitcnt lgkmcnt(2)
    v_mfma_f32_16x16x32_bf16 v[128:131], v[104:107], v[60:63], v[128:131]
    v_mfma_f32_16x16x32_bf16 v[132:135], v[108:111], v[60:63], v[132:135]
    ds_read_b128 v[104:107], v2 offset:13312
    ds_read_b128 v[108:111], v2 offset:27648
    s_waitcnt lgkmcnt(2)
    v_mfma_f32_16x16x32_bf16 v[128:131], v[80:83], v[64:67], v[128:131]
    v_mfma_f32_16x16x32_bf16 v[132:135], v[84:87], v[64:67], v[132:135]
    s_waitcnt lgkmcnt(0)
    v_mfma_f32_16x16x32_bf16 v[128:131], v[104:107], v[68:71], v[128:131]
    v_mfma_f32_16x16x32_bf16 v[132:135], v[108:111], v[68:71], v[132:135]
    ds_read_b128 v[80:83], v5 offset:20480
    ds_read_b128 v[84:87], v5 offset:21504
    s_nop 4
    v_cvt_pk_bf16_f32 v88, v128, v129
    v_cvt_pk_bf16_f32 v89, v130, v131
    v_cvt_pk_bf16_f32 v90, v132, v133
    v_cvt_pk_bf16_f32 v91, v134, v135
    s_waitcnt lgkmcnt(0)
    s_nop 0
    v_mfma_f32_16x16x32_bf16 v[96:99], v[80:83], v[88:91], 0
    v_mfma_f32_16x16x32_bf16 v[100:103], v[84:87], v[88:91], 0
    s_nop 6
    v_cvt_pk_bf16_f32 v97, v96, v97
    v_lshlrev_b32 v96, 16, v97
    v_and_b32 v97, 0xffff0000, v97
    v_cvt_pk_bf16_f32 v99, v98, v99
    v_lshlrev_b32 v98, 16, v99
    v_and_b32 v99, 0xffff0000, v99
    v_cvt_pk_bf16_f32 v101, v100, v101
    v_lshlrev_b32 v100, 16, v101
    v_and_b32 v101, 0xffff0000, v101
    v_cvt_pk_bf16_f32 v103, v102, v103
    v_lshlrev_b32 v102, 16, v103
    v_and_b32 v103, 0xffff0000, v103
    s_barrier
    s_cmp_ge_u32 s81, 224
    s_cbranch_scc1 L_k1pre_136
    s_mul_i32 s44, s85, 57344
    s_add_u32 s12, s94, s44
    s_addc_u32 s13, s95, 0
    s_add_u32 s12, s12, 1409024
    s_addc_u32 s13, s13, 0
    s_mov_b32 s14, 57344
    s_mov_b32 s15, 0x00020000
    s_mul_i32 s46, s3, 7
    s_lshl_b32 s44, s46, 10
    s_add_u32 s45, s44, 0
    s_mov_b32 m0, s45
    s_nop 0
    buffer_load_dwordx4 v2, s[12:15], s44 offen offset:0 lds
    buffer_load_dwordx4 v2, s[12:15], s44 offen offset:1024 lds
    buffer_load_dwordx4 v2, s[12:15], s44 offen offset:2048 lds
    buffer_load_dwordx4 v2, s[12:15], s44 offen offset:3072 lds
    s_add_u32 s44, s44, 4096
    s_add_u32 s45, s45, 4096
    s_mov_b32 m0, s45
    s_nop 0
    buffer_load_dwordx4 v2, s[12:15], s44 offen offset:0 lds
    buffer_load_dwordx4 v2, s[12:15], s44 offen offset:1024 lds
    buffer_load_dwordx4 v2, s[12:15], s44 offen offset:2048 lds
L_k1pre_136:
    v_max3_f32 v8, v96, v97, v98
    v_max_f32 v8, v8, v99
    v_min3_f32 v9, v96, v97, v98
    v_min_f32 v9, v9, v99
    v_max3_f32 v10, v100, v101, v102
    v_max3_f32 v10, v10, v103, v8
    v_min3_f32 v11, v100, v101, v102
    v_min3_f32 v11, v11, v103, v9
    v_cndmask_b32 v8, v10, v8, s[52:53]
    v_cndmask_b32 v9, v11, v9, s[52:53]
    v_mov_b32 v10, v8
    s_nop 1
    v_permlane32_swap_b32 v8, v10
    v_max_f32 v8, v8, v10
    v_mov_b32 v10, v8
    s_nop 1
    v_permlane16_swap_b32 v8, v10
    v_max_f32 v8, v8, v10
    v_mov_b32 v11, v9
    s_nop 1
    v_permlane32_swap_b32 v9, v11
    v_min_f32 v9, v9, v11
    v_mov_b32 v11, v9
    s_nop 1
    v_permlane16_swap_b32 v9, v11
    v_min_f32 v9, v9, v11
    v_mul_f32 v8, s61, v8
    v_mul_f32 v9, s61, v9
    v_fma_f32 v16, v96, s61, -v8
    v_fma_f32 v24, -v96, s61, v9
    v_fma_f32 v17, v97, s61, -v8
    v_fma_f32 v25, -v97, s61, v9
    v_fma_f32 v18, v98, s61, -v8
    v_fma_f32 v26, -v98, s61, v9
    v_fma_f32 v19, v99, s61, -v8
    v_fma_f32 v27, -v99, s61, v9
    v_fma_f32 v20, v100, s61, -v8
    v_fma_f32 v28, -v100, s61, v9
    v_fma_f32 v21, v101, s61, -v8
    v_fma_f32 v29, -v101, s61, v9
    v_fma_f32 v22, v102, s61, -v8
    v_fma_f32 v30, -v102, s61, v9
    v_fma_f32 v23, v103, s61, -v8
    v_fma_f32 v31, -v103, s61, v9
    v_exp_f32 v16, v16
    v_exp_f32 v24, v24
    v_exp_f32 v17, v17
    v_exp_f32 v25, v25
    v_exp_f32 v18, v18
    v_exp_f32 v26, v26
    v_exp_f32 v19, v19
    v_exp_f32 v27, v27
    v_exp_f32 v20, v20
    v_exp_f32 v28, v28
    v_exp_f32 v21, v21
    v_exp_f32 v29, v29
    v_exp_f32 v22, v22
    v_exp_f32 v30, v30
    v_exp_f32 v23, v23
    v_exp_f32 v31, v31
    v_cndmask_b32 v20, v20, 0, s[52:53]
    v_cndmask_b32 v28, v28, 0, s[52:53]
    v_cndmask_b32 v21, v21, 0, s[52:53]
    v_cndmask_b32 v29, v29, 0, s[52:53]
    v_cndmask_b32 v22, v22, 0, s[52:53]
    v_cndmask_b32 v30, v30, 0, s[52:53]
    v_cndmask_b32 v23, v23, 0, s[52:53]
    v_cndmask_b32 v31, v31, 0, s[52:53]
    v_add_f32 v8, v16, v17
    v_add_f32 v8, v8, v18
    v_add_f32 v8, v8, v19
    v_add_f32 v8, v8, v20
    v_add_f32 v8, v8, v21
    v_add_f32 v8, v8, v22
    v_add_f32 v8, v8, v23
    v_add_f32 v9, v24, v25
    v_add_f32 v9, v9, v26
    v_add_f32 v9, v9, v27
    v_add_f32 v9, v9, v28
    v_add_f32 v9, v9, v29
    v_add_f32 v9, v9, v30
    v_add_f32 v9, v9, v31
    v_mov_b32 v10, v8
    s_nop 1
    v_permlane32_swap_b32 v8, v10
    v_add_f32 v8, v8, v10
    v_mov_b32 v10, v8
    s_nop 1
    v_permlane16_swap_b32 v8, v10
    v_add_f32 v8, v8, v10
    v_mov_b32 v11, v9
    s_nop 1
    v_permlane32_swap_b32 v9, v11
    v_add_f32 v9, v9, v11
    v_mov_b32 v11, v9
    s_nop 1
    v_permlane16_swap_b32 v9, v11
    v_add_f32 v9, v9, v11
    v_rcp_f32 v8, v8
    v_rcp_f32 v9, v9
    v_mul_f32 v16, v16, v8
    v_mul_f32 v24, v24, v9
    v_mul_f32 v17, v17, v8
    v_mul_f32 v25, v25, v9
    v_mul_f32 v18, v18, v8
    v_mul_f32 v26, v26, v9
    v_mul_f32 v19, v19, v8
    v_mul_f32 v27, v27, v9
    v_mul_f32 v20, v20, v8
    v_mul_f32 v28, v28, v9
    v_mul_f32 v21, v21, v8
    v_mul_f32 v29, v29, v9
    v_mul_f32 v22, v22, v8
    v_mul_f32 v30, v30, v9
    v_mul_f32 v23, v23, v8
    v_mul_f32 v31, v31, v9
    v_cvt_pk_bf16_f32 v176, v16, v17
    v_cvt_pk_bf16_f32 v180, v24, v25
    v_cvt_pk_bf16_f32 v177, v18, v19
    v_cvt_pk_bf16_f32 v181, v26, v27
    v_cvt_pk_bf16_f32 v178, v20, v21
    v_cvt_pk_bf16_f32 v182, v28, v29
    v_cvt_pk_bf16_f32 v179, v22, v23
    v_cvt_pk_bf16_f32 v183, v30, v31
    s_mov_b32 s40, 2048
    s_cmp_lg_u32 s3, 0
    s_cbranch_scc1 L_wsk_137
    s_add_u32 s28, s94, 7921664
    s_addc_u32 s29, s95, 0
    s_mov_b32 s30, 16384
    s_mov_b32 s31, 0x00020000
    s_mov_b32 s50, 0
    s_lshl_b32 s48, s40, 2
    v_add_u32 v6, s48, v2
    s_nop 1
L_wlp_138:
    buffer_load_dwordx4 v[8:11], v6, s[28:31], 0 offen sc1
    s_waitcnt vmcnt(0)
    v_min_u32 v8, v8, v9
    v_min_u32 v10, v10, v11
    v_min_u32 v8, v8, v10
    v_cmp_ne_u32 vcc, 0, v8
    s_nop 0
    s_cmp_eq_u64 vcc, -1
    s_nop 2
    s_cbranch_scc1 L_wdn_139
    s_sleep 1
    s_add_u32 s50, s50, 1
    s_cmp_lt_u32 s50, 65536
    s_cbranch_scc1 L_wlp_138
L_wdn_139:
    s_cmp_eq_u32 s80, 0
    s_cbranch_scc1 L_wsk_137
    buffer_inv sc1
    s_waitcnt vmcnt(0)
L_wsk_137:
    s_barrier
    v_lshlrev_b32 v6, 2, v1
    v_lshlrev_b32 v7, 6, v4
    v_add_u32 v7, 48, v7
    s_lshl_b32 s44, s87, 13
    s_add_u32 s45, s44, 4096
    buffer_load_dword v16, v6, s[20:23], s44 offen offset:0 sc1
    buffer_load_dword v17, v6, s[20:23], s44 offen offset:256 sc1
    buffer_load_dword v18, v6, s[20:23], s44 offen offset:512 sc1
    buffer_load_dword v19, v6, s[20:23], s44 offen offset:768 sc1
    buffer_load_dword v20, v6, s[20:23], s44 offen offset:1024 sc1
    buffer_load_dword v21, v6, s[20:23], s44 offen offset:1280 sc1
    buffer_load_dword v22, v6, s[20:23], s44 offen offset:1536 sc1
    buffer_load_dword v23, v6, s[20:23], s44 offen offset:1792 sc1
    buffer_load_dword v24, v6, s[20:23], s44 offen offset:2048 sc1
    buffer_load_dword v25, v6, s[20:23], s44 offen offset:2304 sc1
    buffer_load_dword v26, v6, s[20:23], s44 offen offset:2560 sc1
    buffer_load_dword v27, v6, s[20:23], s44 offen offset:2816 sc1
    buffer_load_dword v28, v6, s[20:23], s44 offen offset:3072 sc1
    buffer_load_dword v29, v6, s[20:23], s44 offen offset:3328 sc1
    buffer_load_dword v30, v6, s[20:23], s44 offen offset:3584 sc1
    buffer_load_dword v31, v6, s[20:23], s44 offen offset:3840 sc1
    buffer_load_dword v32, v6, s[20:23], s45 offen offset:0 sc1
    buffer_load_dword v33, v6, s[20:23], s45 offen offset:256 sc1
    buffer_load_dword v34, v6, s[20:23], s45 offen offset:512 sc1
    buffer_load_dword v35, v6, s[20:23], s45 offen offset:768 sc1
    buffer_load_dword v36, v6, s[20:23], s45 offen offset:1024 sc1
    buffer_load_dword v37, v6, s[20:23], s45 offen offset:1280 sc1
    buffer_load_dword v38, v6, s[20:23], s45 offen offset:1536 sc1
    buffer_load_dword v39, v6, s[20:23], s45 offen offset:1792 sc1
    buffer_load_dword v40, v6, s[20:23], s45 offen offset:2048 sc1
    buffer_load_dword v41, v6, s[20:23], s45 offen offset:2304 sc1
    buffer_load_dword v42, v6, s[20:23], s45 offen offset:2560 sc1
    buffer_load_dword v43, v6, s[20:23], s45 offen offset:2816 sc1
    buffer_load_dword v44, v6, s[20:23], s45 offen offset:3072 sc1
    buffer_load_dword v45, v6, s[20:23], s45 offen offset:3328 sc1
    buffer_load_dword v46, v6, s[20:23], s45 offen offset:3584 sc1
    buffer_load_dword v47, v6, s[20:23], s45 offen offset:3840 sc1
    buffer_load_dword v48, v7, s[20:23], s44 offen offset:2048 sc1
    buffer_load_dword v49, v7, s[20:23], s44 offen offset:2304 sc1
    buffer_load_dword v50, v7, s[20:23], s44 offen offset:2560 sc1
    buffer_load_dword v51, v7, s[20:23], s44 offen offset:2816 sc1
    buffer_load_dword v52, v7, s[20:23], s44 offen offset:3072 sc1
    buffer_load_dword v53, v7, s[20:23], s44 offen offset:3328 sc1
    buffer_load_dword v54, v7, s[20:23], s44 offen offset:3584 sc1
    buffer_load_dword v55, v7, s[20:23], s44 offen offset:3840 sc1
    buffer_load_dword v56, v7, s[20:23], s45 offen offset:2048 sc1
    buffer_load_dword v57, v7, s[20:23], s45 offen offset:2304 sc1
    buffer_load_dword v58, v7, s[20:23], s45 offen offset:2560 sc1
    buffer_load_dword v59, v7, s[20:23], s45 offen offset:2816 sc1
    buffer_load_dword v60, v7, s[20:23], s45 offen offset:3072 sc1
    buffer_load_dword v61, v7, s[20:23], s45 offen offset:3328 sc1
    buffer_load_dword v62, v7, s[20:23], s45 offen offset:3584 sc1
    buffer_load_dword v63, v7, s[20:23], s45 offen offset:3840 sc1
    s_waitcnt vmcnt(0)
    v_cvt_pk_bf16_f32 v64, v16, v17
    v_cvt_pk_bf16_f32 v65, v18, v19
    v_cvt_pk_bf16_f32 v66, v20, v21
    v_cvt_pk_bf16_f32 v67, v22, v23
    v_cvt_pk_bf16_f32 v68, v24, v25
    v_cvt_pk_bf16_f32 v69, v26, v27
    v_cvt_pk_bf16_f32 v70, v28, v29
    v_cvt_pk_bf16_f32 v71, v30, v31
    v_cvt_pk_bf16_f32 v72, v32, v33
    v_cvt_pk_bf16_f32 v73, v34, v35
    v_cvt_pk_bf16_f32 v74, v36, v37
    v_cvt_pk_bf16_f32 v75, v38, v39
    v_cvt_pk_bf16_f32 v76, v40, v41
    v_cvt_pk_bf16_f32 v77, v42, v43
    v_cvt_pk_bf16_f32 v78, v44, v45
    v_cvt_pk_bf16_f32 v79, v46, v47
    v_cvt_pk_bf16_f32 v80, v48, v49
    v_cvt_pk_bf16_f32 v81, v50, v51
    v_cvt_pk_bf16_f32 v82, v52, v53
    v_cvt_pk_bf16_f32 v83, v54, v55
    v_cvt_pk_bf16_f32 v84, v56, v57
    v_cvt_pk_bf16_f32 v85, v58, v59
    v_cvt_pk_bf16_f32 v86, v60, v61
    v_cvt_pk_bf16_f32 v87, v62, v63
    v_mfma_f32_16x16x32_bf16 v[96:99], v[64:67], v[176:179], 0
    v_mfma_f32_16x16x32_bf16 v[100:103], v[68:71], v[176:179], 0
    v_mfma_f32_16x16x32_bf16 v[104:107], v[80:83], v[176:179], 0
    v_mfma_f32_16x16x32_bf16 v[96:99], v[72:75], v[180:183], v[96:99]
    v_mfma_f32_16x16x32_bf16 v[100:103], v[76:79], v[180:183], v[100:103]
    v_mfma_f32_16x16x32_bf16 v[104:107], v[84:87], v[180:183], v[104:107]
    s_nop 7
    v_cvt_pk_bf16_f32 v104, v104, v104
    v_and_b32 v104, 0xffff0000, v104
    v_add_f32 v104, 0x358637bd, v104
    v_cvt_pk_bf16_f32 v104, v104, v104
    v_and_b32 v104, 0xffff0000, v104
    v_rcp_f32 v104, v104
    v_cvt_pk_bf16_f32 v97, v96, v97
    v_lshlrev_b32 v96, 16, v97
    v_and_b32 v97, 0xffff0000, v97
    v_cvt_pk_bf16_f32 v99, v98, v99
    v_lshlrev_b32 v98, 16, v99
    v_and_b32 v99, 0xffff0000, v99
    v_cvt_pk_bf16_f32 v101, v100, v101
    v_lshlrev_b32 v100, 16, v101
    v_and_b32 v101, 0xffff0000, v101
    v_cvt_pk_bf16_f32 v103, v102, v103
    v_lshlrev_b32 v102, 16, v103
    v_and_b32 v103, 0xffff0000, v103
    v_mul_f32 v96, v96, v104
    v_mul_f32 v97, v97, v104
    v_mul_f32 v98, v98, v104
    v_mul_f32 v99, v99, v104
    v_mul_f32 v100, v100, v104
    v_mul_f32 v101, v101, v104
    v_mul_f32 v102, v102, v104
    v_mul_f32 v103, v103, v104
    v_cvt_pk_bf16_f32 v108, v96, v97
    v_cvt_pk_bf16_f32 v109, v98, v99
    v_cvt_pk_bf16_f32 v110, v100, v101
    v_cvt_pk_bf16_f32 v111, v102, v103
    s_add_u32 s16, s94, 9773056
    s_addc_u32 s17, s95, 0
    s_mov_b32 s18, 1835008
    s_mov_b32 s19, 0x00020000
    s_mul_i32 s44, s87, 28
    v_lshl_add_u32 v8, v4, 2, s44
    v_lshrrev_b32 v9, 5, v8
    v_lshlrev_b32 v6, 10, v9
    v_bfe_u32 v9, v8, 3, 2
    v_lshl_add_u32 v6, v9, 8, v6
    v_lshl_add_u32 v6, v3, 4, v6
    v_and_b32 v9, 7, v8
    v_lshl_add_u32 v6, v9, 1, v6
    v_add_u32 v8, 16, v8
    v_lshrrev_b32 v9, 5, v8
    v_lshlrev_b32 v7, 10, v9
    v_bfe_u32 v9, v8, 3, 2
    v_lshl_add_u32 v7, v9, 8, v7
    v_lshl_add_u32 v7, v3, 4, v7
    v_and_b32 v9, 7, v8
    v_lshl_add_u32 v7, v9, 1, v7
    v_mov_b32 v8, 0x40000000
    v_cndmask_b32 v7, v7, v8, s[52:53]
    s_mul_i32 s44, s47, 14336
    buffer_store_dwordx2 v[108:109], v6, s[16:19], s44 offen
    buffer_store_dwordx2 v[110:111], v7, s[16:19], s44 offen
    s_lshl_b32 s40, s86, 4
    s_add_u32 s40, s40, s87
    s_add_u32 s40, s40, 2304
    s_waitcnt vmcnt(0)
    s_barrier
    s_cmp_lg_u32 s3, 0
    s_cbranch_scc1 L_sig_140
    s_add_u32 s28, s94, 7921664
    s_addc_u32 s29, s95, 0
    s_mov_b32 s30, 16384
    s_mov_b32 s31, 0x00020000
    s_lshl_b32 s48, s40, 2
    v_mov_b32 v6, 1
    v_mov_b32 v7, s48
    s_mov_b64 exec, 1
    s_cmp_lg_u32 s80, 0
    s_cbranch_scc1 L_sigfb_141
    buffer_store_dword v6, v7, s[28:31], 0 offen
    s_nop 1
    s_branch L_sigj_142
L_sigfb_141:
    buffer_wbl2 sc1
    s_waitcnt vmcnt(0)
    buffer_store_dword v6, v7, s[28:31], 0 offen sc1
    s_nop 1
L_sigj_142:
    s_mov_b64 exec, -1
L_sig_140:
    s_cmp_ge_u32 s81, 224
    s_cbranch_scc1 L_idle_143
    s_lshr_b32 s40, s84, 1
    s_lshl_b32 s40, s40, 4
    s_add_u32 s40, s40, 2304
    s_cmp_lg_u32 s3, 0
    s_cbranch_scc1 L_wsk_146
    s_add_u32 s28, s94, 7921664
    s_addc_u32 s29, s95, 0
    s_mov_b32 s30, 16384
    s_mov_b32 s31, 0x00020000
    s_mov_b32 s50, 0
    v_add_u32 v6, s40, v1
    v_cmp_le_u32 s[48:49], 16, v1
    v_lshlrev_b32 v6, 2, v6
    s_nop 0
    v_cndmask_b32 v6, v6, 0, s[48:49]
    s_nop 1
L_wlp_147:
    buffer_load_dword v8, v6, s[28:31], 0 offen sc1
    s_waitcnt vmcnt(0)
    v_cmp_ne_u32 vcc, 0, v8
    s_nop 0
    s_or_b64 vcc, vcc, s[48:49]
    s_cmp_eq_u64 vcc, -1
    s_nop 1
    s_cbranch_scc1 L_wdn_148
    s_sleep 1
    s_add_u32 s50, s50, 1
    s_cmp_lt_u32 s50, 65536
    s_cbranch_scc1 L_wlp_147
L_wdn_148:
    s_cmp_eq_u32 s80, 0
    s_cbranch_scc1 L_wsk_146
    buffer_inv sc1
    s_waitcnt vmcnt(0)
L_wsk_146:
    s_barrier
    s_add_u32 s8, s94, 9773056
    s_addc_u32 s9, s95, 0
    s_mov_b32 s10, 1835008
    s_mov_b32 s11, 0x00020000
    s_add_u32 s16, s94, 40968192
    s_addc_u32 s17, s95, 0
    s_mov_b32 s18, 1835008
    s_mov_b32 s19, 0x00020000
    s_add_u32 s20, s94, 13443072
    s_addc_u32 s21, s95, 0
    s_mov_b32 s22, 1835008
    s_mov_b32 s23, 0x00020000
    s_lshl_b32 s44, s84, 2
    s_add_u32 s44, s44, s88
    s_mul_i32 s44, s44, 14
    s_mul_i32 s45, s89, 7
    s_add_u32 s44, s44, s45
    s_lshl_b32 s44, s44, 10
    buffer_load_dwordx4 v[16:19], v2, s[8:11], s44 offen offset:0
    buffer_load_dwordx4 v[20:23], v2, s[8:11], s44 offen offset:1024
    buffer_load_dwordx4 v[24:27], v2, s[8:11], s44 offen offset:2048
    buffer_load_dwordx4 v[28:31], v2, s[8:11], s44 offen offset:3072
    s_add_u32 s44, s44, 4096
    buffer_load_dwordx4 v[32:35], v2, s[8:11], s44 offen offset:0
    buffer_load_dwordx4 v[36:39], v2, s[8:11], s44 offen offset:1024
    buffer_load_dwordx4 v[40:43], v2, s[8:11], s44 offen offset:2048
    s_lshl_b32 s41, s84, 2
    s_add_u32 s41, s41, s88
    s_mul_i32 s41, s41, 14
    s_lshl_b32 s45, s85, 1
    s_add_u32 s41, s41, s45
    s_add_u32 s41, s41, s89
    s_lshl_b32 s41, s41, 10
    buffer_load_dwordx4 v[60:63], v2, s[16:19], s41 offen
    s_waitcnt vmcnt(0)
    s_barrier
    s_mul_i32 s44, s85, 57344
    s_add_u32 s12, s94, s44
    s_addc_u32 s13, s95, 0
    s_add_u32 s12, s12, 1810432
    s_addc_u32 s13, s13, 0
    s_mov_b32 s14, 57344
    s_mov_b32 s15, 0x00020000
    s_mul_i32 s46, s3, 7
    s_lshl_b32 s46, s46, 10
    s_add_u32 s47, s46, 57344
    s_mul_i32 s44, s89, 7168
    v_add_u32 v8, s44, v2
    ds_read_b128 v[80:83], v8 offset:0
    ds_read_b128 v[84:87], v8 offset:14336
    ds_read_b128 v[88:91], v8 offset:28672
    ds_read_b128 v[92:95], v8 offset:43008
    ds_read_b128 v[96:99], v8 offset:1024
    ds_read_b128 v[100:103], v8 offset:15360
    ds_read_b128 v[104:107], v8 offset:29696
    ds_read_b128 v[108:111], v8 offset:44032
    s_waitcnt lgkmcnt(4)
    v_mfma_f32_16x16x32_bf16 v[64:67], v[80:83], v[16:19], 0
    v_mfma_f32_16x16x32_bf16 v[68:71], v[84:87], v[16:19], 0
    v_mfma_f32_16x16x32_bf16 v[72:75], v[88:91], v[16:19], 0
    v_mfma_f32_16x16x32_bf16 v[76:79], v[92:95], v[16:19], 0
    s_mov_b32 m0, s47
    s_nop 0
    buffer_load_dwordx4 v2, s[12:15], s46 offen lds
    s_add_u32 s46, s46, 1024
    s_add_u32 s47, s47, 1024
    ds_read_b128 v[80:83], v8 offset:2048
    ds_read_b128 v[84:87], v8 offset:16384
    ds_read_b128 v[88:91], v8 offset:30720
    ds_read_b128 v[92:95], v8 offset:45056
    s_waitcnt lgkmcnt(4)
    v_mfma_f32_16x16x32_bf16 v[64:67], v[96:99], v[20:23], v[64:67]
    v_mfma_f32_16x16x32_bf16 v[68:71], v[100:103], v[20:23], v[68:71]
    v_mfma_f32_16x16x32_bf16 v[72:75], v[104:107], v[20:23], v[72:75]
    v_mfma_f32_16x16x32_bf16 v[76:79], v[108:111], v[20:23], v[76:79]
    s_mov_b32 m0, s47
    s_nop 0
    buffer_load_dwordx4 v2, s[12:15], s46 offen lds
    s_add_u32 s46, s46, 1024
    s_add_u32 s47, s47, 1024
    ds_read_b128 v[96:99], v8 offset:3072
    ds_read_b128 v[100:103], v8 offset:17408
    ds_read_b128 v[104:107], v8 offset:31744
    ds_read_b128 v[108:111], v8 offset:46080
    s_waitcnt lgkmcnt(4)
    v_mfma_f32_16x16x32_bf16 v[64:67], v[80:83], v[24:27], v[64:67]
    v_mfma_f32_16x16x32_bf16 v[68:71], v[84:87], v[24:27], v[68:71]
    v_mfma_f32_16x16x32_bf16 v[72:75], v[88:91], v[24:27], v[72:75]
    v_mfma_f32_16x16x32_bf16 v[76:79], v[92:95], v[24:27], v[76:79]
    s_mov_b32 m0, s47
    s_nop 0
    buffer_load_dwordx4 v2, s[12:15], s46 offen lds
    s_add_u32 s46, s46, 1024
    s_add_u32 s47, s47, 1024
    ds_read_b128 v[80:83], v8 offset:4096
    ds_read_b128 v[84:87], v8 offset:18432
    ds_read_b128 v[88:91], v8 offset:32768
    ds_read_b128 v[92:95], v8 offset:47104
    s_waitcnt lgkmcnt(4)
    v_mfma_f32_16x16x32_bf16 v[64:67], v[96:99], v[28:31], v[64:67]
    v_mfma_f32_16x16x32_bf16 v[68:71], v[100:103], v[28:31], v[68:71]
    v_mfma_f32_16x16x32_bf16 v[72:75], v[104:107], v[28:31], v[72:75]
    v_mfma_f32_16x16x32_bf16 v[76:79], v[108:111], v[28:31], v[76:79]
    s_mov_b32 m0, s47
    s_nop 0
    buffer_load_dwordx4 v2, s[12:15], s46 offen lds
    s_add_u32 s46, s46, 1024
    s_add_u32 s47, s47, 1024
    ds_read_b128 v[96:99], v8 offset:5120
    ds_read_b128 v[100:103], v8 offset:19456
    ds_read_b128 v[104:107], v8 offset:33792
    ds_read_b128 v[108:111], v8 offset:48128
    s_waitcnt lgkmcnt(4)
    v_mfma_f32_16x16x32_bf16 v[64:67], v[80:83], v[32:35], v[64:67]
    v_mfma_f32_16x16x32_bf16 v[68:71], v[84:87], v[32:35], v[68:71]
    v_mfma_f32_16x16x32_bf16 v[72:75], v[88:91], v[32:35], v[72:75]
    v_mfma_f32_16x16x32_bf16 v[76:79], v[92:95], v[32:35], v[76:79]
    s_mov_b32 m0, s47
    s_nop 0
    buffer_load_dwordx4 v2, s[12:15], s46 offen lds
    s_add_u32 s46, s46, 1024
    s_add_u32 s47, s47, 1024
    ds_read_b128 v[80:83], v8 offset:6144
    ds_read_b128 v[84:87], v8 offset:20480
    ds_read_b128 v[88:91], v8 offset:34816
    ds_read_b128 v[92:95], v8 offset:49152
    s_waitcnt lgkmcnt(4)
    v_mfma_f32_16x16x32_bf16 v[64:67], v[96:99], v[36:39], v[64:67]
    v_mfma_f32_16x16x32_bf16 v[68:71], v[100:103], v[36:39], v[68:71]
    v_mfma_f32_16x16x32_bf16 v[72:75], v[104:107], v[36:39], v[72:75]
    v_mfma_f32_16x16x32_bf16 v[76:79], v[108:111], v[36:39], v[76:79]
    s_mov_b32 m0, s47
    s_nop 0
    buffer_load_dwordx4 v2, s[12:15], s46 offen lds
    s_add_u32 s46, s46, 1024
    s_add_u32 s47, s47, 1024
    s_waitcnt lgkmcnt(0)
    v_mfma_f32_16x16x32_bf16 v[64:67], v[80:83], v[40:43], v[64:67]
    v_mfma_f32_16x16x32_bf16 v[68:71], v[84:87], v[40:43], v[68:71]
    v_mfma_f32_16x16x32_bf16 v[72:75], v[88:91], v[40:43], v[72:75]
    v_mfma_f32_16x16x32_bf16 v[76:79], v[92:95], v[40:43], v[76:79]
    s_mov_b32 m0, s47
    s_nop 0
    buffer_load_dwordx4 v2, s[12:15], s46 offen lds
    s_add_u32 s46, s46, 1024
    s_add_u32 s47, s47, 1024
    s_lshl_b32 s44, s88, 1
    s_add_u32 s44, s44, s89
    s_lshl_b32 s45, s44, 11
    s_xor_b32 s44, s44, 1
    s_lshl_b32 s44, s44, 11
    s_add_u32 s45, s45, 147456
    s_add_u32 s44, s44, 147456
    v_add_u32 v6, s45, v2
    v_add_u32 v7, s44, v2
    s_cmp_eq_u32 s89, 0
    s_nop 0
    s_cbranch_scc1 L_hx_lo_149
    ds_write_b128 v6, v[64:67]
    ds_write_b128 v6, v[68:71] offset:1024
    v_mov_b32 v16, v72
    v_mov_b32 v17, v73
    v_mov_b32 v18, v74
    v_mov_b32 v19, v75
    v_mov_b32 v20, v76
    v_mov_b32 v21, v77
    v_mov_b32 v22, v78
    v_mov_b32 v23, v79
    s_nop 1
    s_branch L_hx_j1_150
L_hx_lo_149:
    ds_write_b128 v6, v[72:75]
    ds_write_b128 v6, v[76:79] offset:1024
    v_mov_b32 v16, v64
    v_mov_b32 v17, v65
    v_mov_b32 v18, v66
    v_mov_b32 v19, v67
    v_mov_b32 v20, v68
    v_mov_b32 v21, v69
    v_mov_b32 v22, v70
    v_mov_b32 v23, v71
    s_nop 1
L_hx_j1_150:
    s_waitcnt lgkmcnt(0)
    s_barrier
    ds_read_b128 v[64:67], v7
    ds_read_b128 v[68:71], v7 offset:1024
    s_waitcnt lgkmcnt(0)
    v_add_f32 v16, v16, v64
    v_add_f32 v17, v17, v65
    v_add_f32 v18, v18, v66
    v_add_f32 v19, v19, v67
    v_add_f32 v20, v20, v68
    v_add_f32 v21, v21, v69
    v_add_f32 v22, v22, v70
    v_add_f32 v23, v23, v71
    v_cvt_pk_bf16_f32 v17, v16, v17
    v_lshlrev_b32 v16, 16, v17
    v_and_b32 v17, 0xffff0000, v17
    v_cvt_pk_bf16_f32 v19, v18, v19
    v_lshlrev_b32 v18, 16, v19
    v_and_b32 v19, 0xffff0000, v19
    v_cvt_pk_bf16_f32 v21, v20, v21
    v_lshlrev_b32 v20, 16, v21
    v_and_b32 v21, 0xffff0000, v21
    v_cvt_pk_bf16_f32 v23, v22, v23
    v_lshlrev_b32 v22, 16, v23
    v_and_b32 v23, 0xffff0000, v23
    v_lshlrev_b32 v8, 16, v60
    v_and_b32 v9, 0xffff0000, v60
    v_add_f32 v16, v16, v8
    v_add_f32 v17, v17, v9
    v_lshlrev_b32 v8, 16, v61
    v_and_b32 v9, 0xffff0000, v61
    v_add_f32 v18, v18, v8
    v_add_f32 v19, v19, v9
    v_lshlrev_b32 v8, 16, v62
    v_and_b32 v9, 0xffff0000, v62
    v_add_f32 v20, v20, v8
    v_add_f32 v21, v21, v9
    v_lshlrev_b32 v8, 16, v63
    v_and_b32 v9, 0xffff0000, v63
    v_add_f32 v22, v22, v8
    v_add_f32 v23, v23, v9
    v_cvt_pk_bf16_f32 v24, v16, v17
    v_cvt_pk_bf16_f32 v25, v18, v19
    v_cvt_pk_bf16_f32 v26, v20, v21
    v_cvt_pk_bf16_f32 v27, v22, v23
    buffer_store_dwordx4 v[24:27], v2, s[20:23], s41 offen
    s_lshl_b32 s40, s84, 3
    s_add_u32 s40, s40, s85
    s_add_u32 s40, s40, 2560
    s_waitcnt vmcnt(0)
    s_barrier
    s_cmp_lg_u32 s3, 0
    s_cbranch_scc1 L_sig_151
    s_add_u32 s28, s94, 7921664
    s_addc_u32 s29, s95, 0
    s_mov_b32 s30, 16384
    s_mov_b32 s31, 0x00020000
    s_lshl_b32 s48, s40, 2
    v_mov_b32 v6, 1
    v_mov_b32 v7, s48
    s_mov_b64 exec, 1
    s_cmp_lg_u32 s80, 0
    s_cbranch_scc1 L_sigfb_152
    buffer_store_dword v6, v7, s[28:31], 0 offen
    s_nop 1
    s_branch L_sigj_153
L_sigfb_152:
    buffer_wbl2 sc1
    s_waitcnt vmcnt(0)
    buffer_store_dword v6, v7, s[28:31], 0 offen sc1
    s_nop 1
L_sigj_153:
    s_mov_b64 exec, -1
L_sig_151:
    s_lshl_b32 s40, s84, 3
    s_add_u32 s40, s40, 2560
    s_cmp_lg_u32 s3, 0
    s_cbranch_scc1 L_wsk_154
    s_add_u32 s28, s94, 7921664
    s_addc_u32 s29, s95, 0
    s_mov_b32 s30, 16384
    s_mov_b32 s31, 0x00020000
    s_mov_b32 s50, 0
    v_add_u32 v6, s40, v1
    v_cmp_le_u32 s[48:49], 7, v1
    v_lshlrev_b32 v6, 2, v6
    s_nop 0
    v_cndmask_b32 v6, v6, 0, s[48:49]
    s_nop 1
L_wlp_155:
    buffer_load_dword v8, v6, s[28:31], 0 offen sc1
    s_waitcnt vmcnt(0)
    v_cmp_ne_u32 vcc, 0, v8
    s_nop 0
    s_or_b64 vcc, vcc, s[48:49]
    s_cmp_eq_u64 vcc, -1
    s_nop 1
    s_cbranch_scc1 L_wdn_156
    s_sleep 1
    s_add_u32 s50, s50, 1
    s_cmp_lt_u32 s50, 65536
    s_cbranch_scc1 L_wlp_155
L_wdn_156:
    s_cmp_eq_u32 s80, 0
    s_cbranch_scc1 L_wsk_154
    buffer_inv sc1
    s_waitcnt vmcnt(0)
L_wsk_154:
    s_barrier
    s_add_u32 s8, s94, 13443072
    s_addc_u32 s9, s95, 0
    s_mov_b32 s10, 1835008
    s_mov_b32 s11, 0x00020000
    s_add_u32 s16, s94, 17113088
    s_addc_u32 s17, s95, 0
    s_mov_b32 s18, 1835008
    s_mov_b32 s19, 0x00020000
    s_add_u32 s20, s94, 20783104
    s_addc_u32 s21, s95, 0
    s_mov_b32 s22, 1835008
    s_mov_b32 s23, 0x00020000
    s_lshl_b32 s44, s84, 2
    s_add_u32 s44, s44, s88
    s_mul_i32 s44, s44, 14
    s_mul_i32 s45, s89, 7
    s_add_u32 s44, s44, s45
    s_lshl_b32 s44, s44, 10
    s_mov_b32 s42, s44
    buffer_load_dwordx4 v[16:19], v2, s[8:11], s44 offen offset:0
    buffer_load_dwordx4 v[20:23], v2, s[8:11], s44 offen offset:1024
    buffer_load_dwordx4 v[24:27], v2, s[8:11], s44 offen offset:2048
    buffer_load_dwordx4 v[28:31], v2, s[8:11], s44 offen offset:3072
    s_add_u32 s44, s44, 4096
    buffer_load_dwordx4 v[32:35], v2, s[8:11], s44 offen offset:0
    buffer_load_dwordx4 v[36:39], v2, s[8:11], s44 offen offset:1024
    buffer_load_dwordx4 v[40:43], v2, s[8:11], s44 offen offset:2048
    s_waitcnt vmcnt(0)
    v_mov_b32 v8, 0
    v_mov_b32 v9, 0
    v_mov_b32 v10, 0
    v_mov_b32 v11, 0
    v_dot2_f32_bf16 v8, v16, s60, v8
    v_dot2_f32_bf16 v9, v16, v16, v9
    v_dot2_f32_bf16 v10, v17, s60, v10
    v_dot2_f32_bf16 v11, v17, v17, v11
    v_dot2_f32_bf16 v8, v18, s60, v8
    v_dot2_f32_bf16 v9, v18, v18, v9
    v_dot2_f32_bf16 v10, v19, s60, v10
    v_dot2_f32_bf16 v11, v19, v19, v11
    v_dot2_f32_bf16 v8, v20, s60, v8
    v_dot2_f32_bf16 v9, v20, v20, v9
    v_dot2_f32_bf16 v10, v21, s60, v10
    v_dot2_f32_bf16 v11, v21, v21, v11
    v_dot2_f32_bf16 v8, v22, s60, v8
    v_dot2_f32_bf16 v9, v22, v22, v9
    v_dot2_f32_bf16 v10, v23, s60, v10
    v_dot2_f32_bf16 v11, v23, v23, v11
    v_dot2_f32_bf16 v8, v24, s60, v8
    v_dot2_f32_bf16 v9, v24, v24, v9
    v_dot2_f32_bf16 v10, v25, s60, v10
    v_dot2_f32_bf16 v11, v25, v25, v11
    v_dot2_f32_bf16 v8, v26, s60, v8
    v_dot2_f32_bf16 v9, v26, v26, v9
    v_dot2_f32_bf16 v10, v27, s60, v10
    v_dot2_f32_bf16 v11, v27, v27, v11
    v_dot2_f32_bf16 v8, v28, s60, v8
    v_dot2_f32_bf16 v9, v28, v28, v9
    v_dot2_f32_bf16 v10, v29, s60, v10
    v_dot2_f32_bf16 v11, v29, v29, v11
    v_dot2_f32_bf16 v8, v30, s60, v8
    v_dot2_f32_bf16 v9, v30, v30, v9
    v_dot2_f32_bf16 v10, v31, s60, v10
    v_dot2_f32_bf16 v11, v31, v31, v11
    v_dot2_f32_bf16 v8, v32, s60, v8
    v_dot2_f32_bf16 v9, v32, v32, v9
    v_dot2_f32_bf16 v10, v33, s60, v10
    v_dot2_f32_bf16 v11, v33, v33, v11
    v_dot2_f32_bf16 v8, v34, s60, v8
    v_dot2_f32_bf16 v9, v34, v34, v9
    v_dot2_f32_bf16 v10, v35, s60, v10
    v_dot2_f32_bf16 v11, v35, v35, v11
    v_dot2_f32_bf16 v8, v36, s60, v8
    v_dot2_f32_bf16 v9, v36, v36, v9
    v_dot2_f32_bf16 v10, v37, s60, v10
    v_dot2_f32_bf16 v11, v37, v37, v11
    v_dot2_f32_bf16 v8, v38, s60, v8
    v_dot2_f32_bf16 v9, v38, v38, v9
    v_dot2_f32_bf16 v10, v39, s60, v10
    v_dot2_f32_bf16 v11, v39, v39, v11
    v_dot2_f32_bf16 v8, v40, s60, v8
    v_dot2_f32_bf16 v9, v40, v40, v9
    v_dot2_f32_bf16 v10, v41, s60, v10
    v_dot2_f32_bf16 v11, v41, v41, v11
    v_dot2_f32_bf16 v8, v42, s60, v8
    v_dot2_f32_bf16 v9, v42, v42, v9
    v_dot2_f32_bf16 v10, v43, s60, v10
    v_dot2_f32_bf16 v11, v43, v43, v11
    s_nop 1
    v_add_f32 v8, v8, v10
    v_add_f32 v9, v9, v11
    v_mov_b32 v10, v8
    s_nop 1
    v_permlane32_swap_b32 v8, v10
    v_add_f32 v8, v8, v10
    v_mov_b32 v10, v8
    s_nop 1
    v_permlane16_swap_b32 v8, v10
    v_add_f32 v8, v8, v10
    v_mov_b32 v11, v9
    s_nop 1
    v_permlane32_swap_b32 v9, v11
    v_add_f32 v9, v9, v11
    v_mov_b32 v11, v9
    s_nop 1
    v_permlane16_swap_b32 v9, v11
    v_add_f32 v9, v9, v11
    s_lshl_b32 s44, s89, 2
    s_add_u32 s44, s44, s88
    s_lshl_b32 s45, s44, 7
    s_xor_b32 s44, s44, 4
    s_lshl_b32 s44, s44, 7
    s_add_u32 s45, s45, 145408
    s_add_u32 s44, s44, 145408
    v_lshl_add_u32 v6, v3, 3, s45
    v_lshl_add_u32 v7, v3, 3, s44
    ds_write_b64 v6, v[8:9] offset:0
    s_waitcnt lgkmcnt(0)
    s_barrier
    ds_read_b64 v[6:7], v7 offset:0
    s_waitcnt lgkmcnt(0)
    v_add_f32 v8, v8, v6
    v_add_f32 v9, v9, v7
    v_mul_f32 v8, 0x3b124925, v8
    v_mul_f32 v9, 0x3b124925, v9
    v_fma_f32 v9, -v8, v8, v9
    v_max_f32 v9, 0, v9
    v_cvt_pk_bf16_f32 v8, v8, v8
    v_and_b32 v8, 0xffff0000, v8
    v_cvt_pk_bf16_f32 v9, v9, v9
    v_and_b32 v9, 0xffff0000, v9
    v_add_f32 v9, 0x3727c5ac, v9
    v_cvt_pk_bf16_f32 v9, v9, v9
    v_and_b32 v9, 0xffff0000, v9
    v_sqrt_f32 v9, v9
    s_nop 0
    v_cvt_pk_bf16_f32 v9, v9, v9
    v_and_b32 v9, 0xffff0000, v9
    v_rcp_f32 v72, v9
    s_nop 0
    v_mul_f32 v74, v8, v72
    v_sub_f32 v74, 0, v74
    v_lshlrev_b32 v76, 16, v16
    v_and_b32 v77, 0xffff0000, v16
    v_pk_fma_f32 v[76:77], v[76:77], v[72:73], v[74:75] op_sel_hi:[1,0,0]
    v_cvt_pk_bf16_f32 v16, v76, v77
    v_lshlrev_b32 v78, 16, v17
    v_and_b32 v79, 0xffff0000, v17
    v_pk_fma_f32 v[78:79], v[78:79], v[72:73], v[74:75] op_sel_hi:[1,0,0]
    v_cvt_pk_bf16_f32 v17, v78, v79
    v_lshlrev_b32 v80, 16, v18
    v_and_b32 v81, 0xffff0000, v18
    v_pk_fma_f32 v[80:81], v[80:81], v[72:73], v[74:75] op_sel_hi:[1,0,0]
    v_cvt_pk_bf16_f32 v18, v80, v81
    v_lshlrev_b32 v82, 16, v19
    v_and_b32 v83, 0xffff0000, v19
    v_pk_fma_f32 v[82:83], v[82:83], v[72:73], v[74:75] op_sel_hi:[1,0,0]
    v_cvt_pk_bf16_f32 v19, v82, v83
    v_lshlrev_b32 v76, 16, v20
    v_and_b32 v77, 0xffff0000, v20
    v_pk_fma_f32 v[76:77], v[76:77], v[72:73], v[74:75] op_sel_hi:[1,0,0]
    v_cvt_pk_bf16_f32 v20, v76, v77
    v_lshlrev_b32 v78, 16, v21
    v_and_b32 v79, 0xffff0000, v21
    v_pk_fma_f32 v[78:79], v[78:79], v[72:73], v[74:75] op_sel_hi:[1,0,0]
    v_cvt_pk_bf16_f32 v21, v78, v79
    v_lshlrev_b32 v80, 16, v22
    v_and_b32 v81, 0xffff0000, v22
    v_pk_fma_f32 v[80:81], v[80:81], v[72:73], v[74:75] op_sel_hi:[1,0,0]
    v_cvt_pk_bf16_f32 v22, v80, v81
    v_lshlrev_b32 v82, 16, v23
    v_and_b32 v83, 0xffff0000, v23
    v_pk_fma_f32 v[82:83], v[82:83], v[72:73], v[74:75] op_sel_hi:[1,0,0]
    v_cvt_pk_bf16_f32 v23, v82, v83
    v_lshlrev_b32 v76, 16, v24
    v_and_b32 v77, 0xffff0000, v24
    v_pk_fma_f32 v[76:77], v[76:77], v[72:73], v[74:75] op_sel_hi:[1,0,0]
    v_cvt_pk_bf16_f32 v24, v76, v77
    v_lshlrev_b32 v78, 16, v25
    v_and_b32 v79, 0xffff0000, v25
    v_pk_fma_f32 v[78:79], v[78:79], v[72:73], v[74:75] op_sel_hi:[1,0,0]
    v_cvt_pk_bf16_f32 v25, v78, v79
    v_lshlrev_b32 v80, 16, v26
    v_and_b32 v81, 0xffff0000, v26
    v_pk_fma_f32 v[80:81], v[80:81], v[72:73], v[74:75] op_sel_hi:[1,0,0]
    v_cvt_pk_bf16_f32 v26, v80, v81
    v_lshlrev_b32 v82, 16, v27
    v_and_b32 v83, 0xffff0000, v27
    v_pk_fma_f32 v[82:83], v[82:83], v[72:73], v[74:75] op_sel_hi:[1,0,0]
    v_cvt_pk_bf16_f32 v27, v82, v83
    v_lshlrev_b32 v76, 16, v28
    v_and_b32 v77, 0xffff0000, v28
    v_pk_fma_f32 v[76:77], v[76:77], v[72:73], v[74:75] op_sel_hi:[1,0,0]
    v_cvt_pk_bf16_f32 v28, v76, v77
    v_lshlrev_b32 v78, 16, v29
    v_and_b32 v79, 0xffff0000, v29
    v_pk_fma_f32 v[78:79], v[78:79], v[72:73], v[74:75] op_sel_hi:[1,0,0]
    v_cvt_pk_bf16_f32 v29, v78, v79
    v_lshlrev_b32 v80, 16, v30
    v_and_b32 v81, 0xffff0000, v30
    v_pk_fma_f32 v[80:81], v[80:81], v[72:73], v[74:75] op_sel_hi:[1,0,0]
    v_cvt_pk_bf16_f32 v30, v80, v81
    v_lshlrev_b32 v82, 16, v31
    v_and_b32 v83, 0xffff0000, v31
    v_pk_fma_f32 v[82:83], v[82:83], v[72:73], v[74:75] op_sel_hi:[1,0,0]
    v_cvt_pk_bf16_f32 v31, v82, v83
    v_lshlrev_b32 v76, 16, v32
    v_and_b32 v77, 0xffff0000, v32
    v_pk_fma_f32 v[76:77], v[76:77], v[72:73], v[74:75] op_sel_hi:[1,0,0]
    v_cvt_pk_bf16_f32 v32, v76, v77
    v_lshlrev_b32 v78, 16, v33
    v_and_b32 v79, 0xffff0000, v33
    v_pk_fma_f32 v[78:79], v[78:79], v[72:73], v[74:75] op_sel_hi:[1,0,0]
    v_cvt_pk_bf16_f32 v33, v78, v79
    v_lshlrev_b32 v80, 16, v34
    v_and_b32 v81, 0xffff0000, v34
    v_pk_fma_f32 v[80:81], v[80:81], v[72:73], v[74:75] op_sel_hi:[1,0,0]
    v_cvt_pk_bf16_f32 v34, v80, v81
    v_lshlrev_b32 v82, 16, v35
    v_and_b32 v83, 0xffff0000, v35
    v_pk_fma_f32 v[82:83], v[82:83], v[72:73], v[74:75] op_sel_hi:[1,0,0]
    v_cvt_pk_bf16_f32 v35, v82, v83
    v_lshlrev_b32 v76, 16, v36
    v_and_b32 v77, 0xffff0000, v36
    v_pk_fma_f32 v[76:77], v[76:77], v[72:73], v[74:75] op_sel_hi:[1,0,0]
    v_cvt_pk_bf16_f32 v36, v76, v77
    v_lshlrev_b32 v78, 16, v37
    v_and_b32 v79, 0xffff0000, v37
    v_pk_fma_f32 v[78:79], v[78:79], v[72:73], v[74:75] op_sel_hi:[1,0,0]
    v_cvt_pk_bf16_f32 v37, v78, v79
    v_lshlrev_b32 v80, 16, v38
    v_and_b32 v81, 0xffff0000, v38
    v_pk_fma_f32 v[80:81], v[80:81], v[72:73], v[74:75] op_sel_hi:[1,0,0]
    v_cvt_pk_bf16_f32 v38, v80, v81
    v_lshlrev_b32 v82, 16, v39
    v_and_b32 v83, 0xffff0000, v39
    v_pk_fma_f32 v[82:83], v[82:83], v[72:73], v[74:75] op_sel_hi:[1,0,0]
    v_cvt_pk_bf16_f32 v39, v82, v83
    v_lshlrev_b32 v76, 16, v40
    v_and_b32 v77, 0xffff0000, v40
    v_pk_fma_f32 v[76:77], v[76:77], v[72:73], v[74:75] op_sel_hi:[1,0,0]
    v_cvt_pk_bf16_f32 v40, v76, v77
    v_lshlrev_b32 v78, 16, v41
    v_and_b32 v79, 0xffff0000, v41
    v_pk_fma_f32 v[78:79], v[78:79], v[72:73], v[74:75] op_sel_hi:[1,0,0]
    v_cvt_pk_bf16_f32 v41, v78, v79
    v_lshlrev_b32 v80, 16, v42
    v_and_b32 v81, 0xffff0000, v42
    v_pk_fma_f32 v[80:81], v[80:81], v[72:73], v[74:75] op_sel_hi:[1,0,0]
    v_cvt_pk_bf16_f32 v42, v80, v81
    v_lshlrev_b32 v82, 16, v43
    v_and_b32 v83, 0xffff0000, v43
    v_pk_fma_f32 v[82:83], v[82:83], v[72:73], v[74:75] op_sel_hi:[1,0,0]
    v_cvt_pk_bf16_f32 v43, v82, v83
    s_mul_i32 s47, s89, 7
    s_add_u32 s44, s47, 0
    s_lshr_b32 s44, s44, 1
    s_cmp_lg_u32 s44, s85
    s_cbranch_scc1 L_k3sk_157
    s_add_u32 s44, s42, 0
    buffer_store_dwordx4 v[16:19], v2, s[16:19], s44 offen
    s_nop 1
L_k3sk_157:
    s_add_u32 s44, s47, 1
    s_lshr_b32 s44, s44, 1
    s_cmp_lg_u32 s44, s85
    s_cbranch_scc1 L_k3sk_158
    s_add_u32 s44, s42, 1024
    buffer_store_dwordx4 v[20:23], v2, s[16:19], s44 offen
    s_nop 1
L_k3sk_158:
    s_add_u32 s44, s47, 2
    s_lshr_b32 s44, s44, 1
    s_cmp_lg_u32 s44, s85
    s_cbranch_scc1 L_k3sk_159
    s_add_u32 s44, s42, 2048
    buffer_store_dwordx4 v[24:27], v2, s[16:19], s44 offen
    s_nop 1
L_k3sk_159:
    s_add_u32 s44, s47, 3
    s_lshr_b32 s44, s44, 1
    s_cmp_lg_u32 s44, s85
    s_cbranch_scc1 L_k3sk_160
    s_add_u32 s44, s42, 3072
    buffer_store_dwordx4 v[28:31], v2, s[16:19], s44 offen
    s_nop 1
L_k3sk_160:
    s_add_u32 s44, s47, 4
    s_lshr_b32 s44, s44, 1
    s_cmp_lg_u32 s44, s85
    s_cbranch_scc1 L_k3sk_161
    s_add_u32 s44, s42, 4096
    buffer_store_dwordx4 v[32:35], v2, s[16:19], s44 offen
    s_nop 1
L_k3sk_161:
    s_add_u32 s44, s47, 5
    s_lshr_b32 s44, s44, 1
    s_cmp_lg_u32 s44, s85
    s_cbranch_scc1 L_k3sk_162
    s_add_u32 s44, s42, 5120
    buffer_store_dwordx4 v[36:39], v2, s[16:19], s44 offen
    s_nop 1
L_k3sk_162:
    s_add_u32 s44, s47, 6
    s_lshr_b32 s44, s44, 1
    s_cmp_lg_u32 s44, s85
    s_cbranch_scc1 L_k3sk_163
    s_add_u32 s44, s42, 6144
    buffer_store_dwordx4 v[40:43], v2, s[16:19], s44 offen
    s_nop 1
L_k3sk_163:
    v_mov_b32 v8, 0
    v_mov_b32 v9, 0
    v_mov_b32 v10, 0
    v_mov_b32 v11, 0
    v_dot2_f32_bf16 v8, v16, s60, v8
    v_dot2_f32_bf16 v9, v16, v16, v9
    v_dot2_f32_bf16 v10, v17, s60, v10
    v_dot2_f32_bf16 v11, v17, v17, v11
    v_dot2_f32_bf16 v8, v18, s60, v8
    v_dot2_f32_bf16 v9, v18, v18, v9
    v_dot2_f32_bf16 v10, v19, s60, v10
    v_dot2_f32_bf16 v11, v19, v19, v11
    v_dot2_f32_bf16 v8, v20, s60, v8
    v_dot2_f32_bf16 v9, v20, v20, v9
    v_dot2_f32_bf16 v10, v21, s60, v10
    v_dot2_f32_bf16 v11, v21, v21, v11
    v_dot2_f32_bf16 v8, v22, s60, v8
    v_dot2_f32_bf16 v9, v22, v22, v9
    v_dot2_f32_bf16 v10, v23, s60, v10
    v_dot2_f32_bf16 v11, v23, v23, v11
    v_dot2_f32_bf16 v8, v24, s60, v8
    v_dot2_f32_bf16 v9, v24, v24, v9
    v_dot2_f32_bf16 v10, v25, s60, v10
    v_dot2_f32_bf16 v11, v25, v25, v11
    v_dot2_f32_bf16 v8, v26, s60, v8
    v_dot2_f32_bf16 v9, v26, v26, v9
    v_dot2_f32_bf16 v10, v27, s60, v10
    v_dot2_f32_bf16 v11, v27, v27, v11
    v_dot2_f32_bf16 v8, v28, s60, v8
    v_dot2_f32_bf16 v9, v28, v28, v9
    v_dot2_f32_bf16 v10, v29, s60, v10
    v_dot2_f32_bf16 v11, v29, v29, v11
    v_dot2_f32_bf16 v8, v30, s60, v8
    v_dot2_f32_bf16 v9, v30, v30, v9
    v_dot2_f32_bf16 v10, v31, s60, v10
    v_dot2_f32_bf16 v11, v31, v31, v11
    v_dot2_f32_bf16 v8, v32, s60, v8
    v_dot2_f32_bf16 v9, v32, v32, v9
    v_dot2_f32_bf16 v10, v33, s60, v10
    v_dot2_f32_bf16 v11, v33, v33, v11
    v_dot2_f32_bf16 v8, v34, s60, v8
    v_dot2_f32_bf16 v9, v34, v34, v9
    v_dot2_f32_bf16 v10, v35, s60, v10
    v_dot2_f32_bf16 v11, v35, v35, v11
    v_dot2_f32_bf16 v8, v36, s60, v8
    v_dot2_f32_bf16 v9, v36, v36, v9
    v_dot2_f32_bf16 v10, v37, s60, v10
    v_dot2_f32_bf16 v11, v37, v37, v11
    v_dot2_f32_bf16 v8, v38, s60, v8
    v_dot2_f32_bf16 v9, v38, v38, v9
    v_dot2_f32_bf16 v10, v39, s60, v10
    v_dot2_f32_bf16 v11, v39, v39, v11
    v_dot2_f32_bf16 v8, v40, s60, v8
    v_dot2_f32_bf16 v9, v40, v40, v9
    v_dot2_f32_bf16 v10, v41, s60, v10
    v_dot2_f32_bf16 v11, v41, v41, v11
    v_dot2_f32_bf16 v8, v42, s60, v8
    v_dot2_f32_bf16 v9, v42, v42, v9
    v_dot2_f32_bf16 v10, v43, s60, v10
    v_dot2_f32_bf16 v11, v43, v43, v11
    s_nop 1
    v_add_f32 v8, v8, v10
    v_add_f32 v9, v9, v11
    v_mov_b32 v10, v8
    s_nop 1
    v_permlane32_swap_b32 v8, v10
    v_add_f32 v8, v8, v10
    v_mov_b32 v10, v8
    s_nop 1
    v_permlane16_swap_b32 v8, v10
    v_add_f32 v8, v8, v10
    v_mov_b32 v11, v9
    s_nop 1
    v_permlane32_swap_b32 v9, v11
    v_add_f32 v9, v9, v11
    v_mov_b32 v11, v9
    s_nop 1
    v_permlane16_swap_b32 v9, v11
    v_add_f32 v9, v9, v11
    s_lshl_b32 s44, s89, 2
    s_add_u32 s44, s44, s88
    s_lshl_b32 s45, s44, 7
    s_xor_b32 s44, s44, 4
    s_lshl_b32 s44, s44, 7
    s_add_u32 s45, s45, 145408
    s_add_u32 s44, s44, 145408
    v_lshl_add_u32 v6, v3, 3, s45
    v_lshl_add_u32 v7, v3, 3, s44
    ds_write_b64 v6, v[8:9] offset:1024
    s_waitcnt lgkmcnt(0)
    s_barrier
    ds_read_b64 v[6:7], v7 offset:1024
    s_waitcnt lgkmcnt(0)
    v_add_f32 v8, v8, v6
    v_add_f32 v9, v9, v7
    v_mul_f32 v8, 0x3b124925, v8
    v_mul_f32 v9, 0x3b124925, v9
    v_fma_f32 v9, -v8, v8, v9
    v_max_f32 v9, 0, v9
    v_cvt_pk_bf16_f32 v8, v8, v8
    v_and_b32 v8, 0xffff0000, v8
    v_cvt_pk_bf16_f32 v9, v9, v9
    v_and_b32 v9, 0xffff0000, v9
    v_add_f32 v9, 0x3727c5ac, v9
    v_cvt_pk_bf16_f32 v9, v9, v9
    v_and_b32 v9, 0xffff0000, v9
    v_sqrt_f32 v9, v9
    s_nop 0
    v_cvt_pk_bf16_f32 v9, v9, v9
    v_and_b32 v9, 0xffff0000, v9
    v_rcp_f32 v72, v9
    s_nop 0
    v_mul_f32 v74, v8, v72
    v_sub_f32 v74, 0, v74
    v_lshlrev_b32 v76, 16, v16
    v_and_b32 v77, 0xffff0000, v16
    v_pk_fma_f32 v[76:77], v[76:77], v[72:73], v[74:75] op_sel_hi:[1,0,0]
    v_cvt_pk_bf16_f32 v16, v76, v77
    v_lshlrev_b32 v78, 16, v17
    v_and_b32 v79, 0xffff0000, v17
    v_pk_fma_f32 v[78:79], v[78:79], v[72:73], v[74:75] op_sel_hi:[1,0,0]
    v_cvt_pk_bf16_f32 v17, v78, v79
    v_lshlrev_b32 v80, 16, v18
    v_and_b32 v81, 0xffff0000, v18
    v_pk_fma_f32 v[80:81], v[80:81], v[72:73], v[74:75] op_sel_hi:[1,0,0]
    v_cvt_pk_bf16_f32 v18, v80, v81
    v_lshlrev_b32 v82, 16, v19
    v_and_b32 v83, 0xffff0000, v19
    v_pk_fma_f32 v[82:83], v[82:83], v[72:73], v[74:75] op_sel_hi:[1,0,0]
    v_cvt_pk_bf16_f32 v19, v82, v83
    v_lshlrev_b32 v76, 16, v20
    v_and_b32 v77, 0xffff0000, v20
    v_pk_fma_f32 v[76:77], v[76:77], v[72:73], v[74:75] op_sel_hi:[1,0,0]
    v_cvt_pk_bf16_f32 v20, v76, v77
    v_lshlrev_b32 v78, 16, v21
    v_and_b32 v79, 0xffff0000, v21
    v_pk_fma_f32 v[78:79], v[78:79], v[72:73], v[74:75] op_sel_hi:[1,0,0]
    v_cvt_pk_bf16_f32 v21, v78, v79
    v_lshlrev_b32 v80, 16, v22
    v_and_b32 v81, 0xffff0000, v22
    v_pk_fma_f32 v[80:81], v[80:81], v[72:73], v[74:75] op_sel_hi:[1,0,0]
    v_cvt_pk_bf16_f32 v22, v80, v81
    v_lshlrev_b32 v82, 16, v23
    v_and_b32 v83, 0xffff0000, v23
    v_pk_fma_f32 v[82:83], v[82:83], v[72:73], v[74:75] op_sel_hi:[1,0,0]
    v_cvt_pk_bf16_f32 v23, v82, v83
    v_lshlrev_b32 v76, 16, v24
    v_and_b32 v77, 0xffff0000, v24
    v_pk_fma_f32 v[76:77], v[76:77], v[72:73], v[74:75] op_sel_hi:[1,0,0]
    v_cvt_pk_bf16_f32 v24, v76, v77
    v_lshlrev_b32 v78, 16, v25
    v_and_b32 v79, 0xffff0000, v25
    v_pk_fma_f32 v[78:79], v[78:79], v[72:73], v[74:75] op_sel_hi:[1,0,0]
    v_cvt_pk_bf16_f32 v25, v78, v79
    v_lshlrev_b32 v80, 16, v26
    v_and_b32 v81, 0xffff0000, v26
    v_pk_fma_f32 v[80:81], v[80:81], v[72:73], v[74:75] op_sel_hi:[1,0,0]
    v_cvt_pk_bf16_f32 v26, v80, v81
    v_lshlrev_b32 v82, 16, v27
    v_and_b32 v83, 0xffff0000, v27
    v_pk_fma_f32 v[82:83], v[82:83], v[72:73], v[74:75] op_sel_hi:[1,0,0]
    v_cvt_pk_bf16_f32 v27, v82, v83
    v_lshlrev_b32 v76, 16, v28
    v_and_b32 v77, 0xffff0000, v28
    v_pk_fma_f32 v[76:77], v[76:77], v[72:73], v[74:75] op_sel_hi:[1,0,0]
    v_cvt_pk_bf16_f32 v28, v76, v77
    v_lshlrev_b32 v78, 16, v29
    v_and_b32 v79, 0xffff0000, v29
    v_pk_fma_f32 v[78:79], v[78:79], v[72:73], v[74:75] op_sel_hi:[1,0,0]
    v_cvt_pk_bf16_f32 v29, v78, v79
    v_lshlrev_b32 v80, 16, v30
    v_and_b32 v81, 0xffff0000, v30
    v_pk_fma_f32 v[80:81], v[80:81], v[72:73], v[74:75] op_sel_hi:[1,0,0]
    v_cvt_pk_bf16_f32 v30, v80, v81
    v_lshlrev_b32 v82, 16, v31
    v_and_b32 v83, 0xffff0000, v31
    v_pk_fma_f32 v[82:83], v[82:83], v[72:73], v[74:75] op_sel_hi:[1,0,0]
    v_cvt_pk_bf16_f32 v31, v82, v83
    v_lshlrev_b32 v76, 16, v32
    v_and_b32 v77, 0xffff0000, v32
    v_pk_fma_f32 v[76:77], v[76:77], v[72:73], v[74:75] op_sel_hi:[1,0,0]
    v_cvt_pk_bf16_f32 v32, v76, v77
    v_lshlrev_b32 v78, 16, v33
    v_and_b32 v79, 0xffff0000, v33
    v_pk_fma_f32 v[78:79], v[78:79], v[72:73], v[74:75] op_sel_hi:[1,0,0]
    v_cvt_pk_bf16_f32 v33, v78, v79
    v_lshlrev_b32 v80, 16, v34
    v_and_b32 v81, 0xffff0000, v34
    v_pk_fma_f32 v[80:81], v[80:81], v[72:73], v[74:75] op_sel_hi:[1,0,0]
    v_cvt_pk_bf16_f32 v34, v80, v81
    v_lshlrev_b32 v82, 16, v35
    v_and_b32 v83, 0xffff0000, v35
    v_pk_fma_f32 v[82:83], v[82:83], v[72:73], v[74:75] op_sel_hi:[1,0,0]
    v_cvt_pk_bf16_f32 v35, v82, v83
    v_lshlrev_b32 v76, 16, v36
    v_and_b32 v77, 0xffff0000, v36
    v_pk_fma_f32 v[76:77], v[76:77], v[72:73], v[74:75] op_sel_hi:[1,0,0]
    v_cvt_pk_bf16_f32 v36, v76, v77
    v_lshlrev_b32 v78, 16, v37
    v_and_b32 v79, 0xffff0000, v37
    v_pk_fma_f32 v[78:79], v[78:79], v[72:73], v[74:75] op_sel_hi:[1,0,0]
    v_cvt_pk_bf16_f32 v37, v78, v79
    v_lshlrev_b32 v80, 16, v38
    v_and_b32 v81, 0xffff0000, v38
    v_pk_fma_f32 v[80:81], v[80:81], v[72:73], v[74:75] op_sel_hi:[1,0,0]
    v_cvt_pk_bf16_f32 v38, v80, v81
    v_lshlrev_b32 v82, 16, v39
    v_and_b32 v83, 0xffff0000, v39
    v_pk_fma_f32 v[82:83], v[82:83], v[72:73], v[74:75] op_sel_hi:[1,0,0]
    v_cvt_pk_bf16_f32 v39, v82, v83
    v_lshlrev_b32 v76, 16, v40
    v_and_b32 v77, 0xffff0000, v40
    v_pk_fma_f32 v[76:77], v[76:77], v[72:73], v[74:75] op_sel_hi:[1,0,0]
    v_cvt_pk_bf16_f32 v40, v76, v77
    v_lshlrev_b32 v78, 16, v41
    v_and_b32 v79, 0xffff0000, v41
    v_pk_fma_f32 v[78:79], v[78:79], v[72:73], v[74:75] op_sel_hi:[1,0,0]
    v_cvt_pk_bf16_f32 v41, v78, v79
    v_lshlrev_b32 v80, 16, v42
    v_and_b32 v81, 0xffff0000, v42
    v_pk_fma_f32 v[80:81], v[80:81], v[72:73], v[74:75] op_sel_hi:[1,0,0]
    v_cvt_pk_bf16_f32 v42, v80, v81
    v_lshlrev_b32 v82, 16, v43
    v_and_b32 v83, 0xffff0000, v43
    v_pk_fma_f32 v[82:83], v[82:83], v[72:73], v[74:75] op_sel_hi:[1,0,0]
    v_cvt_pk_bf16_f32 v43, v82, v83
    s_mul_i32 s44, s85, 57344
    s_add_u32 s12, s94, s44
    s_addc_u32 s13, s95, 0
    s_add_u32 s12, s12, 2211840
    s_addc_u32 s13, s13, 0
    s_mov_b32 s14, 57344
    s_mov_b32 s15, 0x00020000
    s_mul_i32 s46, s3, 7
    s_lshl_b32 s46, s46, 10
    s_add_u32 s47, s46, 0
    s_mul_i32 s44, s89, 7168
    s_add_u32 s44, s44, 57344
    v_add_u32 v8, s44, v2
    ds_read_b128 v[80:83], v8 offset:0
    ds_read_b128 v[84:87], v8 offset:14336
    ds_read_b128 v[88:91], v8 offset:28672
    ds_read_b128 v[92:95], v8 offset:43008
    ds_read_b128 v[96:99], v8 offset:1024
    ds_read_b128 v[100:103], v8 offset:15360
    ds_read_b128 v[104:107], v8 offset:29696
    ds_read_b128 v[108:111], v8 offset:44032
    s_waitcnt lgkmcnt(4)
    v_mfma_f32_16x16x32_bf16 v[64:67], v[80:83], v[16:19], 0
    v_mfma_f32_16x16x32_bf16 v[68:71], v[84:87], v[16:19], 0
    v_mfma_f32_16x16x32_bf16 v[72:75], v[88:91], v[16:19], 0
    v_mfma_f32_16x16x32_bf16 v[76:79], v[92:95], v[16:19], 0
    s_mov_b32 m0, s47
    s_nop 0
    buffer_load_dwordx4 v2, s[12:15], s46 offen lds
    s_add_u32 s46, s46, 1024
    s_add_u32 s47, s47, 1024
    ds_read_b128 v[80:83], v8 offset:2048
    ds_read_b128 v[84:87], v8 offset:16384
    ds_read_b128 v[88:91], v8 offset:30720
    ds_read_b128 v[92:95], v8 offset:45056
    s_waitcnt lgkmcnt(4)
    v_mfma_f32_16x16x32_bf16 v[64:67], v[96:99], v[20:23], v[64:67]
    v_mfma_f32_16x16x32_bf16 v[68:71], v[100:103], v[20:23], v[68:71]
    v_mfma_f32_16x16x32_bf16 v[72:75], v[104:107], v[20:23], v[72:75]
    v_mfma_f32_16x16x32_bf16 v[76:79], v[108:111], v[20:23], v[76:79]
    s_mov_b32 m0, s47
    s_nop 0
    buffer_load_dwordx4 v2, s[12:15], s46 offen lds
    s_add_u32 s46, s46, 1024
    s_add_u32 s47, s47, 1024
    ds_read_b128 v[96:99], v8 offset:3072
    ds_read_b128 v[100:103], v8 offset:17408
    ds_read_b128 v[104:107], v8 offset:31744
    ds_read_b128 v[108:111], v8 offset:46080
    s_waitcnt lgkmcnt(4)
    v_mfma_f32_16x16x32_bf16 v[64:67], v[80:83], v[24:27], v[64:67]
    v_mfma_f32_16x16x32_bf16 v[68:71], v[84:87], v[24:27], v[68:71]
    v_mfma_f32_16x16x32_bf16 v[72:75], v[88:91], v[24:27], v[72:75]
    v_mfma_f32_16x16x32_bf16 v[76:79], v[92:95], v[24:27], v[76:79]
    s_mov_b32 m0, s47
    s_nop 0
    buffer_load_dwordx4 v2, s[12:15], s46 offen lds
    s_add_u32 s46, s46, 1024
    s_add_u32 s47, s47, 1024
    ds_read_b128 v[80:83], v8 offset:4096
    ds_read_b128 v[84:87], v8 offset:18432
    ds_read_b128 v[88:91], v8 offset:32768
    ds_read_b128 v[92:95], v8 offset:47104
    s_waitcnt lgkmcnt(4)
    v_mfma_f32_16x16x32_bf16 v[64:67], v[96:99], v[28:31], v[64:67]
    v_mfma_f32_16x16x32_bf16 v[68:71], v[100:103], v[28:31], v[68:71]
    v_mfma_f32_16x16x32_bf16 v[72:75], v[104:107], v[28:31], v[72:75]
    v_mfma_f32_16x16x32_bf16 v[76:79], v[108:111], v[28:31], v[76:79]
    s_mov_b32 m0, s47
    s_nop 0
    buffer_load_dwordx4 v2, s[12:15], s46 offen lds
    s_add_u32 s46, s46, 1024
    s_add_u32 s47, s47, 1024
    ds_read_b128 v[96:99], v8 offset:5120
    ds_read_b128 v[100:103], v8 offset:19456
    ds_read_b128 v[104:107], v8 offset:33792
    ds_read_b128 v[108:111], v8 offset:48128
    s_waitcnt lgkmcnt(4)
    v_mfma_f32_16x16x32_bf16 v[64:67], v[80:83], v[32:35], v[64:67]
    v_mfma_f32_16x16x32_bf16 v[68:71], v[84:87], v[32:35], v[68:71]
    v_mfma_f32_16x16x32_bf16 v[72:75], v[88:91], v[32:35], v[72:75]
    v_mfma_f32_16x16x32_bf16 v[76:79], v[92:95], v[32:35], v[76:79]
    s_mov_b32 m0, s47
    s_nop 0
    buffer_load_dwordx4 v2, s[12:15], s46 offen lds
    s_add_u32 s46, s46, 1024
    s_add_u32 s47, s47, 1024
    ds_read_b128 v[80:83], v8 offset:6144
    ds_read_b128 v[84:87], v8 offset:20480
    ds_read_b128 v[88:91], v8 offset:34816
    ds_read_b128 v[92:95], v8 offset:49152
    s_waitcnt lgkmcnt(4)
    v_mfma_f32_16x16x32_bf16 v[64:67], v[96:99], v[36:39], v[64:67]
    v_mfma_f32_16x16x32_bf16 v[68:71], v[100:103], v[36:39], v[68:71]
    v_mfma_f32_16x16x32_bf16 v[72:75], v[104:107], v[36:39], v[72:75]
    v_mfma_f32_16x16x32_bf16 v[76:79], v[108:111], v[36:39], v[76:79]
    s_mov_b32 m0, s47
    s_nop 0
    buffer_load_dwordx4 v2, s[12:15], s46 offen lds
    s_add_u32 s46, s46, 1024
    s_add_u32 s47, s47, 1024
    s_waitcnt lgkmcnt(0)
    v_mfma_f32_16x16x32_bf16 v[64:67], v[80:83], v[40:43], v[64:67]
    v_mfma_f32_16x16x32_bf16 v[68:71], v[84:87], v[40:43], v[68:71]
    v_mfma_f32_16x16x32_bf16 v[72:75], v[88:91], v[40:43], v[72:75]
    v_mfma_f32_16x16x32_bf16 v[76:79], v[92:95], v[40:43], v[76:79]
    s_mov_b32 m0, s47
    s_nop 0
    buffer_load_dwordx4 v2, s[12:15], s46 offen lds
    s_add_u32 s46, s46, 1024
    s_add_u32 s47, s47, 1024
    s_lshl_b32 s44, s88, 1
    s_add_u32 s44, s44, s89
    s_lshl_b32 s45, s44, 11
    s_xor_b32 s44, s44, 1
    s_lshl_b32 s44, s44, 11
    s_add_u32 s45, s45, 147456
    s_add_u32 s44, s44, 147456
    v_add_u32 v6, s45, v2
    v_add_u32 v7, s44, v2
    s_cmp_eq_u32 s89, 0
    s_nop 0
    s_cbranch_scc1 L_hx_lo_164
    ds_write_b128 v6, v[64:67]
    ds_write_b128 v6, v[68:71] offset:1024
    v_mov_b32 v16, v72
    v_mov_b32 v17, v73
    v_mov_b32 v18, v74
    v_mov_b32 v19, v75
    v_mov_b32 v20, v76
    v_mov_b32 v21, v77
    v_mov_b32 v22, v78
    v_mov_b32 v23, v79
    s_nop 1
    s_branch L_hx_j1_165
L_hx_lo_164:
    ds_write_b128 v6, v[72:75]
    ds_write_b128 v6, v[76:79] offset:1024
    v_mov_b32 v16, v64
    v_mov_b32 v17, v65
    v_mov_b32 v18, v66
    v_mov_b32 v19, v67
    v_mov_b32 v20, v68
    v_mov_b32 v21, v69
    v_mov_b32 v22, v70
    v_mov_b32 v23, v71
    s_nop 1
L_hx_j1_165:
    s_waitcnt lgkmcnt(0)
    s_barrier
    ds_read_b128 v[64:67], v7
    ds_read_b128 v[68:71], v7 offset:1024
    s_waitcnt lgkmcnt(0)
    v_add_f32 v16, v16, v64
    v_add_f32 v17, v17, v65
    v_add_f32 v18, v18, v66
    v_add_f32 v19, v19, v67
    v_add_f32 v20, v20, v68
    v_add_f32 v21, v21, v69
    v_add_f32 v22, v22, v70
    v_add_f32 v23, v23, v71
    v_cvt_pk_bf16_f32 v17, v16, v17
    v_lshlrev_b32 v16, 16, v17
    v_and_b32 v17, 0xffff0000, v17
    v_cvt_pk_bf16_f32 v19, v18, v19
    v_lshlrev_b32 v18, 16, v19
    v_and_b32 v19, 0xffff0000, v19
    v_cvt_pk_bf16_f32 v21, v20, v21
    v_lshlrev_b32 v20, 16, v21
    v_and_b32 v21, 0xffff0000, v21
    v_cvt_pk_bf16_f32 v23, v22, v23
    v_lshlrev_b32 v22, 16, v23
    v_and_b32 v23, 0xffff0000, v23
    v_mul_f32 v32, v16, v16
    v_mul_f32 v33, v17, v17
    v_mul_f32 v34, v18, v18
    v_mul_f32 v35, v19, v19
    v_fma_f32 v32, v32, s90, 1.0
    v_fma_f32 v33, v33, s90, 1.0
    v_fma_f32 v34, v34, s90, 1.0
    v_fma_f32 v35, v35, s90, 1.0
    v_mul_f32 v32, v32, v16
    v_mul_f32 v33, v33, v17
    v_mul_f32 v34, v34, v18
    v_mul_f32 v35, v35, v19
    v_mul_f32 v32, s91, v32
    v_mul_f32 v33, s91, v33
    v_mul_f32 v34, s91, v34
    v_mul_f32 v35, s91, v35
    v_exp_f32 v32, v32
    v_exp_f32 v33, v33
    v_exp_f32 v34, v34
    v_exp_f32 v35, v35
    v_add_f32 v32, 1.0, v32
    v_add_f32 v33, 1.0, v33
    v_add_f32 v34, 1.0, v34
    v_add_f32 v35, 1.0, v35
    v_rcp_f32 v32, v32
    v_rcp_f32 v33, v33
    v_rcp_f32 v34, v34
    v_rcp_f32 v35, v35
    v_mul_f32 v16, v16, v32
    v_mul_f32 v17, v17, v33
    v_mul_f32 v18, v18, v34
    v_mul_f32 v19, v19, v35
    v_mul_f32 v32, v20, v20
    v_mul_f32 v33, v21, v21
    v_mul_f32 v34, v22, v22
    v_mul_f32 v35, v23, v23
    v_fma_f32 v32, v32, s90, 1.0
    v_fma_f32 v33, v33, s90, 1.0
    v_fma_f32 v34, v34, s90, 1.0
    v_fma_f32 v35, v35, s90, 1.0
    v_mul_f32 v32, v32, v20
    v_mul_f32 v33, v33, v21
    v_mul_f32 v34, v34, v22
    v_mul_f32 v35, v35, v23
    v_mul_f32 v32, s91, v32
    v_mul_f32 v33, s91, v33
    v_mul_f32 v34, s91, v34
    v_mul_f32 v35, s91, v35
    v_exp_f32 v32, v32
    v_exp_f32 v33, v33
    v_exp_f32 v34, v34
    v_exp_f32 v35, v35
    v_add_f32 v32, 1.0, v32
    v_add_f32 v33, 1.0, v33
    v_add_f32 v34, 1.0, v34
    v_add_f32 v35, 1.0, v35
    v_rcp_f32 v32, v32
    v_rcp_f32 v33, v33
    v_rcp_f32 v34, v34
    v_rcp_f32 v35, v35
    v_mul_f32 v20, v20, v32
    v_mul_f32 v21, v21, v33
    v_mul_f32 v22, v22, v34
    v_mul_f32 v23, v23, v35
    v_cvt_pk_bf16_f32 v24, v16, v17
    v_cvt_pk_bf16_f32 v25, v18, v19
    v_cvt_pk_bf16_f32 v26, v20, v21
    v_cvt_pk_bf16_f32 v27, v22, v23
    s_lshl_b32 s41, s84, 2
    s_add_u32 s41, s41, s88
    s_mul_i32 s41, s41, 14
    s_lshl_b32 s45, s85, 1
    s_add_u32 s41, s41, s45
    s_add_u32 s41, s41, s89
    s_lshl_b32 s41, s41, 10
    s_and_b32 s42, s84, 3
    s_cmp_eq_u32 s42, s88
    s_cselect_b32 s43, 1, 0
    s_add_u32 s44, s42, 1
    s_and_b32 s44, s44, 2
    s_cmp_eq_u32 s44, 0
    s_cselect_b32 s42, 1, 0
    s_and_b32 s43, s43, s42
    s_cmp_lg_u32 s43, 0
    s_cbranch_scc1 L_k3bs_166
    buffer_store_dwordx4 v[24:27], v2, s[20:23], s41 offen
    s_nop 1
    s_branch L_k3bj_167
L_k3bs_166:
    buffer_store_dwordx4 v[24:27], v2, s[20:23], s41 offen sc1
    s_nop 1
L_k3bj_167:
    s_lshl_b32 s40, s84, 3
    s_add_u32 s40, s40, s85
    s_add_u32 s40, s40, 2816
    s_waitcnt vmcnt(0)
    s_barrier
    s_cmp_lg_u32 s3, 0
    s_cbranch_scc1 L_sig_168
    s_add_u32 s28, s94, 7921664
    s_addc_u32 s29, s95, 0
    s_mov_b32 s30, 16384
    s_mov_b32 s31, 0x00020000
    s_lshl_b32 s48, s40, 2
    v_mov_b32 v6, 1
    v_mov_b32 v7, s48
    s_mov_b64 exec, 1
    s_cmp_lg_u32 s80, 0
    s_cbranch_scc1 L_sigfb_169
    buffer_store_dword v6, v7, s[28:31], 0 offen
    s_nop 1
    s_branch L_sigj_170
L_sigfb_169:
    buffer_wbl2 sc1
    s_waitcnt vmcnt(0)
    buffer_store_dword v6, v7, s[28:31], 0 offen sc1
    s_nop 1
L_sigj_170:
    s_cmp_eq_u32 s42, 0
    s_cbranch_scc1 L_signr_171
    v_add_u32 v7, 4096, v7
    buffer_store_dword v6, v7, s[28:31], 0 offen sc1
    s_nop 1
L_signr_171:
    s_mov_b64 exec, -1
L_sig_168:
    s_lshl_b32 s40, s84, 3
    s_add_u32 s40, s40, 2808
    s_cmp_lg_u32 s3, 0
    s_cbranch_scc1 L_wsk_172
    s_add_u32 s28, s94, 7921664
    s_addc_u32 s29, s95, 0
    s_mov_b32 s30, 16384
    s_mov_b32 s31, 0x00020000
    s_mov_b32 s50, 0
    v_add_u32 v6, s40, v1
    v_and_b32 v7, 7, v1
    v_cmp_eq_u32 s[48:49], 7, v7
    v_cmp_le_u32 vcc, 24, v1
    s_nop 0
    s_or_b64 s[48:49], s[48:49], vcc
    v_lshrrev_b32 v7, 3, v1
    v_add_u32 v7, s84, v7
    v_cmp_eq_u32 vcc, 0, v7
    s_nop 0
    s_or_b64 s[48:49], s[48:49], vcc
    v_cmp_lt_u32 vcc, 32, v7
    s_nop 0
    s_or_b64 s[48:49], s[48:49], vcc
    s_and_b32 s51, s84, 3
    s_cmp_eq_u32 s51, 0
    s_cselect_b32 s45, 1024, 0
    s_cmp_eq_u32 s51, 3
    s_cselect_b32 s51, 1024, 0
    v_cmp_gt_u32 vcc, 8, v1
    v_mov_b32 v7, s45
    s_nop 0
    v_cndmask_b32 v7, 0, v7, vcc
    v_add_u32 v6, v6, v7
    v_cmp_le_u32 vcc, 16, v1
    v_mov_b32 v7, s51
    s_nop 0
    v_cndmask_b32 v7, 0, v7, vcc
    v_add_u32 v6, v6, v7
    v_lshlrev_b32 v6, 2, v6
    v_cndmask_b32 v6, v6, 0, s[48:49]
    s_nop 1
L_wlp_173:
    buffer_load_dword v8, v6, s[28:31], 0 offen sc1
    s_waitcnt vmcnt(0)
    v_cmp_ne_u32 vcc, 0, v8
    s_nop 0
    s_or_b64 vcc, vcc, s[48:49]
    s_cmp_eq_u64 vcc, -1
    s_nop 1
    s_cbranch_scc1 L_wdn_174
    s_sleep 1
    s_add_u32 s50, s50, 1
    s_cmp_lt_u32 s50, 65536
    s_cbranch_scc1 L_wlp_173
L_wdn_174:
    s_cmp_eq_u32 s80, 0
    s_cbranch_scc1 L_wsk_172
    buffer_inv sc1
    s_waitcnt vmcnt(0)
L_wsk_172:
    s_barrier
    s_add_u32 s8, s94, 20783104
    s_addc_u32 s9, s95, 0
    s_mov_b32 s10, 1835008
    s_mov_b32 s11, 0x00020000
    s_add_u32 s16, s94, 17113088
    s_addc_u32 s17, s95, 0
    s_mov_b32 s18, 1835008
    s_mov_b32 s19, 0x00020000
    s_add_u32 s20, s94, 24453120
    s_addc_u32 s21, s95, 0
    s_mov_b32 s22, 1835008
    s_mov_b32 s23, 0x00020000
    s_lshl_b32 s44, s84, 6
    s_lshl_b32 s45, s88, 4
    s_add_u32 s44, s44, s45
    v_add_u32 v12, s44, v3
    s_mov_b32 s45, 14336
    v_add_u32 v10, -1, v12
    v_ashrrev_i32 v9, 4, v10
    v_mul_lo_u32 v13, v9, s45
    v_and_b32 v10, 15, v10
    v_lshl_add_u32 v13, v10, 4, v13
    v_lshl_add_u32 v13, v4, 8, v13
    v_add_u32 v10, 1, v12
    v_ashrrev_i32 v9, 4, v10
    v_mul_lo_u32 v14, v9, s45
    v_and_b32 v10, 15, v10
    v_lshl_add_u32 v14, v10, 4, v14
    v_lshl_add_u32 v14, v4, 8, v14
    v_add_u32 v10, -2, v12
    v_ashrrev_i32 v9, 4, v10
    v_mul_lo_u32 v15, v9, s45
    v_and_b32 v10, 15, v10
    v_lshl_add_u32 v15, v10, 4, v15
    v_lshl_add_u32 v15, v4, 8, v15
    v_add_u32 v10, 2, v12
    v_ashrrev_i32 v9, 4, v10
    v_mul_lo_u32 v11, v9, s45
    v_and_b32 v10, 15, v10
    v_lshl_add_u32 v11, v10, 4, v11
    v_lshl_add_u32 v11, v4, 8, v11
    s_mul_i32 s44, s89, 7168
    s_add_u32 s45, s44, 4096
    s_cmp_eq_u32 s89, 1
    s_cbranch_scc1 L_k4hi_175
    v_cndmask_b32 v10, v14, v13, s[58:59]
    buffer_load_dwordx4 v[16:19], v13, s[8:11], s44 offen offset:0
    buffer_load_dwordx4 v[20:23], v13, s[8:11], s44 offen offset:1024
    buffer_load_dwordx4 v[24:27], v13, s[8:11], s44 offen offset:2048
    buffer_load_dwordx4 v[28:31], v10, s[8:11], s44 offen offset:3072
    buffer_load_dwordx4 v[32:35], v14, s[8:11], s45 offen offset:0
    buffer_load_dwordx4 v[36:39], v14, s[8:11], s45 offen offset:1024
    buffer_load_dwordx4 v[40:43], v14, s[8:11], s45 offen offset:2048
    s_branch L_k4jn_176
L_k4hi_175:
    v_cndmask_b32 v10, v11, v15, s[58:59]
    buffer_load_dwordx4 v[16:19], v15, s[8:11], s44 offen offset:0
    buffer_load_dwordx4 v[20:23], v15, s[8:11], s44 offen offset:1024
    buffer_load_dwordx4 v[24:27], v15, s[8:11], s44 offen offset:2048
    buffer_load_dwordx4 v[28:31], v10, s[8:11], s44 offen offset:3072
    buffer_load_dwordx4 v[32:35], v11, s[8:11], s45 offen offset:0
    buffer_load_dwordx4 v[36:39], v11, s[8:11], s45 offen offset:1024
    buffer_load_dwordx4 v[40:43], v11, s[8:11], s45 offen offset:2048
L_k4jn_176:
    s_lshl_b32 s41, s84, 2
    s_add_u32 s41, s41, s88
    s_mul_i32 s41, s41, 14
    s_lshl_b32 s45, s85, 1
    s_add_u32 s41, s41, s45
    s_add_u32 s41, s41, s89
    s_lshl_b32 s41, s41, 10
    buffer_load_dwordx4 v[60:63], v2, s[16:19], s41 offen
    s_waitcnt vmcnt(0)
    s_barrier
    s_mul_i32 s44, s83, 114688
    s_add_u32 s12, s94, s44
    s_addc_u32 s13, s95, 0
    s_add_u32 s12, s12, 2613248
    s_addc_u32 s13, s13, 0
    s_mov_b32 s14, 114688
    s_mov_b32 s15, 0x00020000
    s_mul_i32 s46, s3, 11
    s_min_u32 s46, s46, 73
    s_lshl_b32 s46, s46, 10
    s_add_u32 s47, s46, 57344
    s_mul_i32 s44, s89, 7168
    v_add_u32 v8, s44, v2
    ds_read_b128 v[80:83], v8 offset:0
    ds_read_b128 v[84:87], v8 offset:14336
    ds_read_b128 v[88:91], v8 offset:28672
    ds_read_b128 v[92:95], v8 offset:43008
    ds_read_b128 v[96:99], v8 offset:1024
    ds_read_b128 v[100:103], v8 offset:15360
    ds_read_b128 v[104:107], v8 offset:29696
    ds_read_b128 v[108:111], v8 offset:44032
    s_waitcnt lgkmcnt(4)
    v_mfma_f32_16x16x32_bf16 v[64:67], v[80:83], v[16:19], 0
    v_mfma_f32_16x16x32_bf16 v[68:71], v[84:87], v[16:19], 0
    v_mfma_f32_16x16x32_bf16 v[72:75], v[88:91], v[16:19], 0
    v_mfma_f32_16x16x32_bf16 v[76:79], v[92:95], v[16:19], 0
    s_mov_b32 m0, s47
    s_nop 0
    buffer_load_dwordx4 v2, s[12:15], s46 offen lds
    s_add_u32 s46, s46, 1024
    s_add_u32 s47, s47, 1024
    s_mov_b32 m0, s47
    s_nop 0
    buffer_load_dwordx4 v2, s[12:15], s46 offen lds
    s_add_u32 s46, s46, 1024
    s_add_u32 s47, s47, 1024
    ds_read_b128 v[80:83], v8 offset:2048
    ds_read_b128 v[84:87], v8 offset:16384
    ds_read_b128 v[88:91], v8 offset:30720
    ds_read_b128 v[92:95], v8 offset:45056
    s_waitcnt lgkmcnt(4)
    v_mfma_f32_16x16x32_bf16 v[64:67], v[96:99], v[20:23], v[64:67]
    v_mfma_f32_16x16x32_bf16 v[68:71], v[100:103], v[20:23], v[68:71]
    v_mfma_f32_16x16x32_bf16 v[72:75], v[104:107], v[20:23], v[72:75]
    v_mfma_f32_16x16x32_bf16 v[76:79], v[108:111], v[20:23], v[76:79]
    s_mov_b32 m0, s47
    s_nop 0
    buffer_load_dwordx4 v2, s[12:15], s46 offen lds
    s_add_u32 s46, s46, 1024
    s_add_u32 s47, s47, 1024
    s_mov_b32 m0, s47
    s_nop 0
    buffer_load_dwordx4 v2, s[12:15], s46 offen lds
    s_add_u32 s46, s46, 1024
    s_add_u32 s47, s47, 1024
    ds_read_b128 v[96:99], v8 offset:3072
    ds_read_b128 v[100:103], v8 offset:17408
    ds_read_b128 v[104:107], v8 offset:31744
    ds_read_b128 v[108:111], v8 offset:46080
    s_waitcnt lgkmcnt(4)
    v_mfma_f32_16x16x32_bf16 v[64:67], v[80:83], v[24:27], v[64:67]
    v_mfma_f32_16x16x32_bf16 v[68:71], v[84:87], v[24:27], v[68:71]
    v_mfma_f32_16x16x32_bf16 v[72:75], v[88:91], v[24:27], v[72:75]
    v_mfma_f32_16x16x32_bf16 v[76:79], v[92:95], v[24:27], v[76:79]
    s_mov_b32 m0, s47
    s_nop 0
    buffer_load_dwordx4 v2, s[12:15], s46 offen lds
    s_add_u32 s46, s46, 1024
    s_add_u32 s47, s47, 1024
    s_mov_b32 m0, s47
    s_nop 0
    buffer_load_dwordx4 v2, s[12:15], s46 offen lds
    s_add_u32 s46, s46, 1024
    s_add_u32 s47, s47, 1024
    ds_read_b128 v[80:83], v8 offset:4096
    ds_read_b128 v[84:87], v8 offset:18432
    ds_read_b128 v[88:91], v8 offset:32768
    ds_read_b128 v[92:95], v8 offset:47104
    s_waitcnt lgkmcnt(4)
    v_mfma_f32_16x16x32_bf16 v[64:67], v[96:99], v[28:31], v[64:67]
    v_mfma_f32_16x16x32_bf16 v[68:71], v[100:103], v[28:31], v[68:71]
    v_mfma_f32_16x16x32_bf16 v[72:75], v[104:107], v[28:31], v[72:75]
    v_mfma_f32_16x16x32_bf16 v[76:79], v[108:111], v[28:31], v[76:79]
    s_mov_b32 m0, s47
    s_nop 0
    buffer_load_dwordx4 v2, s[12:15], s46 offen lds
    s_add_u32 s46, s46, 1024
    s_add_u32 s47, s47, 1024
    s_mov_b32 m0, s47
    s_nop 0
    buffer_load_dwordx4 v2, s[12:15], s46 offen lds
    s_add_u32 s46, s46, 1024
    s_add_u32 s47, s47, 1024
    ds_read_b128 v[96:99], v8 offset:5120
    ds_read_b128 v[100:103], v8 offset:19456
    ds_read_b128 v[104:107], v8 offset:33792
    ds_read_b128 v[108:111], v8 offset:48128
    s_waitcnt lgkmcnt(4)
    v_mfma_f32_16x16x32_bf16 v[64:67], v[80:83], v[32:35], v[64:67]
    v_mfma_f32_16x16x32_bf16 v[68:71], v[84:87], v[32:35], v[68:71]
    v_mfma_f32_16x16x32_bf16 v[72:75], v[88:91], v[32:35], v[72:75]
    v_mfma_f32_16x16x32_bf16 v[76:79], v[92:95], v[32:35], v[76:79]
    s_mov_b32 m0, s47
    s_nop 0
    buffer_load_dwordx4 v2, s[12:15], s46 offen lds
    s_add_u32 s46, s46, 1024
    s_add_u32 s47, s47, 1024
    ds_read_b128 v[80:83], v8 offset:6144
    ds_read_b128 v[84:87], v8 offset:20480
    ds_read_b128 v[88:91], v8 offset:34816
    ds_read_b128 v[92:95], v8 offset:49152
    s_waitcnt lgkmcnt(4)
    v_mfma_f32_16x16x32_bf16 v[64:67], v[96:99], v[36:39], v[64:67]
    v_mfma_f32_16x16x32_bf16 v[68:71], v[100:103], v[36:39], v[68:71]
    v_mfma_f32_16x16x32_bf16 v[72:75], v[104:107], v[36:39], v[72:75]
    v_mfma_f32_16x16x32_bf16 v[76:79], v[108:111], v[36:39], v[76:79]
    s_mov_b32 m0, s47
    s_nop 0
    buffer_load_dwordx4 v2, s[12:15], s46 offen lds
    s_add_u32 s46, s46, 1024
    s_add_u32 s47, s47, 1024
    s_waitcnt lgkmcnt(0)
    v_mfma_f32_16x16x32_bf16 v[64:67], v[80:83], v[40:43], v[64:67]
    v_mfma_f32_16x16x32_bf16 v[68:71], v[84:87], v[40:43], v[68:71]
    v_mfma_f32_16x16x32_bf16 v[72:75], v[88:91], v[40:43], v[72:75]
    v_mfma_f32_16x16x32_bf16 v[76:79], v[92:95], v[40:43], v[76:79]
    s_mov_b32 m0, s47
    s_nop 0
    buffer_load_dwordx4 v2, s[12:15], s46 offen lds
    s_add_u32 s46, s46, 1024
    s_add_u32 s47, s47, 1024
    s_lshl_b32 s44, s88, 1
    s_add_u32 s44, s44, s89
    s_lshl_b32 s45, s44, 11
    s_xor_b32 s44, s44, 1
    s_lshl_b32 s44, s44, 11
    s_add_u32 s45, s45, 147456
    s_add_u32 s44, s44, 147456
    v_add_u32 v6, s45, v2
    v_add_u32 v7, s44, v2
    s_cmp_eq_u32 s89, 0
    s_nop 0
    s_cbranch_scc1 L_hx_lo_177
    ds_write_b128 v6, v[64:67]
    ds_write_b128 v6, v[68:71] offset:1024
    v_mov_b32 v16, v72
    v_mov_b32 v17, v73
    v_mov_b32 v18, v74
    v_mov_b32 v19, v75
    v_mov_b32 v20, v76
    v_mov_b32 v21, v77
    v_mov_b32 v22, v78
    v_mov_b32 v23, v79
    s_nop 1
    s_branch L_hx_j1_178
L_hx_lo_177:
    ds_write_b128 v6, v[72:75]
    ds_write_b128 v6, v[76:79] offset:1024
    v_mov_b32 v16, v64
    v_mov_b32 v17, v65
    v_mov_b32 v18, v66
    v_mov_b32 v19, v67
    v_mov_b32 v20, v68
    v_mov_b32 v21, v69
    v_mov_b32 v22, v70
    v_mov_b32 v23, v71
    s_nop 1
L_hx_j1_178:
    s_waitcnt lgkmcnt(0)
    s_barrier
    ds_read_b128 v[64:67], v7
    ds_read_b128 v[68:71], v7 offset:1024
    s_waitcnt lgkmcnt(0)
    v_add_f32 v16, v16, v64
    v_add_f32 v17, v17, v65
    v_add_f32 v18, v18, v66
    v_add_f32 v19, v19, v67
    v_add_f32 v20, v20, v68
    v_add_f32 v21, v21, v69
    v_add_f32 v22, v22, v70
    v_add_f32 v23, v23, v71
    v_cvt_pk_bf16_f32 v17, v16, v17
    v_lshlrev_b32 v16, 16, v17
    v_and_b32 v17, 0xffff0000, v17
    v_cvt_pk_bf16_f32 v19, v18, v19
    v_lshlrev_b32 v18, 16, v19
    v_and_b32 v19, 0xffff0000, v19
    v_cvt_pk_bf16_f32 v21, v20, v21
    v_lshlrev_b32 v20, 16, v21
    v_and_b32 v21, 0xffff0000, v21
    v_cvt_pk_bf16_f32 v23, v22, v23
    v_lshlrev_b32 v22, 16, v23
    v_and_b32 v23, 0xffff0000, v23
    v_lshlrev_b32 v8, 16, v60
    v_and_b32 v9, 0xffff0000, v60
    v_add_f32 v16, v16, v8
    v_add_f32 v17, v17, v9
    v_lshlrev_b32 v8, 16, v61
    v_and_b32 v9, 0xffff0000, v61
    v_add_f32 v18, v18, v8
    v_add_f32 v19, v19, v9
    v_lshlrev_b32 v8, 16, v62
    v_and_b32 v9, 0xffff0000, v62
    v_add_f32 v20, v20, v8
    v_add_f32 v21, v21, v9
    v_lshlrev_b32 v8, 16, v63
    v_and_b32 v9, 0xffff0000, v63
    v_add_f32 v22, v22, v8
    v_add_f32 v23, v23, v9
    v_cvt_pk_bf16_f32 v24, v16, v17
    v_cvt_pk_bf16_f32 v25, v18, v19
    v_cvt_pk_bf16_f32 v26, v20, v21
    v_cvt_pk_bf16_f32 v27, v22, v23
    buffer_store_dwordx4 v[24:27], v2, s[20:23], s41 offen
    s_lshl_b32 s40, s84, 3
    s_add_u32 s40, s40, s85
    s_add_u32 s40, s40, 3072
    s_waitcnt vmcnt(0)
    s_barrier
    s_cmp_lg_u32 s3, 0
    s_cbranch_scc1 L_sig_179
    s_add_u32 s28, s94, 7921664
    s_addc_u32 s29, s95, 0
    s_mov_b32 s30, 16384
    s_mov_b32 s31, 0x00020000
    s_lshl_b32 s48, s40, 2
    v_mov_b32 v6, 1
    v_mov_b32 v7, s48
    s_mov_b64 exec, 1
    s_cmp_lg_u32 s80, 0
    s_cbranch_scc1 L_sigfb_180
    buffer_store_dword v6, v7, s[28:31], 0 offen
    s_nop 1
    s_branch L_sigj_181
L_sigfb_180:
    buffer_wbl2 sc1
    s_waitcnt vmcnt(0)
    buffer_store_dword v6, v7, s[28:31], 0 offen sc1
    s_nop 1
L_sigj_181:
    s_mov_b64 exec, -1
L_sig_179:
    s_mul_i32 s44, s83, 114688
    s_add_u32 s12, s94, s44
    s_addc_u32 s13, s95, 0
    s_add_u32 s12, s12, 2613248
    s_addc_u32 s13, s13, 0
    s_mov_b32 s14, 114688
    s_mov_b32 s15, 0x00020000
    s_mul_i32 s46, s3, 3
    s_min_u32 s47, s3, 4
    s_add_u32 s46, s46, s47
    s_add_u32 s46, s46, 84
    s_lshl_b32 s44, s46, 10
    s_add_u32 s45, s44, 4294881280
    s_mov_b32 m0, s45
    s_nop 0
    buffer_load_dwordx4 v2, s[12:15], s44 offen offset:0 lds
    buffer_load_dwordx4 v2, s[12:15], s44 offen offset:1024 lds
    buffer_load_dwordx4 v2, s[12:15], s44 offen offset:2048 lds
    s_cmp_ge_u32 s3, 4
    s_cbranch_scc1 L_k5b_182
    s_add_u32 s46, s46, 3
    s_lshl_b32 s44, s46, 10
    s_add_u32 s45, s44, 4294881280
    s_mov_b32 m0, s45
    s_nop 0
    buffer_load_dwordx4 v2, s[12:15], s44 offen offset:0 lds
L_k5b_182:
    s_lshl_b32 s40, s82, 4
    s_add_u32 s40, s40, 3072
    s_cmp_lg_u32 s3, 0
    s_cbranch_scc1 L_wsk_183
    s_add_u32 s28, s94, 7921664
    s_addc_u32 s29, s95, 0
    s_mov_b32 s30, 16384
    s_mov_b32 s31, 0x00020000
    s_mov_b32 s50, 0
    v_add_u32 v6, s40, v1
    v_and_b32 v7, 7, v1
    v_cmp_eq_u32 s[48:49], 7, v7
    v_cmp_le_u32 vcc, 16, v1
    s_nop 0
    s_or_b64 s[48:49], s[48:49], vcc
    v_lshlrev_b32 v6, 2, v6
    v_cndmask_b32 v6, v6, 0, s[48:49]
    s_nop 1
L_wlp_184:
    buffer_load_dword v8, v6, s[28:31], 0 offen sc1
    s_waitcnt vmcnt(0)
    v_cmp_ne_u32 vcc, 0, v8
    s_nop 0
    s_or_b64 vcc, vcc, s[48:49]
    s_cmp_eq_u64 vcc, -1
    s_nop 1
    s_cbranch_scc1 L_wdn_185
    s_sleep 1
    s_add_u32 s50, s50, 1
    s_cmp_lt_u32 s50, 65536
    s_cbranch_scc1 L_wlp_184
L_wdn_185:
    s_cmp_eq_u32 s80, 0
    s_cbranch_scc1 L_wsk_183
    buffer_inv sc1
    s_waitcnt vmcnt(0)
L_wsk_183:
    s_barrier
    s_add_u32 s8, s94, 24453120
    s_addc_u32 s9, s95, 0
    s_mov_b32 s10, 1835008
    s_mov_b32 s11, 0x00020000
    s_add_u32 s20, s94, 33628160
    s_addc_u32 s21, s95, 0
    s_mov_b32 s22, 7340032
    s_mov_b32 s23, 0x00020000
    s_lshl_b32 s47, s82, 3
    s_add_u32 s47, s47, s3
    s_mul_i32 s44, s47, 14336
    buffer_load_dwordx4 v[16:19], v2, s[8:11], s44 offen offset:0
    buffer_load_dwordx4 v[20:23], v2, s[8:11], s44 offen offset:1024
    buffer_load_dwordx4 v[24:27], v2, s[8:11], s44 offen offset:2048
    buffer_load_dwordx4 v[28:31], v2, s[8:11], s44 offen offset:3072
    s_add_u32 s44, s44, 4096
    buffer_load_dwordx4 v[32:35], v2, s[8:11], s44 offen offset:0
    buffer_load_dwordx4 v[36:39], v2, s[8:11], s44 offen offset:1024
    buffer_load_dwordx4 v[40:43], v2, s[8:11], s44 offen offset:2048
    buffer_load_dwordx4 v[44:47], v2, s[8:11], s44 offen offset:3072
    s_add_u32 s44, s44, 4096
    buffer_load_dwordx4 v[48:51], v2, s[8:11], s44 offen offset:0
    buffer_load_dwordx4 v[52:55], v2, s[8:11], s44 offen offset:1024
    buffer_load_dwordx4 v[56:59], v2, s[8:11], s44 offen offset:2048
    buffer_load_dwordx4 v[60:63], v2, s[8:11], s44 offen offset:3072
    s_add_u32 s44, s44, 4096
    buffer_load_dwordx4 v[64:67], v2, s[8:11], s44 offen offset:0
    buffer_load_dwordx4 v[68:71], v2, s[8:11], s44 offen offset:1024
    s_waitcnt vmcnt(0)
    v_mov_b32 v8, 0
    v_mov_b32 v9, 0
    v_mov_b32 v10, 0
    v_mov_b32 v11, 0
    v_dot2_f32_bf16 v8, v16, s60, v8
    v_dot2_f32_bf16 v9, v16, v16, v9
    v_dot2_f32_bf16 v10, v17, s60, v10
    v_dot2_f32_bf16 v11, v17, v17, v11
    v_dot2_f32_bf16 v8, v18, s60, v8
    v_dot2_f32_bf16 v9, v18, v18, v9
    v_dot2_f32_bf16 v10, v19, s60, v10
    v_dot2_f32_bf16 v11, v19, v19, v11
    v_dot2_f32_bf16 v8, v20, s60, v8
    v_dot2_f32_bf16 v9, v20, v20, v9
    v_dot2_f32_bf16 v10, v21, s60, v10
    v_dot2_f32_bf16 v11, v21, v21, v11
    v_dot2_f32_bf16 v8, v22, s60, v8
    v_dot2_f32_bf16 v9, v22, v22, v9
    v_dot2_f32_bf16 v10, v23, s60, v10
    v_dot2_f32_bf16 v11, v23, v23, v11
    v_dot2_f32_bf16 v8, v24, s60, v8
    v_dot2_f32_bf16 v9, v24, v24, v9
    v_dot2_f32_bf16 v10, v25, s60, v10
    v_dot2_f32_bf16 v11, v25, v25, v11
    v_dot2_f32_bf16 v8, v26, s60, v8
    v_dot2_f32_bf16 v9, v26, v26, v9
    v_dot2_f32_bf16 v10, v27, s60, v10
    v_dot2_f32_bf16 v11, v27, v27, v11
    v_dot2_f32_bf16 v8, v28, s60, v8
    v_dot2_f32_bf16 v9, v28, v28, v9
    v_dot2_f32_bf16 v10, v29, s60, v10
    v_dot2_f32_bf16 v11, v29, v29, v11
    v_dot2_f32_bf16 v8, v30, s60, v8
    v_dot2_f32_bf16 v9, v30, v30, v9
    v_dot2_f32_bf16 v10, v31, s60, v10
    v_dot2_f32_bf16 v11, v31, v31, v11
    v_dot2_f32_bf16 v8, v32, s60, v8
    v_dot2_f32_bf16 v9, v32, v32, v9
    v_dot2_f32_bf16 v10, v33, s60, v10
    v_dot2_f32_bf16 v11, v33, v33, v11
    v_dot2_f32_bf16 v8, v34, s60, v8
    v_dot2_f32_bf16 v9, v34, v34, v9
    v_dot2_f32_bf16 v10, v35, s60, v10
    v_dot2_f32_bf16 v11, v35, v35, v11
    v_dot2_f32_bf16 v8, v36, s60, v8
    v_dot2_f32_bf16 v9, v36, v36, v9
    v_dot2_f32_bf16 v10, v37, s60, v10
    v_dot2_f32_bf16 v11, v37, v37, v11
    v_dot2_f32_bf16 v8, v38, s60, v8
    v_dot2_f32_bf16 v9, v38, v38, v9
    v_dot2_f32_bf16 v10, v39, s60, v10
    v_dot2_f32_bf16 v11, v39, v39, v11
    v_dot2_f32_bf16 v8, v40, s60, v8
    v_dot2_f32_bf16 v9, v40, v40, v9
    v_dot2_f32_bf16 v10, v41, s60, v10
    v_dot2_f32_bf16 v11, v41, v41, v11
    v_dot2_f32_bf16 v8, v42, s60, v8
    v_dot2_f32_bf16 v9, v42, v42, v9
    v_dot2_f32_bf16 v10, v43, s60, v10
    v_dot2_f32_bf16 v11, v43, v43, v11
    v_dot2_f32_bf16 v8, v44, s60, v8
    v_dot2_f32_bf16 v9, v44, v44, v9
    v_dot2_f32_bf16 v10, v45, s60, v10
    v_dot2_f32_bf16 v11, v45, v45, v11
    v_dot2_f32_bf16 v8, v46, s60, v8
    v_dot2_f32_bf16 v9, v46, v46, v9
    v_dot2_f32_bf16 v10, v47, s60, v10
    v_dot2_f32_bf16 v11, v47, v47, v11
    v_dot2_f32_bf16 v8, v48, s60, v8
    v_dot2_f32_bf16 v9, v48, v48, v9
    v_dot2_f32_bf16 v10, v49, s60, v10
    v_dot2_f32_bf16 v11, v49, v49, v11
    v_dot2_f32_bf16 v8, v50, s60, v8
    v_dot2_f32_bf16 v9, v50, v50, v9
    v_dot2_f32_bf16 v10, v51, s60, v10
    v_dot2_f32_bf16 v11, v51, v51, v11
    v_dot2_f32_bf16 v8, v52, s60, v8
    v_dot2_f32_bf16 v9, v52, v52, v9
    v_dot2_f32_bf16 v10, v53, s60, v10
    v_dot2_f32_bf16 v11, v53, v53, v11
    v_dot2_f32_bf16 v8, v54, s60, v8
    v_dot2_f32_bf16 v9, v54, v54, v9
    v_dot2_f32_bf16 v10, v55, s60, v10
    v_dot2_f32_bf16 v11, v55, v55, v11
    v_dot2_f32_bf16 v8, v56, s60, v8
    v_dot2_f32_bf16 v9, v56, v56, v9
    v_dot2_f32_bf16 v10, v57, s60, v10
    v_dot2_f32_bf16 v11, v57, v57, v11
    v_dot2_f32_bf16 v8, v58, s60, v8
    v_dot2_f32_bf16 v9, v58, v58, v9
    v_dot2_f32_bf16 v10, v59, s60, v10
    v_dot2_f32_bf16 v11, v59, v59, v11
    v_dot2_f32_bf16 v8, v60, s60, v8
    v_dot2_f32_bf16 v9, v60, v60, v9
    v_dot2_f32_bf16 v10, v61, s60, v10
    v_dot2_f32_bf16 v11, v61, v61, v11
    v_dot2_f32_bf16 v8, v62, s60, v8
    v_dot2_f32_bf16 v9, v62, v62, v9
    v_dot2_f32_bf16 v10, v63, s60, v10
    v_dot2_f32_bf16 v11, v63, v63, v11
    v_dot2_f32_bf16 v8, v64, s60, v8
    v_dot2_f32_bf16 v9, v64, v64, v9
    v_dot2_f32_bf16 v10, v65, s60, v10
    v_dot2_f32_bf16 v11, v65, v65, v11
    v_dot2_f32_bf16 v8, v66, s60, v8
    v_dot2_f32_bf16 v9, v66, v66, v9
    v_dot2_f32_bf16 v10, v67, s60, v10
    v_dot2_f32_bf16 v11, v67, v67, v11
    v_dot2_f32_bf16 v8, v68, s60, v8
    v_dot2_f32_bf16 v9, v68, v68, v9
    v_dot2_f32_bf16 v10, v69, s60, v10
    v_dot2_f32_bf16 v11, v69, v69, v11
    v_dot2_f32_bf16 v8, v70, s60, v8
    v_dot2_f32_bf16 v9, v70, v70, v9
    v_dot2_f32_bf16 v10, v71, s60, v10
    v_dot2_f32_bf16 v11, v71, v71, v11
    s_nop 1
    v_add_f32 v8, v8, v10
    v_add_f32 v9, v9, v11
    v_mov_b32 v10, v8
    s_nop 1
    v_permlane32_swap_b32 v8, v10
    v_add_f32 v8, v8, v10
    v_mov_b32 v10, v8
    s_nop 1
    v_permlane16_swap_b32 v8, v10
    v_add_f32 v8, v8, v10
    v_mov_b32 v11, v9
    s_nop 1
    v_permlane32_swap_b32 v9, v11
    v_add_f32 v9, v9, v11
    v_mov_b32 v11, v9
    s_nop 1
    v_permlane16_swap_b32 v9, v11
    v_add_f32 v9, v9, v11
    v_mul_f32 v8, 0x3b124925, v8
    v_mul_f32 v9, 0x3b124925, v9
    v_fma_f32 v9, -v8, v8, v9
    v_max_f32 v9, 0, v9
    v_cvt_pk_bf16_f32 v8, v8, v8
    v_and_b32 v8, 0xffff0000, v8
    v_cvt_pk_bf16_f32 v9, v9, v9
    v_and_b32 v9, 0xffff0000, v9
    v_add_f32 v9, 0x3727c5ac, v9
    v_cvt_pk_bf16_f32 v9, v9, v9
    v_and_b32 v9, 0xffff0000, v9
    v_sqrt_f32 v9, v9
    s_nop 0
    v_cvt_pk_bf16_f32 v9, v9, v9
    v_and_b32 v9, 0xffff0000, v9
    v_rcp_f32 v72, v9
    s_nop 0
    v_mul_f32 v74, v8, v72
    v_sub_f32 v74, 0, v74
    v_lshlrev_b32 v76, 16, v16
    v_and_b32 v77, 0xffff0000, v16
    v_pk_fma_f32 v[76:77], v[76:77], v[72:73], v[74:75] op_sel_hi:[1,0,0]
    v_cvt_pk_bf16_f32 v16, v76, v77
    v_lshlrev_b32 v78, 16, v17
    v_and_b32 v79, 0xffff0000, v17
    v_pk_fma_f32 v[78:79], v[78:79], v[72:73], v[74:75] op_sel_hi:[1,0,0]
    v_cvt_pk_bf16_f32 v17, v78, v79
    v_lshlrev_b32 v80, 16, v18
    v_and_b32 v81, 0xffff0000, v18
    v_pk_fma_f32 v[80:81], v[80:81], v[72:73], v[74:75] op_sel_hi:[1,0,0]
    v_cvt_pk_bf16_f32 v18, v80, v81
    v_lshlrev_b32 v82, 16, v19
    v_and_b32 v83, 0xffff0000, v19
    v_pk_fma_f32 v[82:83], v[82:83], v[72:73], v[74:75] op_sel_hi:[1,0,0]
    v_cvt_pk_bf16_f32 v19, v82, v83
    v_lshlrev_b32 v76, 16, v20
    v_and_b32 v77, 0xffff0000, v20
    v_pk_fma_f32 v[76:77], v[76:77], v[72:73], v[74:75] op_sel_hi:[1,0,0]
    v_cvt_pk_bf16_f32 v20, v76, v77
    v_lshlrev_b32 v78, 16, v21
    v_and_b32 v79, 0xffff0000, v21
    v_pk_fma_f32 v[78:79], v[78:79], v[72:73], v[74:75] op_sel_hi:[1,0,0]
    v_cvt_pk_bf16_f32 v21, v78, v79
    v_lshlrev_b32 v80, 16, v22
    v_and_b32 v81, 0xffff0000, v22
    v_pk_fma_f32 v[80:81], v[80:81], v[72:73], v[74:75] op_sel_hi:[1,0,0]
    v_cvt_pk_bf16_f32 v22, v80, v81
    v_lshlrev_b32 v82, 16, v23
    v_and_b32 v83, 0xffff0000, v23
    v_pk_fma_f32 v[82:83], v[82:83], v[72:73], v[74:75] op_sel_hi:[1,0,0]
    v_cvt_pk_bf16_f32 v23, v82, v83
    v_lshlrev_b32 v76, 16, v24
    v_and_b32 v77, 0xffff0000, v24
    v_pk_fma_f32 v[76:77], v[76:77], v[72:73], v[74:75] op_sel_hi:[1,0,0]
    v_cvt_pk_bf16_f32 v24, v76, v77
    v_lshlrev_b32 v78, 16, v25
    v_and_b32 v79, 0xffff0000, v25
    v_pk_fma_f32 v[78:79], v[78:79], v[72:73], v[74:75] op_sel_hi:[1,0,0]
    v_cvt_pk_bf16_f32 v25, v78, v79
    v_lshlrev_b32 v80, 16, v26
    v_and_b32 v81, 0xffff0000, v26
    v_pk_fma_f32 v[80:81], v[80:81], v[72:73], v[74:75] op_sel_hi:[1,0,0]
    v_cvt_pk_bf16_f32 v26, v80, v81
    v_lshlrev_b32 v82, 16, v27
    v_and_b32 v83, 0xffff0000, v27
    v_pk_fma_f32 v[82:83], v[82:83], v[72:73], v[74:75] op_sel_hi:[1,0,0]
    v_cvt_pk_bf16_f32 v27, v82, v83
    v_lshlrev_b32 v76, 16, v28
    v_and_b32 v77, 0xffff0000, v28
    v_pk_fma_f32 v[76:77], v[76:77], v[72:73], v[74:75] op_sel_hi:[1,0,0]
    v_cvt_pk_bf16_f32 v28, v76, v77
    v_lshlrev_b32 v78, 16, v29
    v_and_b32 v79, 0xffff0000, v29
    v_pk_fma_f32 v[78:79], v[78:79], v[72:73], v[74:75] op_sel_hi:[1,0,0]
    v_cvt_pk_bf16_f32 v29, v78, v79
    v_lshlrev_b32 v80, 16, v30
    v_and_b32 v81, 0xffff0000, v30
    v_pk_fma_f32 v[80:81], v[80:81], v[72:73], v[74:75] op_sel_hi:[1,0,0]
    v_cvt_pk_bf16_f32 v30, v80, v81
    v_lshlrev_b32 v82, 16, v31
    v_and_b32 v83, 0xffff0000, v31
    v_pk_fma_f32 v[82:83], v[82:83], v[72:73], v[74:75] op_sel_hi:[1,0,0]
    v_cvt_pk_bf16_f32 v31, v82, v83
    v_lshlrev_b32 v76, 16, v32
    v_and_b32 v77, 0xffff0000, v32
    v_pk_fma_f32 v[76:77], v[76:77], v[72:73], v[74:75] op_sel_hi:[1,0,0]
    v_cvt_pk_bf16_f32 v32, v76, v77
    v_lshlrev_b32 v78, 16, v33
    v_and_b32 v79, 0xffff0000, v33
    v_pk_fma_f32 v[78:79], v[78:79], v[72:73], v[74:75] op_sel_hi:[1,0,0]
    v_cvt_pk_bf16_f32 v33, v78, v79
    v_lshlrev_b32 v80, 16, v34
    v_and_b32 v81, 0xffff0000, v34
    v_pk_fma_f32 v[80:81], v[80:81], v[72:73], v[74:75] op_sel_hi:[1,0,0]
    v_cvt_pk_bf16_f32 v34, v80, v81
    v_lshlrev_b32 v82, 16, v35
    v_and_b32 v83, 0xffff0000, v35
    v_pk_fma_f32 v[82:83], v[82:83], v[72:73], v[74:75] op_sel_hi:[1,0,0]
    v_cvt_pk_bf16_f32 v35, v82, v83
    v_lshlrev_b32 v76, 16, v36
    v_and_b32 v77, 0xffff0000, v36
    v_pk_fma_f32 v[76:77], v[76:77], v[72:73], v[74:75] op_sel_hi:[1,0,0]
    v_cvt_pk_bf16_f32 v36, v76, v77
    v_lshlrev_b32 v78, 16, v37
    v_and_b32 v79, 0xffff0000, v37
    v_pk_fma_f32 v[78:79], v[78:79], v[72:73], v[74:75] op_sel_hi:[1,0,0]
    v_cvt_pk_bf16_f32 v37, v78, v79
    v_lshlrev_b32 v80, 16, v38
    v_and_b32 v81, 0xffff0000, v38
    v_pk_fma_f32 v[80:81], v[80:81], v[72:73], v[74:75] op_sel_hi:[1,0,0]
    v_cvt_pk_bf16_f32 v38, v80, v81
    v_lshlrev_b32 v82, 16, v39
    v_and_b32 v83, 0xffff0000, v39
    v_pk_fma_f32 v[82:83], v[82:83], v[72:73], v[74:75] op_sel_hi:[1,0,0]
    v_cvt_pk_bf16_f32 v39, v82, v83
    v_lshlrev_b32 v76, 16, v40
    v_and_b32 v77, 0xffff0000, v40
    v_pk_fma_f32 v[76:77], v[76:77], v[72:73], v[74:75] op_sel_hi:[1,0,0]
    v_cvt_pk_bf16_f32 v40, v76, v77
    v_lshlrev_b32 v78, 16, v41
    v_and_b32 v79, 0xffff0000, v41
    v_pk_fma_f32 v[78:79], v[78:79], v[72:73], v[74:75] op_sel_hi:[1,0,0]
    v_cvt_pk_bf16_f32 v41, v78, v79
    v_lshlrev_b32 v80, 16, v42
    v_and_b32 v81, 0xffff0000, v42
    v_pk_fma_f32 v[80:81], v[80:81], v[72:73], v[74:75] op_sel_hi:[1,0,0]
    v_cvt_pk_bf16_f32 v42, v80, v81
    v_lshlrev_b32 v82, 16, v43
    v_and_b32 v83, 0xffff0000, v43
    v_pk_fma_f32 v[82:83], v[82:83], v[72:73], v[74:75] op_sel_hi:[1,0,0]
    v_cvt_pk_bf16_f32 v43, v82, v83
    v_lshlrev_b32 v76, 16, v44
    v_and_b32 v77, 0xffff0000, v44
    v_pk_fma_f32 v[76:77], v[76:77], v[72:73], v[74:75] op_sel_hi:[1,0,0]
    v_cvt_pk_bf16_f32 v44, v76, v77
    v_lshlrev_b32 v78, 16, v45
    v_and_b32 v79, 0xffff0000, v45
    v_pk_fma_f32 v[78:79], v[78:79], v[72:73], v[74:75] op_sel_hi:[1,0,0]
    v_cvt_pk_bf16_f32 v45, v78, v79
    v_lshlrev_b32 v80, 16, v46
    v_and_b32 v81, 0xffff0000, v46
    v_pk_fma_f32 v[80:81], v[80:81], v[72:73], v[74:75] op_sel_hi:[1,0,0]
    v_cvt_pk_bf16_f32 v46, v80, v81
    v_lshlrev_b32 v82, 16, v47
    v_and_b32 v83, 0xffff0000, v47
    v_pk_fma_f32 v[82:83], v[82:83], v[72:73], v[74:75] op_sel_hi:[1,0,0]
    v_cvt_pk_bf16_f32 v47, v82, v83
    v_lshlrev_b32 v76, 16, v48
    v_and_b32 v77, 0xffff0000, v48
    v_pk_fma_f32 v[76:77], v[76:77], v[72:73], v[74:75] op_sel_hi:[1,0,0]
    v_cvt_pk_bf16_f32 v48, v76, v77
    v_lshlrev_b32 v78, 16, v49
    v_and_b32 v79, 0xffff0000, v49
    v_pk_fma_f32 v[78:79], v[78:79], v[72:73], v[74:75] op_sel_hi:[1,0,0]
    v_cvt_pk_bf16_f32 v49, v78, v79
    v_lshlrev_b32 v80, 16, v50
    v_and_b32 v81, 0xffff0000, v50
    v_pk_fma_f32 v[80:81], v[80:81], v[72:73], v[74:75] op_sel_hi:[1,0,0]
    v_cvt_pk_bf16_f32 v50, v80, v81
    v_lshlrev_b32 v82, 16, v51
    v_and_b32 v83, 0xffff0000, v51
    v_pk_fma_f32 v[82:83], v[82:83], v[72:73], v[74:75] op_sel_hi:[1,0,0]
    v_cvt_pk_bf16_f32 v51, v82, v83
    v_lshlrev_b32 v76, 16, v52
    v_and_b32 v77, 0xffff0000, v52
    v_pk_fma_f32 v[76:77], v[76:77], v[72:73], v[74:75] op_sel_hi:[1,0,0]
    v_cvt_pk_bf16_f32 v52, v76, v77
    v_lshlrev_b32 v78, 16, v53
    v_and_b32 v79, 0xffff0000, v53
    v_pk_fma_f32 v[78:79], v[78:79], v[72:73], v[74:75] op_sel_hi:[1,0,0]
    v_cvt_pk_bf16_f32 v53, v78, v79
    v_lshlrev_b32 v80, 16, v54
    v_and_b32 v81, 0xffff0000, v54
    v_pk_fma_f32 v[80:81], v[80:81], v[72:73], v[74:75] op_sel_hi:[1,0,0]
    v_cvt_pk_bf16_f32 v54, v80, v81
    v_lshlrev_b32 v82, 16, v55
    v_and_b32 v83, 0xffff0000, v55
    v_pk_fma_f32 v[82:83], v[82:83], v[72:73], v[74:75] op_sel_hi:[1,0,0]
    v_cvt_pk_bf16_f32 v55, v82, v83
    v_lshlrev_b32 v76, 16, v56
    v_and_b32 v77, 0xffff0000, v56
    v_pk_fma_f32 v[76:77], v[76:77], v[72:73], v[74:75] op_sel_hi:[1,0,0]
    v_cvt_pk_bf16_f32 v56, v76, v77
    v_lshlrev_b32 v78, 16, v57
    v_and_b32 v79, 0xffff0000, v57
    v_pk_fma_f32 v[78:79], v[78:79], v[72:73], v[74:75] op_sel_hi:[1,0,0]
    v_cvt_pk_bf16_f32 v57, v78, v79
    v_lshlrev_b32 v80, 16, v58
    v_and_b32 v81, 0xffff0000, v58
    v_pk_fma_f32 v[80:81], v[80:81], v[72:73], v[74:75] op_sel_hi:[1,0,0]
    v_cvt_pk_bf16_f32 v58, v80, v81
    v_lshlrev_b32 v82, 16, v59
    v_and_b32 v83, 0xffff0000, v59
    v_pk_fma_f32 v[82:83], v[82:83], v[72:73], v[74:75] op_sel_hi:[1,0,0]
    v_cvt_pk_bf16_f32 v59, v82, v83
    v_lshlrev_b32 v76, 16, v60
    v_and_b32 v77, 0xffff0000, v60
    v_pk_fma_f32 v[76:77], v[76:77], v[72:73], v[74:75] op_sel_hi:[1,0,0]
    v_cvt_pk_bf16_f32 v60, v76, v77
    v_lshlrev_b32 v78, 16, v61
    v_and_b32 v79, 0xffff0000, v61
    v_pk_fma_f32 v[78:79], v[78:79], v[72:73], v[74:75] op_sel_hi:[1,0,0]
    v_cvt_pk_bf16_f32 v61, v78, v79
    v_lshlrev_b32 v80, 16, v62
    v_and_b32 v81, 0xffff0000, v62
    v_pk_fma_f32 v[80:81], v[80:81], v[72:73], v[74:75] op_sel_hi:[1,0,0]
    v_cvt_pk_bf16_f32 v62, v80, v81
    v_lshlrev_b32 v82, 16, v63
    v_and_b32 v83, 0xffff0000, v63
    v_pk_fma_f32 v[82:83], v[82:83], v[72:73], v[74:75] op_sel_hi:[1,0,0]
    v_cvt_pk_bf16_f32 v63, v82, v83
    v_lshlrev_b32 v76, 16, v64
    v_and_b32 v77, 0xffff0000, v64
    v_pk_fma_f32 v[76:77], v[76:77], v[72:73], v[74:75] op_sel_hi:[1,0,0]
    v_cvt_pk_bf16_f32 v64, v76, v77
    v_lshlrev_b32 v78, 16, v65
    v_and_b32 v79, 0xffff0000, v65
    v_pk_fma_f32 v[78:79], v[78:79], v[72:73], v[74:75] op_sel_hi:[1,0,0]
    v_cvt_pk_bf16_f32 v65, v78, v79
    v_lshlrev_b32 v80, 16, v66
    v_and_b32 v81, 0xffff0000, v66
    v_pk_fma_f32 v[80:81], v[80:81], v[72:73], v[74:75] op_sel_hi:[1,0,0]
    v_cvt_pk_bf16_f32 v66, v80, v81
    v_lshlrev_b32 v82, 16, v67
    v_and_b32 v83, 0xffff0000, v67
    v_pk_fma_f32 v[82:83], v[82:83], v[72:73], v[74:75] op_sel_hi:[1,0,0]
    v_cvt_pk_bf16_f32 v67, v82, v83
    v_lshlrev_b32 v76, 16, v68
    v_and_b32 v77, 0xffff0000, v68
    v_pk_fma_f32 v[76:77], v[76:77], v[72:73], v[74:75] op_sel_hi:[1,0,0]
    v_cvt_pk_bf16_f32 v68, v76, v77
    v_lshlrev_b32 v78, 16, v69
    v_and_b32 v79, 0xffff0000, v69
    v_pk_fma_f32 v[78:79], v[78:79], v[72:73], v[74:75] op_sel_hi:[1,0,0]
    v_cvt_pk_bf16_f32 v69, v78, v79
    v_lshlrev_b32 v80, 16, v70
    v_and_b32 v81, 0xffff0000, v70
    v_pk_fma_f32 v[80:81], v[80:81], v[72:73], v[74:75] op_sel_hi:[1,0,0]
    v_cvt_pk_bf16_f32 v70, v80, v81
    v_lshlrev_b32 v82, 16, v71
    v_and_b32 v83, 0xffff0000, v71
    v_pk_fma_f32 v[82:83], v[82:83], v[72:73], v[74:75] op_sel_hi:[1,0,0]
    v_cvt_pk_bf16_f32 v71, v82, v83
    s_barrier
    v_add_u32 v13, 0x20000, v2
    ds_read_b128 v[84:87], v2 offset:57344
    ds_read_b128 v[88:91], v5 offset:6144
    ds_read_b128 v[92:95], v5 offset:20480
    ds_read_b128 v[96:99], v5 offset:34816
    ds_read_b128 v[100:103], v5 offset:49152
    ds_read_b128 v[104:107], v5 offset:63488
    ds_read_b128 v[108:111], v2 offset:0
    ds_read_b128 v[112:115], v2 offset:14336
    ds_read_b128 v[116:119], v2 offset:58368
    ds_read_b128 v[120:123], v5 offset:7168
    ds_read_b128 v[124:127], v5 offset:21504
    ds_read_b128 v[128:131], v5 offset:35840
    ds_read_b128 v[132:135], v5 offset:50176
    ds_read_b128 v[136:139], v5 offset:64512
    ds_read_b128 v[140:143], v2 offset:1024
    ds_read_b128 v[144:147], v2 offset:15360
    s_waitcnt lgkmcnt(8)
    v_mfma_f32_16x16x32_bf16 v[148:151], v[84:87], v[16:19], 0
    v_mfma_f32_16x16x32_bf16 v[152:155], v[88:91], v[16:19], 0
    v_mfma_f32_16x16x32_bf16 v[156:159], v[92:95], v[16:19], 0
    v_mfma_f32_16x16x32_bf16 v[160:163], v[96:99], v[16:19], 0
    v_mfma_f32_16x16x32_bf16 v[164:167], v[100:103], v[16:19], 0
    v_mfma_f32_16x16x32_bf16 v[168:171], v[104:107], v[16:19], 0
    v_mfma_f32_16x16x32_bf16 v[172:175], v[108:111], v[16:19], 0
    v_mfma_f32_16x16x32_bf16 v[176:179], v[112:115], v[16:19], 0
    ds_read_b128 v[84:87], v2 offset:59392
    ds_read_b128 v[88:91], v5 offset:8192
    ds_read_b128 v[92:95], v5 offset:22528
    ds_read_b128 v[96:99], v5 offset:36864
    ds_read_b128 v[100:103], v5 offset:51200
    ds_read_b128 v[104:107], v13 offset:0
    ds_read_b128 v[108:111], v2 offset:2048
    ds_read_b128 v[112:115], v2 offset:16384
    s_waitcnt lgkmcnt(8)
    v_mfma_f32_16x16x32_bf16 v[148:151], v[116:119], v[20:23], v[148:151]
    v_mfma_f32_16x16x32_bf16 v[152:155], v[120:123], v[20:23], v[152:155]
    v_mfma_f32_16x16x32_bf16 v[156:159], v[124:127], v[20:23], v[156:159]
    v_mfma_f32_16x16x32_bf16 v[160:163], v[128:131], v[20:23], v[160:163]
    v_mfma_f32_16x16x32_bf16 v[164:167], v[132:135], v[20:23], v[164:167]
    v_mfma_f32_16x16x32_bf16 v[168:171], v[136:139], v[20:23], v[168:171]
    v_mfma_f32_16x16x32_bf16 v[172:175], v[140:143], v[20:23], v[172:175]
    v_mfma_f32_16x16x32_bf16 v[176:179], v[144:147], v[20:23], v[176:179]
    ds_read_b128 v[116:119], v2 offset:60416
    ds_read_b128 v[120:123], v5 offset:9216
    ds_read_b128 v[124:127], v5 offset:23552
    ds_read_b128 v[128:131], v5 offset:37888
    ds_read_b128 v[132:135], v5 offset:52224
    ds_read_b128 v[136:139], v13 offset:1024
    ds_read_b128 v[140:143], v2 offset:3072
    ds_read_b128 v[144:147], v2 offset:17408
    s_waitcnt lgkmcnt(8)
    v_mfma_f32_16x16x32_bf16 v[148:151], v[84:87], v[24:27], v[148:151]
    v_mfma_f32_16x16x32_bf16 v[152:155], v[88:91], v[24:27], v[152:155]
    v_mfma_f32_16x16x32_bf16 v[156:159], v[92:95], v[24:27], v[156:159]
    v_mfma_f32_16x16x32_bf16 v[160:163], v[96:99], v[24:27], v[160:163]
    v_mfma_f32_16x16x32_bf16 v[164:167], v[100:103], v[24:27], v[164:167]
    v_mfma_f32_16x16x32_bf16 v[168:171], v[104:107], v[24:27], v[168:171]
    v_mfma_f32_16x16x32_bf16 v[172:175], v[108:111], v[24:27], v[172:175]
    v_mfma_f32_16x16x32_bf16 v[176:179], v[112:115], v[24:27], v[176:179]
    ds_read_b128 v[84:87], v2 offset:61440
    ds_read_b128 v[88:91], v5 offset:10240
    ds_read_b128 v[92:95], v5 offset:24576
    ds_read_b128 v[96:99], v5 offset:38912
    ds_read_b128 v[100:103], v5 offset:53248
    ds_read_b128 v[104:107], v13 offset:2048
    ds_read_b128 v[108:111], v2 offset:4096
    ds_read_b128 v[112:115], v2 offset:18432
    s_waitcnt lgkmcnt(8)
    v_mfma_f32_16x16x32_bf16 v[148:151], v[116:119], v[28:31], v[148:151]
    v_mfma_f32_16x16x32_bf16 v[152:155], v[120:123], v[28:31], v[152:155]
    v_mfma_f32_16x16x32_bf16 v[156:159], v[124:127], v[28:31], v[156:159]
    v_mfma_f32_16x16x32_bf16 v[160:163], v[128:131], v[28:31], v[160:163]
    v_mfma_f32_16x16x32_bf16 v[164:167], v[132:135], v[28:31], v[164:167]
    v_mfma_f32_16x16x32_bf16 v[168:171], v[136:139], v[28:31], v[168:171]
    v_mfma_f32_16x16x32_bf16 v[172:175], v[140:143], v[28:31], v[172:175]
    v_mfma_f32_16x16x32_bf16 v[176:179], v[144:147], v[28:31], v[176:179]
    ds_read_b128 v[116:119], v2 offset:62464
    ds_read_b128 v[120:123], v5 offset:11264
    ds_read_b128 v[124:127], v5 offset:25600
    ds_read_b128 v[128:131], v5 offset:39936
    ds_read_b128 v[132:135], v5 offset:54272
    ds_read_b128 v[136:139], v13 offset:3072
    ds_read_b128 v[140:143], v2 offset:5120
    ds_read_b128 v[144:147], v2 offset:19456
    s_waitcnt lgkmcnt(8)
    v_mfma_f32_16x16x32_bf16 v[148:151], v[84:87], v[32:35], v[148:151]
    v_mfma_f32_16x16x32_bf16 v[152:155], v[88:91], v[32:35], v[152:155]
    v_mfma_f32_16x16x32_bf16 v[156:159], v[92:95], v[32:35], v[156:159]
    v_mfma_f32_16x16x32_bf16 v[160:163], v[96:99], v[32:35], v[160:163]
    v_mfma_f32_16x16x32_bf16 v[164:167], v[100:103], v[32:35], v[164:167]
    v_mfma_f32_16x16x32_bf16 v[168:171], v[104:107], v[32:35], v[168:171]
    v_mfma_f32_16x16x32_bf16 v[172:175], v[108:111], v[32:35], v[172:175]
    v_mfma_f32_16x16x32_bf16 v[176:179], v[112:115], v[32:35], v[176:179]
    ds_read_b128 v[84:87], v2 offset:63488
    ds_read_b128 v[88:91], v5 offset:12288
    ds_read_b128 v[92:95], v5 offset:26624
    ds_read_b128 v[96:99], v5 offset:40960
    ds_read_b128 v[100:103], v5 offset:55296
    ds_read_b128 v[104:107], v13 offset:4096
    ds_read_b128 v[108:111], v2 offset:6144
    ds_read_b128 v[112:115], v2 offset:20480
    s_waitcnt lgkmcnt(8)
    v_mfma_f32_16x16x32_bf16 v[148:151], v[116:119], v[36:39], v[148:151]
    v_mfma_f32_16x16x32_bf16 v[152:155], v[120:123], v[36:39], v[152:155]
    v_mfma_f32_16x16x32_bf16 v[156:159], v[124:127], v[36:39], v[156:159]
    v_mfma_f32_16x16x32_bf16 v[160:163], v[128:131], v[36:39], v[160:163]
    v_mfma_f32_16x16x32_bf16 v[164:167], v[132:135], v[36:39], v[164:167]
    v_mfma_f32_16x16x32_bf16 v[168:171], v[136:139], v[36:39], v[168:171]
    v_mfma_f32_16x16x32_bf16 v[172:175], v[140:143], v[36:39], v[172:175]
    v_mfma_f32_16x16x32_bf16 v[176:179], v[144:147], v[36:39], v[176:179]
    ds_read_b128 v[116:119], v2 offset:64512
    ds_read_b128 v[120:123], v5 offset:13312
    ds_read_b128 v[124:127], v5 offset:27648
    ds_read_b128 v[128:131], v5 offset:41984
    ds_read_b128 v[132:135], v5 offset:56320
    ds_read_b128 v[136:139], v13 offset:5120
    ds_read_b128 v[140:143], v2 offset:7168
    ds_read_b128 v[144:147], v2 offset:21504
    s_waitcnt lgkmcnt(8)
    v_mfma_f32_16x16x32_bf16 v[148:151], v[84:87], v[40:43], v[148:151]
    v_mfma_f32_16x16x32_bf16 v[152:155], v[88:91], v[40:43], v[152:155]
    v_mfma_f32_16x16x32_bf16 v[156:159], v[92:95], v[40:43], v[156:159]
    v_mfma_f32_16x16x32_bf16 v[160:163], v[96:99], v[40:43], v[160:163]
    v_mfma_f32_16x16x32_bf16 v[164:167], v[100:103], v[40:43], v[164:167]
    v_mfma_f32_16x16x32_bf16 v[168:171], v[104:107], v[40:43], v[168:171]
    v_mfma_f32_16x16x32_bf16 v[172:175], v[108:111], v[40:43], v[172:175]
    v_mfma_f32_16x16x32_bf16 v[176:179], v[112:115], v[40:43], v[176:179]
    ds_read_b128 v[84:87], v5 offset:0
    ds_read_b128 v[88:91], v5 offset:14336
    ds_read_b128 v[92:95], v5 offset:28672
    ds_read_b128 v[96:99], v5 offset:43008
    ds_read_b128 v[100:103], v5 offset:57344
    ds_read_b128 v[104:107], v13 offset:6144
    ds_read_b128 v[108:111], v2 offset:8192
    ds_read_b128 v[112:115], v2 offset:22528
    s_waitcnt lgkmcnt(8)
    v_mfma_f32_16x16x32_bf16 v[148:151], v[116:119], v[44:47], v[148:151]
    v_mfma_f32_16x16x32_bf16 v[152:155], v[120:123], v[44:47], v[152:155]
    v_mfma_f32_16x16x32_bf16 v[156:159], v[124:127], v[44:47], v[156:159]
    v_mfma_f32_16x16x32_bf16 v[160:163], v[128:131], v[44:47], v[160:163]
    v_mfma_f32_16x16x32_bf16 v[164:167], v[132:135], v[44:47], v[164:167]
    v_mfma_f32_16x16x32_bf16 v[168:171], v[136:139], v[44:47], v[168:171]
    v_mfma_f32_16x16x32_bf16 v[172:175], v[140:143], v[44:47], v[172:175]
    v_mfma_f32_16x16x32_bf16 v[176:179], v[144:147], v[44:47], v[176:179]
    ds_read_b128 v[116:119], v5 offset:1024
    ds_read_b128 v[120:123], v5 offset:15360
    ds_read_b128 v[124:127], v5 offset:29696
    ds_read_b128 v[128:131], v5 offset:44032
    ds_read_b128 v[132:135], v5 offset:58368
    ds_read_b128 v[136:139], v13 offset:7168
    ds_read_b128 v[140:143], v2 offset:9216
    ds_read_b128 v[144:147], v2 offset:23552
    s_waitcnt lgkmcnt(8)
    v_mfma_f32_16x16x32_bf16 v[148:151], v[84:87], v[48:51], v[148:151]
    v_mfma_f32_16x16x32_bf16 v[152:155], v[88:91], v[48:51], v[152:155]
    v_mfma_f32_16x16x32_bf16 v[156:159], v[92:95], v[48:51], v[156:159]
    v_mfma_f32_16x16x32_bf16 v[160:163], v[96:99], v[48:51], v[160:163]
    v_mfma_f32_16x16x32_bf16 v[164:167], v[100:103], v[48:51], v[164:167]
    v_mfma_f32_16x16x32_bf16 v[168:171], v[104:107], v[48:51], v[168:171]
    v_mfma_f32_16x16x32_bf16 v[172:175], v[108:111], v[48:51], v[172:175]
    v_mfma_f32_16x16x32_bf16 v[176:179], v[112:115], v[48:51], v[176:179]
    ds_read_b128 v[84:87], v5 offset:2048
    ds_read_b128 v[88:91], v5 offset:16384
    ds_read_b128 v[92:95], v5 offset:30720
    ds_read_b128 v[96:99], v5 offset:45056
    ds_read_b128 v[100:103], v5 offset:59392
    ds_read_b128 v[104:107], v13 offset:8192
    ds_read_b128 v[108:111], v2 offset:10240
    ds_read_b128 v[112:115], v2 offset:24576
    s_waitcnt lgkmcnt(8)
    v_mfma_f32_16x16x32_bf16 v[148:151], v[116:119], v[52:55], v[148:151]
    v_mfma_f32_16x16x32_bf16 v[152:155], v[120:123], v[52:55], v[152:155]
    v_mfma_f32_16x16x32_bf16 v[156:159], v[124:127], v[52:55], v[156:159]
    v_mfma_f32_16x16x32_bf16 v[160:163], v[128:131], v[52:55], v[160:163]
    v_mfma_f32_16x16x32_bf16 v[164:167], v[132:135], v[52:55], v[164:167]
    v_mfma_f32_16x16x32_bf16 v[168:171], v[136:139], v[52:55], v[168:171]
    v_mfma_f32_16x16x32_bf16 v[172:175], v[140:143], v[52:55], v[172:175]
    v_mfma_f32_16x16x32_bf16 v[176:179], v[144:147], v[52:55], v[176:179]
    ds_read_b128 v[116:119], v5 offset:3072
    ds_read_b128 v[120:123], v5 offset:17408
    ds_read_b128 v[124:127], v5 offset:31744
    ds_read_b128 v[128:131], v5 offset:46080
    ds_read_b128 v[132:135], v5 offset:60416
    ds_read_b128 v[136:139], v13 offset:9216
    ds_read_b128 v[140:143], v2 offset:11264
    ds_read_b128 v[144:147], v2 offset:25600
    s_waitcnt lgkmcnt(8)
    v_mfma_f32_16x16x32_bf16 v[148:151], v[84:87], v[56:59], v[148:151]
    v_mfma_f32_16x16x32_bf16 v[152:155], v[88:91], v[56:59], v[152:155]
    v_mfma_f32_16x16x32_bf16 v[156:159], v[92:95], v[56:59], v[156:159]
    v_mfma_f32_16x16x32_bf16 v[160:163], v[96:99], v[56:59], v[160:163]
    v_mfma_f32_16x16x32_bf16 v[164:167], v[100:103], v[56:59], v[164:167]
    v_mfma_f32_16x16x32_bf16 v[168:171], v[104:107], v[56:59], v[168:171]
    v_mfma_f32_16x16x32_bf16 v[172:175], v[108:111], v[56:59], v[172:175]
    v_mfma_f32_16x16x32_bf16 v[176:179], v[112:115], v[56:59], v[176:179]
    ds_read_b128 v[84:87], v5 offset:4096
    ds_read_b128 v[88:91], v5 offset:18432
    ds_read_b128 v[92:95], v5 offset:32768
    ds_read_b128 v[96:99], v5 offset:47104
    ds_read_b128 v[100:103], v5 offset:61440
    ds_read_b128 v[104:107], v13 offset:10240
    ds_read_b128 v[108:111], v2 offset:12288
    ds_read_b128 v[112:115], v2 offset:26624
    s_waitcnt lgkmcnt(8)
    v_mfma_f32_16x16x32_bf16 v[148:151], v[116:119], v[60:63], v[148:151]
    v_mfma_f32_16x16x32_bf16 v[152:155], v[120:123], v[60:63], v[152:155]
    v_mfma_f32_16x16x32_bf16 v[156:159], v[124:127], v[60:63], v[156:159]
    v_mfma_f32_16x16x32_bf16 v[160:163], v[128:131], v[60:63], v[160:163]
    v_mfma_f32_16x16x32_bf16 v[164:167], v[132:135], v[60:63], v[164:167]
    v_mfma_f32_16x16x32_bf16 v[168:171], v[136:139], v[60:63], v[168:171]
    v_mfma_f32_16x16x32_bf16 v[172:175], v[140:143], v[60:63], v[172:175]
    v_mfma_f32_16x16x32_bf16 v[176:179], v[144:147], v[60:63], v[176:179]
    ds_read_b128 v[116:119], v5 offset:5120
    ds_read_b128 v[120:123], v5 offset:19456
    ds_read_b128 v[124:127], v5 offset:33792
    ds_read_b128 v[128:131], v5 offset:48128
    ds_read_b128 v[132:135], v5 offset:62464
    ds_read_b128 v[136:139], v13 offset:11264
    ds_read_b128 v[140:143], v2 offset:13312
    ds_read_b128 v[144:147], v2 offset:27648
    s_waitcnt lgkmcnt(8)
    v_mfma_f32_16x16x32_bf16 v[148:151], v[84:87], v[64:67], v[148:151]
    v_mfma_f32_16x16x32_bf16 v[152:155], v[88:91], v[64:67], v[152:155]
    v_mfma_f32_16x16x32_bf16 v[156:159], v[92:95], v[64:67], v[156:159]
    v_mfma_f32_16x16x32_bf16 v[160:163], v[96:99], v[64:67], v[160:163]
    v_mfma_f32_16x16x32_bf16 v[164:167], v[100:103], v[64:67], v[164:167]
    v_mfma_f32_16x16x32_bf16 v[168:171], v[104:107], v[64:67], v[168:171]
    v_mfma_f32_16x16x32_bf16 v[172:175], v[108:111], v[64:67], v[172:175]
    v_mfma_f32_16x16x32_bf16 v[176:179], v[112:115], v[64:67], v[176:179]
    s_waitcnt lgkmcnt(0)
    v_mfma_f32_16x16x32_bf16 v[148:151], v[116:119], v[68:71], v[148:151]
    v_mfma_f32_16x16x32_bf16 v[152:155], v[120:123], v[68:71], v[152:155]
    v_mfma_f32_16x16x32_bf16 v[156:159], v[124:127], v[68:71], v[156:159]
    v_mfma_f32_16x16x32_bf16 v[160:163], v[128:131], v[68:71], v[160:163]
    v_mfma_f32_16x16x32_bf16 v[164:167], v[132:135], v[68:71], v[164:167]
    v_mfma_f32_16x16x32_bf16 v[168:171], v[136:139], v[68:71], v[168:171]
    v_mfma_f32_16x16x32_bf16 v[172:175], v[140:143], v[68:71], v[172:175]
    v_mfma_f32_16x16x32_bf16 v[176:179], v[144:147], v[68:71], v[176:179]
    s_nop 0
    v_cvt_pk_bf16_f32 v149, v148, v149
    v_lshlrev_b32 v148, 16, v149
    v_and_b32 v149, 0xffff0000, v149
    v_cvt_pk_bf16_f32 v151, v150, v151
    v_lshlrev_b32 v150, 16, v151
    v_and_b32 v151, 0xffff0000, v151
    v_cvt_pk_bf16_f32 v153, v152, v153
    v_lshlrev_b32 v152, 16, v153
    v_and_b32 v153, 0xffff0000, v153
    v_cvt_pk_bf16_f32 v155, v154, v155
    v_lshlrev_b32 v154, 16, v155
    v_and_b32 v155, 0xffff0000, v155
    v_cvt_pk_bf16_f32 v157, v156, v157
    v_lshlrev_b32 v156, 16, v157
    v_and_b32 v157, 0xffff0000, v157
    v_cvt_pk_bf16_f32 v159, v158, v159
    v_lshlrev_b32 v158, 16, v159
    v_and_b32 v159, 0xffff0000, v159
    v_cvt_pk_bf16_f32 v161, v160, v161
    v_lshlrev_b32 v160, 16, v161
    v_and_b32 v161, 0xffff0000, v161
    v_cvt_pk_bf16_f32 v163, v162, v163
    v_lshlrev_b32 v162, 16, v163
    v_and_b32 v163, 0xffff0000, v163
    v_cvt_pk_bf16_f32 v165, v164, v165
    v_lshlrev_b32 v164, 16, v165
    v_and_b32 v165, 0xffff0000, v165
    v_cvt_pk_bf16_f32 v167, v166, v167
    v_lshlrev_b32 v166, 16, v167
    v_and_b32 v167, 0xffff0000, v167
    v_cvt_pk_bf16_f32 v169, v168, v169
    v_lshlrev_b32 v168, 16, v169
    v_and_b32 v169, 0xffff0000, v169
    v_cvt_pk_bf16_f32 v171, v170, v171
    v_lshlrev_b32 v170, 16, v171
    v_and_b32 v171, 0xffff0000, v171
    v_cvt_pk_bf16_f32 v173, v172, v173
    v_lshlrev_b32 v172, 16, v173
    v_and_b32 v173, 0xffff0000, v173
    v_cvt_pk_bf16_f32 v175, v174, v175
    v_lshlrev_b32 v174, 16, v175
    v_and_b32 v175, 0xffff0000, v175
    v_cvt_pk_bf16_f32 v177, v176, v177
    v_lshlrev_b32 v176, 16, v177
    v_and_b32 v177, 0xffff0000, v177
    v_cvt_pk_bf16_f32 v179, v178, v179
    v_lshlrev_b32 v178, 16, v179
    v_and_b32 v179, 0xffff0000, v179
    v_mul_f32 v32, v148, v148
    v_mul_f32 v33, v149, v149
    v_mul_f32 v34, v150, v150
    v_mul_f32 v35, v151, v151
    v_fma_f32 v32, v32, s90, 1.0
    v_fma_f32 v33, v33, s90, 1.0
    v_fma_f32 v34, v34, s90, 1.0
    v_fma_f32 v35, v35, s90, 1.0
    v_mul_f32 v32, v32, v148
    v_mul_f32 v33, v33, v149
    v_mul_f32 v34, v34, v150
    v_mul_f32 v35, v35, v151
    v_mul_f32 v32, s91, v32
    v_mul_f32 v33, s91, v33
    v_mul_f32 v34, s91, v34
    v_mul_f32 v35, s91, v35
    v_exp_f32 v32, v32
    v_exp_f32 v33, v33
    v_exp_f32 v34, v34
    v_exp_f32 v35, v35
    v_add_f32 v32, 1.0, v32
    v_add_f32 v33, 1.0, v33
    v_add_f32 v34, 1.0, v34
    v_add_f32 v35, 1.0, v35
    v_rcp_f32 v32, v32
    v_rcp_f32 v33, v33
    v_rcp_f32 v34, v34
    v_rcp_f32 v35, v35
    v_mul_f32 v148, v148, v32
    v_mul_f32 v149, v149, v33
    v_mul_f32 v150, v150, v34
    v_mul_f32 v151, v151, v35
    v_mul_f32 v32, v152, v152
    v_mul_f32 v33, v153, v153
    v_mul_f32 v34, v154, v154
    v_mul_f32 v35, v155, v155
    v_fma_f32 v32, v32, s90, 1.0
    v_fma_f32 v33, v33, s90, 1.0
    v_fma_f32 v34, v34, s90, 1.0
    v_fma_f32 v35, v35, s90, 1.0
    v_mul_f32 v32, v32, v152
    v_mul_f32 v33, v33, v153
    v_mul_f32 v34, v34, v154
    v_mul_f32 v35, v35, v155
    v_mul_f32 v32, s91, v32
    v_mul_f32 v33, s91, v33
    v_mul_f32 v34, s91, v34
    v_mul_f32 v35, s91, v35
    v_exp_f32 v32, v32
    v_exp_f32 v33, v33
    v_exp_f32 v34, v34
    v_exp_f32 v35, v35
    v_add_f32 v32, 1.0, v32
    v_add_f32 v33, 1.0, v33
    v_add_f32 v34, 1.0, v34
    v_add_f32 v35, 1.0, v35
    v_rcp_f32 v32, v32
    v_rcp_f32 v33, v33
    v_rcp_f32 v34, v34
    v_rcp_f32 v35, v35
    v_mul_f32 v152, v152, v32
    v_mul_f32 v153, v153, v33
    v_mul_f32 v154, v154, v34
    v_mul_f32 v155, v155, v35
    v_mul_f32 v32, v156, v156
    v_mul_f32 v33, v157, v157
    v_mul_f32 v34, v158, v158
    v_mul_f32 v35, v159, v159
    v_fma_f32 v32, v32, s90, 1.0
    v_fma_f32 v33, v33, s90, 1.0
    v_fma_f32 v34, v34, s90, 1.0
    v_fma_f32 v35, v35, s90, 1.0
    v_mul_f32 v32, v32, v156
    v_mul_f32 v33, v33, v157
    v_mul_f32 v34, v34, v158
    v_mul_f32 v35, v35, v159
    v_mul_f32 v32, s91, v32
    v_mul_f32 v33, s91, v33
    v_mul_f32 v34, s91, v34
    v_mul_f32 v35, s91, v35
    v_exp_f32 v32, v32
    v_exp_f32 v33, v33
    v_exp_f32 v34, v34
    v_exp_f32 v35, v35
    v_add_f32 v32, 1.0, v32
    v_add_f32 v33, 1.0, v33
    v_add_f32 v34, 1.0, v34
    v_add_f32 v35, 1.0, v35
    v_rcp_f32 v32, v32
    v_rcp_f32 v33, v33
    v_rcp_f32 v34, v34
    v_rcp_f32 v35, v35
    v_mul_f32 v156, v156, v32
    v_mul_f32 v157, v157, v33
    v_mul_f32 v158, v158, v34
    v_mul_f32 v159, v159, v35
    v_mul_f32 v32, v160, v160
    v_mul_f32 v33, v161, v161
    v_mul_f32 v34, v162, v162
    v_mul_f32 v35, v163, v163
    v_fma_f32 v32, v32, s90, 1.0
    v_fma_f32 v33, v33, s90, 1.0
    v_fma_f32 v34, v34, s90, 1.0
    v_fma_f32 v35, v35, s90, 1.0
    v_mul_f32 v32, v32, v160
    v_mul_f32 v33, v33, v161
    v_mul_f32 v34, v34, v162
    v_mul_f32 v35, v35, v163
    v_mul_f32 v32, s91, v32
    v_mul_f32 v33, s91, v33
    v_mul_f32 v34, s91, v34
    v_mul_f32 v35, s91, v35
    v_exp_f32 v32, v32
    v_exp_f32 v33, v33
    v_exp_f32 v34, v34
    v_exp_f32 v35, v35
    v_add_f32 v32, 1.0, v32
    v_add_f32 v33, 1.0, v33
    v_add_f32 v34, 1.0, v34
    v_add_f32 v35, 1.0, v35
    v_rcp_f32 v32, v32
    v_rcp_f32 v33, v33
    v_rcp_f32 v34, v34
    v_rcp_f32 v35, v35
    v_mul_f32 v160, v160, v32
    v_mul_f32 v161, v161, v33
    v_mul_f32 v162, v162, v34
    v_mul_f32 v163, v163, v35
    v_mul_f32 v32, v164, v164
    v_mul_f32 v33, v165, v165
    v_mul_f32 v34, v166, v166
    v_mul_f32 v35, v167, v167
    v_fma_f32 v32, v32, s90, 1.0
    v_fma_f32 v33, v33, s90, 1.0
    v_fma_f32 v34, v34, s90, 1.0
    v_fma_f32 v35, v35, s90, 1.0
    v_mul_f32 v32, v32, v164
    v_mul_f32 v33, v33, v165
    v_mul_f32 v34, v34, v166
    v_mul_f32 v35, v35, v167
    v_mul_f32 v32, s91, v32
    v_mul_f32 v33, s91, v33
    v_mul_f32 v34, s91, v34
    v_mul_f32 v35, s91, v35
    v_exp_f32 v32, v32
    v_exp_f32 v33, v33
    v_exp_f32 v34, v34
    v_exp_f32 v35, v35
    v_add_f32 v32, 1.0, v32
    v_add_f32 v33, 1.0, v33
    v_add_f32 v34, 1.0, v34
    v_add_f32 v35, 1.0, v35
    v_rcp_f32 v32, v32
    v_rcp_f32 v33, v33
    v_rcp_f32 v34, v34
    v_rcp_f32 v35, v35
    v_mul_f32 v164, v164, v32
    v_mul_f32 v165, v165, v33
    v_mul_f32 v166, v166, v34
    v_mul_f32 v167, v167, v35
    v_mul_f32 v32, v168, v168
    v_mul_f32 v33, v169, v169
    v_mul_f32 v34, v170, v170
    v_mul_f32 v35, v171, v171
    v_fma_f32 v32, v32, s90, 1.0
    v_fma_f32 v33, v33, s90, 1.0
    v_fma_f32 v34, v34, s90, 1.0
    v_fma_f32 v35, v35, s90, 1.0
    v_mul_f32 v32, v32, v168
    v_mul_f32 v33, v33, v169
    v_mul_f32 v34, v34, v170
    v_mul_f32 v35, v35, v171
    v_mul_f32 v32, s91, v32
    v_mul_f32 v33, s91, v33
    v_mul_f32 v34, s91, v34
    v_mul_f32 v35, s91, v35
    v_exp_f32 v32, v32
    v_exp_f32 v33, v33
    v_exp_f32 v34, v34
    v_exp_f32 v35, v35
    v_add_f32 v32, 1.0, v32
    v_add_f32 v33, 1.0, v33
    v_add_f32 v34, 1.0, v34
    v_add_f32 v35, 1.0, v35
    v_rcp_f32 v32, v32
    v_rcp_f32 v33, v33
    v_rcp_f32 v34, v34
    v_rcp_f32 v35, v35
    v_mul_f32 v168, v168, v32
    v_mul_f32 v169, v169, v33
    v_mul_f32 v170, v170, v34
    v_mul_f32 v171, v171, v35
    v_mul_f32 v32, v172, v172
    v_mul_f32 v33, v173, v173
    v_mul_f32 v34, v174, v174
    v_mul_f32 v35, v175, v175
    v_fma_f32 v32, v32, s90, 1.0
    v_fma_f32 v33, v33, s90, 1.0
    v_fma_f32 v34, v34, s90, 1.0
    v_fma_f32 v35, v35, s90, 1.0
    v_mul_f32 v32, v32, v172
    v_mul_f32 v33, v33, v173
    v_mul_f32 v34, v34, v174
    v_mul_f32 v35, v35, v175
    v_mul_f32 v32, s91, v32
    v_mul_f32 v33, s91, v33
    v_mul_f32 v34, s91, v34
    v_mul_f32 v35, s91, v35
    v_exp_f32 v32, v32
    v_exp_f32 v33, v33
    v_exp_f32 v34, v34
    v_exp_f32 v35, v35
    v_add_f32 v32, 1.0, v32
    v_add_f32 v33, 1.0, v33
    v_add_f32 v34, 1.0, v34
    v_add_f32 v35, 1.0, v35
    v_rcp_f32 v32, v32
    v_rcp_f32 v33, v33
    v_rcp_f32 v34, v34
    v_rcp_f32 v35, v35
    v_mul_f32 v172, v172, v32
    v_mul_f32 v173, v173, v33
    v_mul_f32 v174, v174, v34
    v_mul_f32 v175, v175, v35
    v_mul_f32 v32, v176, v176
    v_mul_f32 v33, v177, v177
    v_mul_f32 v34, v178, v178
    v_mul_f32 v35, v179, v179
    v_fma_f32 v32, v32, s90, 1.0
    v_fma_f32 v33, v33, s90, 1.0
    v_fma_f32 v34, v34, s90, 1.0
    v_fma_f32 v35, v35, s90, 1.0
    v_mul_f32 v32, v32, v176
    v_mul_f32 v33, v33, v177
    v_mul_f32 v34, v34, v178
    v_mul_f32 v35, v35, v179
    v_mul_f32 v32, s91, v32
    v_mul_f32 v33, s91, v33
    v_mul_f32 v34, s91, v34
    v_mul_f32 v35, s91, v35
    v_exp_f32 v32, v32
    v_exp_f32 v33, v33
    v_exp_f32 v34, v34
    v_exp_f32 v35, v35
    v_add_f32 v32, 1.0, v32
    v_add_f32 v33, 1.0, v33
    v_add_f32 v34, 1.0, v34
    v_add_f32 v35, 1.0, v35
    v_rcp_f32 v32, v32
    v_rcp_f32 v33, v33
    v_rcp_f32 v34, v34
    v_rcp_f32 v35, v35
    v_mul_f32 v176, v176, v32
    v_mul_f32 v177, v177, v33
    v_mul_f32 v178, v178, v34
    v_mul_f32 v179, v179, v35
    v_cvt_pk_bf16_f32 v16, v148, v149
    v_cvt_pk_bf16_f32 v17, v150, v151
    v_cvt_pk_bf16_f32 v18, v152, v153
    v_cvt_pk_bf16_f32 v19, v154, v155
    v_cvt_pk_bf16_f32 v20, v156, v157
    v_cvt_pk_bf16_f32 v21, v158, v159
    v_cvt_pk_bf16_f32 v22, v160, v161
    v_cvt_pk_bf16_f32 v23, v162, v163
    v_cvt_pk_bf16_f32 v24, v164, v165
    v_cvt_pk_bf16_f32 v25, v166, v167
    v_cvt_pk_bf16_f32 v26, v168, v169
    v_cvt_pk_bf16_f32 v27, v170, v171
    v_cvt_pk_bf16_f32 v28, v172, v173
    v_cvt_pk_bf16_f32 v29, v174, v175
    v_cvt_pk_bf16_f32 v30, v176, v177
    v_cvt_pk_bf16_f32 v31, v178, v179
    s_mul_i32 s44, s47, 56
    s_lshl_b32 s45, s83, 2
    s_add_u32 s44, s44, s45
    s_lshl_b32 s44, s44, 10
    buffer_store_dwordx4 v[16:19], v2, s[20:23], s44 offen offset:0
    buffer_store_dwordx4 v[20:23], v2, s[20:23], s44 offen offset:1024
    buffer_store_dwordx4 v[24:27], v2, s[20:23], s44 offen offset:2048
    buffer_store_dwordx4 v[28:31], v2, s[20:23], s44 offen offset:3072
    s_lshl_b32 s40, s82, 4
    s_add_u32 s40, s40, s83
    s_add_u32 s40, s40, 3328
    s_waitcnt vmcnt(0)
    s_barrier
    s_cmp_lg_u32 s3, 0
    s_cbranch_scc1 L_sig_186
    s_add_u32 s28, s94, 7921664
    s_addc_u32 s29, s95, 0
    s_mov_b32 s30, 16384
    s_mov_b32 s31, 0x00020000
    s_lshl_b32 s48, s40, 2
    v_mov_b32 v6, 1
    v_mov_b32 v7, s48
    s_mov_b64 exec, 1
    s_cmp_lg_u32 s80, 0
    s_cbranch_scc1 L_sigfb_187
    buffer_store_dword v6, v7, s[28:31], 0 offen
    s_nop 1
    s_branch L_sigj_188
L_sigfb_187:
    buffer_wbl2 sc1
    s_waitcnt vmcnt(0)
    buffer_store_dword v6, v7, s[28:31], 0 offen sc1
    s_nop 1
L_sigj_188:
    s_mov_b64 exec, -1
L_sig_186:
    s_mul_i32 s44, s85, 229376
    s_add_u32 s12, s94, s44
    s_addc_u32 s13, s95, 0
    s_add_u32 s12, s12, 4218880
    s_addc_u32 s13, s13, 0
    s_mov_b32 s14, 229376
    s_mov_b32 s15, 0x00020000
    s_lshr_b32 s44, s3, 1
    s_and_b32 s45, s3, 1
    s_mul_i32 s46, s44, 56
    s_mul_i32 s47, s45, 28
    s_add_u32 s46, s46, s47
    s_lshl_b32 s46, s46, 10
    s_lshl_b32 s47, s3, 12
    s_add_u32 s44, s46, 0
    s_add_u32 s45, s47, 0
    s_mov_b32 m0, s45
    s_nop 0
    buffer_load_dwordx4 v2, s[12:15], s44 offen offset:0 lds
    buffer_load_dwordx4 v2, s[12:15], s44 offen offset:1024 lds
    buffer_load_dwordx4 v2, s[12:15], s44 offen offset:2048 lds
    buffer_load_dwordx4 v2, s[12:15], s44 offen offset:3072 lds
    s_add_u32 s44, s46, 4096
    s_add_u32 s45, s47, 32768
    s_mov_b32 m0, s45
    s_nop 0
    buffer_load_dwordx4 v2, s[12:15], s44 offen offset:0 lds
    buffer_load_dwordx4 v2, s[12:15], s44 offen offset:1024 lds
    buffer_load_dwordx4 v2, s[12:15], s44 offen offset:2048 lds
    buffer_load_dwordx4 v2, s[12:15], s44 offen offset:3072 lds
    s_add_u32 s44, s46, 8192
    s_add_u32 s45, s47, 65536
    s_mov_b32 m0, s45
    s_nop 0
    buffer_load_dwordx4 v2, s[12:15], s44 offen offset:0 lds
    buffer_load_dwordx4 v2, s[12:15], s44 offen offset:1024 lds
    buffer_load_dwordx4 v2, s[12:15], s44 offen offset:2048 lds
    buffer_load_dwordx4 v2, s[12:15], s44 offen offset:3072 lds
    s_add_u32 s44, s46, 12288
    s_add_u32 s45, s47, 98304
    s_mov_b32 m0, s45
    s_nop 0
    buffer_load_dwordx4 v2, s[12:15], s44 offen offset:0 lds
    buffer_load_dwordx4 v2, s[12:15], s44 offen offset:1024 lds
    buffer_load_dwordx4 v2, s[12:15], s44 offen offset:2048 lds
    buffer_load_dwordx4 v2, s[12:15], s44 offen offset:3072 lds
    s_lshr_b32 s40, s84, 1
    s_lshl_b32 s40, s40, 4
    s_add_u32 s40, s40, 3328
    s_cmp_lg_u32 s3, 0
    s_cbranch_scc1 L_wsk_189
    s_add_u32 s28, s94, 7921664
    s_addc_u32 s29, s95, 0
    s_mov_b32 s30, 16384
    s_mov_b32 s31, 0x00020000
    s_mov_b32 s50, 0
    v_add_u32 v6, s40, v1
    v_cmp_le_u32 s[48:49], 14, v1
    v_lshlrev_b32 v6, 2, v6
    s_nop 0
    v_cndmask_b32 v6, v6, 0, s[48:49]
    s_nop 1
L_wlp_190:
    buffer_load_dword v8, v6, s[28:31], 0 offen sc1
    s_waitcnt vmcnt(0)
    v_cmp_ne_u32 vcc, 0, v8
    s_nop 0
    s_or_b64 vcc, vcc, s[48:49]
    s_cmp_eq_u64 vcc, -1
    s_nop 1
    s_cbranch_scc1 L_wdn_191
    s_sleep 1
    s_add_u32 s50, s50, 1
    s_cmp_lt_u32 s50, 65536
    s_cbranch_scc1 L_wlp_190
L_wdn_191:
    s_cmp_eq_u32 s80, 0
    s_cbranch_scc1 L_wsk_189
    buffer_inv sc1
    s_waitcnt vmcnt(0)
L_wsk_189:
    s_barrier
    s_add_u32 s8, s94, 33628160
    s_addc_u32 s9, s95, 0
    s_mov_b32 s10, 7340032
    s_mov_b32 s11, 0x00020000
    s_add_u32 s16, s94, 24453120
    s_addc_u32 s17, s95, 0
    s_mov_b32 s18, 1835008
    s_mov_b32 s19, 0x00020000
    s_add_u32 s20, s94, 13443072
    s_addc_u32 s21, s95, 0
    s_mov_b32 s22, 1835008
    s_mov_b32 s23, 0x00020000
    s_mov_b32 s24, s98
    s_mov_b32 s25, s99
    s_mov_b32 s26, 1835008
    s_mov_b32 s27, 0x00020000
    s_mul_i32 s44, s85, 229376
    s_add_u32 s12, s94, s44
    s_addc_u32 s13, s95, 0
    s_add_u32 s12, s12, 4218880
    s_addc_u32 s13, s13, 0
    s_mov_b32 s14, 229376
    s_mov_b32 s15, 0x00020000
    s_lshr_b32 s44, s3, 1
    s_and_b32 s45, s3, 1
    s_mul_i32 s46, s44, 56
    s_mul_i32 s47, s45, 28
    s_add_u32 s46, s46, s47
    s_lshl_b32 s46, s46, 10
    s_lshl_b32 s47, s3, 12
    s_lshl_b32 s43, s84, 2
    s_add_u32 s43, s43, s88
    s_mul_i32 s43, s43, 56
    s_mul_i32 s45, s89, 28
    s_add_u32 s43, s43, s45
    s_lshl_b32 s43, s43, 10
    s_add_u32 s44, s43, 0
    buffer_load_dwordx4 v[16:19], v2, s[8:11], s44 offen offset:0
    buffer_load_dwordx4 v[20:23], v2, s[8:11], s44 offen offset:1024
    buffer_load_dwordx4 v[24:27], v2, s[8:11], s44 offen offset:2048
    buffer_load_dwordx4 v[28:31], v2, s[8:11], s44 offen offset:3072
    s_add_u32 s44, s43, 4096
    buffer_load_dwordx4 v[32:35], v2, s[8:11], s44 offen offset:0
    buffer_load_dwordx4 v[36:39], v2, s[8:11], s44 offen offset:1024
    buffer_load_dwordx4 v[40:43], v2, s[8:11], s44 offen offset:2048
    buffer_load_dwordx4 v[44:47], v2, s[8:11], s44 offen offset:3072
    s_lshl_b32 s41, s84, 2
    s_add_u32 s41, s41, s88
    s_mul_i32 s41, s41, 14
    s_lshl_b32 s45, s85, 1
    s_add_u32 s41, s41, s45
    s_add_u32 s41, s41, s89
    s_lshl_b32 s41, s41, 10
    buffer_load_dwordx4 v[176:179], v2, s[16:19], s41 offen
    buffer_load_dwordx4 v[180:183], v2, s[20:23], s41 offen
    s_lshl_b32 s44, s89, 12
    v_add_u32 v8, s44, v2
    v_add_u32 v9, 65536, v8
    s_add_u32 s44, s43, 8192
    buffer_load_dwordx4 v[48:51], v2, s[8:11], s44 offen offset:0
    buffer_load_dwordx4 v[52:55], v2, s[8:11], s44 offen offset:1024
    buffer_load_dwordx4 v[56:59], v2, s[8:11], s44 offen offset:2048
    buffer_load_dwordx4 v[60:63], v2, s[8:11], s44 offen offset:3072
    s_waitcnt vmcnt(10)
    s_barrier
    ds_read_b128 v[144:147], v8 offset:0
    ds_read_b128 v[148:151], v8 offset:8192
    ds_read_b128 v[152:155], v8 offset:16384
    ds_read_b128 v[156:159], v8 offset:24576
    ds_read_b128 v[160:163], v8 offset:1024
    ds_read_b128 v[164:167], v8 offset:9216
    ds_read_b128 v[168:171], v8 offset:17408
    ds_read_b128 v[172:175], v8 offset:25600
    s_waitcnt lgkmcnt(4)
    v_mfma_f32_16x16x32_bf16 v[128:131], v[144:147], v[16:19], 0
    v_mfma_f32_16x16x32_bf16 v[132:135], v[148:151], v[16:19], 0
    v_mfma_f32_16x16x32_bf16 v[136:139], v[152:155], v[16:19], 0
    v_mfma_f32_16x16x32_bf16 v[140:143], v[156:159], v[16:19], 0
    ds_read_b128 v[144:147], v8 offset:2048
    ds_read_b128 v[148:151], v8 offset:10240
    ds_read_b128 v[152:155], v8 offset:18432
    ds_read_b128 v[156:159], v8 offset:26624
    s_waitcnt lgkmcnt(4)
    v_mfma_f32_16x16x32_bf16 v[128:131], v[160:163], v[20:23], v[128:131]
    v_mfma_f32_16x16x32_bf16 v[132:135], v[164:167], v[20:23], v[132:135]
    v_mfma_f32_16x16x32_bf16 v[136:139], v[168:171], v[20:23], v[136:139]
    v_mfma_f32_16x16x32_bf16 v[140:143], v[172:175], v[20:23], v[140:143]
    ds_read_b128 v[160:163], v8 offset:3072
    ds_read_b128 v[164:167], v8 offset:11264
    ds_read_b128 v[168:171], v8 offset:19456
    ds_read_b128 v[172:175], v8 offset:27648
    s_waitcnt lgkmcnt(4)
    v_mfma_f32_16x16x32_bf16 v[128:131], v[144:147], v[24:27], v[128:131]
    v_mfma_f32_16x16x32_bf16 v[132:135], v[148:151], v[24:27], v[132:135]
    v_mfma_f32_16x16x32_bf16 v[136:139], v[152:155], v[24:27], v[136:139]
    v_mfma_f32_16x16x32_bf16 v[140:143], v[156:159], v[24:27], v[140:143]
    s_waitcnt lgkmcnt(0)
    v_mfma_f32_16x16x32_bf16 v[128:131], v[160:163], v[28:31], v[128:131]
    v_mfma_f32_16x16x32_bf16 v[132:135], v[164:167], v[28:31], v[132:135]
    v_mfma_f32_16x16x32_bf16 v[136:139], v[168:171], v[28:31], v[136:139]
    v_mfma_f32_16x16x32_bf16 v[140:143], v[172:175], v[28:31], v[140:143]
    s_add_u32 s44, s43, 12288
    buffer_load_dwordx4 v[64:67], v2, s[8:11], s44 offen offset:0
    buffer_load_dwordx4 v[68:71], v2, s[8:11], s44 offen offset:1024
    buffer_load_dwordx4 v[72:75], v2, s[8:11], s44 offen offset:2048
    buffer_load_dwordx4 v[76:79], v2, s[8:11], s44 offen offset:3072
    s_waitcnt vmcnt(10)
    s_barrier
    s_add_u32 s44, s46, 16384
    s_add_u32 s45, s47, 0
    s_mov_b32 m0, s45
    s_nop 0
    buffer_load_dwordx4 v2, s[12:15], s44 offen offset:0 lds
    buffer_load_dwordx4 v2, s[12:15], s44 offen offset:1024 lds
    buffer_load_dwordx4 v2, s[12:15], s44 offen offset:2048 lds
    buffer_load_dwordx4 v2, s[12:15], s44 offen offset:3072 lds
    ds_read_b128 v[144:147], v8 offset:32768
    ds_read_b128 v[148:151], v8 offset:40960
    ds_read_b128 v[152:155], v8 offset:49152
    ds_read_b128 v[156:159], v8 offset:57344
    ds_read_b128 v[160:163], v8 offset:33792
    ds_read_b128 v[164:167], v8 offset:41984
    ds_read_b128 v[168:171], v8 offset:50176
    ds_read_b128 v[172:175], v8 offset:58368
    s_waitcnt lgkmcnt(4)
    v_mfma_f32_16x16x32_bf16 v[128:131], v[144:147], v[32:35], v[128:131]
    v_mfma_f32_16x16x32_bf16 v[132:135], v[148:151], v[32:35], v[132:135]
    v_mfma_f32_16x16x32_bf16 v[136:139], v[152:155], v[32:35], v[136:139]
    v_mfma_f32_16x16x32_bf16 v[140:143], v[156:159], v[32:35], v[140:143]
    ds_read_b128 v[144:147], v8 offset:34816
    ds_read_b128 v[148:151], v8 offset:43008
    ds_read_b128 v[152:155], v8 offset:51200
    ds_read_b128 v[156:159], v8 offset:59392
    s_waitcnt lgkmcnt(4)
    v_mfma_f32_16x16x32_bf16 v[128:131], v[160:163], v[36:39], v[128:131]
    v_mfma_f32_16x16x32_bf16 v[132:135], v[164:167], v[36:39], v[132:135]
    v_mfma_f32_16x16x32_bf16 v[136:139], v[168:171], v[36:39], v[136:139]
    v_mfma_f32_16x16x32_bf16 v[140:143], v[172:175], v[36:39], v[140:143]
    ds_read_b128 v[160:163], v8 offset:35840
    ds_read_b128 v[164:167], v8 offset:44032
    ds_read_b128 v[168:171], v8 offset:52224
    ds_read_b128 v[172:175], v8 offset:60416
    s_waitcnt lgkmcnt(4)
    v_mfma_f32_16x16x32_bf16 v[128:131], v[144:147], v[40:43], v[128:131]
    v_mfma_f32_16x16x32_bf16 v[132:135], v[148:151], v[40:43], v[132:135]
    v_mfma_f32_16x16x32_bf16 v[136:139], v[152:155], v[40:43], v[136:139]
    v_mfma_f32_16x16x32_bf16 v[140:143], v[156:159], v[40:43], v[140:143]
    s_waitcnt lgkmcnt(0)
    v_mfma_f32_16x16x32_bf16 v[128:131], v[160:163], v[44:47], v[128:131]
    v_mfma_f32_16x16x32_bf16 v[132:135], v[164:167], v[44:47], v[132:135]
    v_mfma_f32_16x16x32_bf16 v[136:139], v[168:171], v[44:47], v[136:139]
    v_mfma_f32_16x16x32_bf16 v[140:143], v[172:175], v[44:47], v[140:143]
    s_add_u32 s44, s43, 16384
    buffer_load_dwordx4 v[80:83], v2, s[8:11], s44 offen offset:0
    buffer_load_dwordx4 v[84:87], v2, s[8:11], s44 offen offset:1024
    buffer_load_dwordx4 v[88:91], v2, s[8:11], s44 offen offset:2048
    buffer_load_dwordx4 v[92:95], v2, s[8:11], s44 offen offset:3072
    s_waitcnt vmcnt(12)
    s_barrier
    s_add_u32 s44, s46, 20480
    s_add_u32 s45, s47, 32768
    s_mov_b32 m0, s45
    s_nop 0
    buffer_load_dwordx4 v2, s[12:15], s44 offen offset:0 lds
    buffer_load_dwordx4 v2, s[12:15], s44 offen offset:1024 lds
    buffer_load_dwordx4 v2, s[12:15], s44 offen offset:2048 lds
    buffer_load_dwordx4 v2, s[12:15], s44 offen offset:3072 lds
    ds_read_b128 v[144:147], v9 offset:0
    ds_read_b128 v[148:151], v9 offset:8192
    ds_read_b128 v[152:155], v9 offset:16384
    ds_read_b128 v[156:159], v9 offset:24576
    ds_read_b128 v[160:163], v9 offset:1024
    ds_read_b128 v[164:167], v9 offset:9216
    ds_read_b128 v[168:171], v9 offset:17408
    ds_read_b128 v[172:175], v9 offset:25600
    s_waitcnt lgkmcnt(4)
    v_mfma_f32_16x16x32_bf16 v[128:131], v[144:147], v[48:51], v[128:131]
    v_mfma_f32_16x16x32_bf16 v[132:135], v[148:151], v[48:51], v[132:135]
    v_mfma_f32_16x16x32_bf16 v[136:139], v[152:155], v[48:51], v[136:139]
    v_mfma_f32_16x16x32_bf16 v[140:143], v[156:159], v[48:51], v[140:143]
    ds_read_b128 v[144:147], v9 offset:2048
    ds_read_b128 v[148:151], v9 offset:10240
    ds_read_b128 v[152:155], v9 offset:18432
    ds_read_b128 v[156:159], v9 offset:26624
    s_waitcnt lgkmcnt(4)
    v_mfma_f32_16x16x32_bf16 v[128:131], v[160:163], v[52:55], v[128:131]
    v_mfma_f32_16x16x32_bf16 v[132:135], v[164:167], v[52:55], v[132:135]
    v_mfma_f32_16x16x32_bf16 v[136:139], v[168:171], v[52:55], v[136:139]
    v_mfma_f32_16x16x32_bf16 v[140:143], v[172:175], v[52:55], v[140:143]
    ds_read_b128 v[160:163], v9 offset:3072
    ds_read_b128 v[164:167], v9 offset:11264
    ds_read_b128 v[168:171], v9 offset:19456
    ds_read_b128 v[172:175], v9 offset:27648
    s_waitcnt lgkmcnt(4)
    v_mfma_f32_16x16x32_bf16 v[128:131], v[144:147], v[56:59], v[128:131]
    v_mfma_f32_16x16x32_bf16 v[132:135], v[148:151], v[56:59], v[132:135]
    v_mfma_f32_16x16x32_bf16 v[136:139], v[152:155], v[56:59], v[136:139]
    v_mfma_f32_16x16x32_bf16 v[140:143], v[156:159], v[56:59], v[140:143]
    s_waitcnt lgkmcnt(0)
    v_mfma_f32_16x16x32_bf16 v[128:131], v[160:163], v[60:63], v[128:131]
    v_mfma_f32_16x16x32_bf16 v[132:135], v[164:167], v[60:63], v[132:135]
    v_mfma_f32_16x16x32_bf16 v[136:139], v[168:171], v[60:63], v[136:139]
    v_mfma_f32_16x16x32_bf16 v[140:143], v[172:175], v[60:63], v[140:143]
    s_add_u32 s44, s43, 20480
    buffer_load_dwordx4 v[96:99], v2, s[8:11], s44 offen offset:0
    buffer_load_dwordx4 v[100:103], v2, s[8:11], s44 offen offset:1024
    buffer_load_dwordx4 v[104:107], v2, s[8:11], s44 offen offset:2048
    buffer_load_dwordx4 v[108:111], v2, s[8:11], s44 offen offset:3072
    s_waitcnt vmcnt(16)
    s_barrier
    s_add_u32 s44, s46, 24576
    s_add_u32 s45, s47, 65536
    s_mov_b32 m0, s45
    s_nop 0
    buffer_load_dwordx4 v2, s[12:15], s44 offen offset:0 lds
    buffer_load_dwordx4 v2, s[12:15], s44 offen offset:1024 lds
    buffer_load_dwordx4 v2, s[12:15], s44 offen offset:2048 lds
    buffer_load_dwordx4 v2, s[12:15], s44 offen offset:3072 lds
    ds_read_b128 v[144:147], v9 offset:32768
    ds_read_b128 v[148:151], v9 offset:40960
    ds_read_b128 v[152:155], v9 offset:49152
    ds_read_b128 v[156:159], v9 offset:57344
    ds_read_b128 v[160:163], v9 offset:33792
    ds_read_b128 v[164:167], v9 offset:41984
    ds_read_b128 v[168:171], v9 offset:50176
    ds_read_b128 v[172:175], v9 offset:58368
    s_waitcnt lgkmcnt(4)
    v_mfma_f32_16x16x32_bf16 v[128:131], v[144:147], v[64:67], v[128:131]
    v_mfma_f32_16x16x32_bf16 v[132:135], v[148:151], v[64:67], v[132:135]
    v_mfma_f32_16x16x32_bf16 v[136:139], v[152:155], v[64:67], v[136:139]
    v_mfma_f32_16x16x32_bf16 v[140:143], v[156:159], v[64:67], v[140:143]
    ds_read_b128 v[144:147], v9 offset:34816
    ds_read_b128 v[148:151], v9 offset:43008
    ds_read_b128 v[152:155], v9 offset:51200
    ds_read_b128 v[156:159], v9 offset:59392
    s_waitcnt lgkmcnt(4)
    v_mfma_f32_16x16x32_bf16 v[128:131], v[160:163], v[68:71], v[128:131]
    v_mfma_f32_16x16x32_bf16 v[132:135], v[164:167], v[68:71], v[132:135]
    v_mfma_f32_16x16x32_bf16 v[136:139], v[168:171], v[68:71], v[136:139]
    v_mfma_f32_16x16x32_bf16 v[140:143], v[172:175], v[68:71], v[140:143]
    ds_read_b128 v[160:163], v9 offset:35840
    ds_read_b128 v[164:167], v9 offset:44032
    ds_read_b128 v[168:171], v9 offset:52224
    ds_read_b128 v[172:175], v9 offset:60416
    s_waitcnt lgkmcnt(4)
    v_mfma_f32_16x16x32_bf16 v[128:131], v[144:147], v[72:75], v[128:131]
    v_mfma_f32_16x16x32_bf16 v[132:135], v[148:151], v[72:75], v[132:135]
    v_mfma_f32_16x16x32_bf16 v[136:139], v[152:155], v[72:75], v[136:139]
    v_mfma_f32_16x16x32_bf16 v[140:143], v[156:159], v[72:75], v[140:143]
    s_waitcnt lgkmcnt(0)
    v_mfma_f32_16x16x32_bf16 v[128:131], v[160:163], v[76:79], v[128:131]
    v_mfma_f32_16x16x32_bf16 v[132:135], v[164:167], v[76:79], v[132:135]
    v_mfma_f32_16x16x32_bf16 v[136:139], v[168:171], v[76:79], v[136:139]
    v_mfma_f32_16x16x32_bf16 v[140:143], v[172:175], v[76:79], v[140:143]
    s_add_u32 s44, s43, 24576
    buffer_load_dwordx4 v[112:115], v2, s[8:11], s44 offen offset:0
    buffer_load_dwordx4 v[116:119], v2, s[8:11], s44 offen offset:1024
    buffer_load_dwordx4 v[120:123], v2, s[8:11], s44 offen offset:2048
    buffer_load_dwordx4 v[124:127], v2, s[8:11], s44 offen offset:3072
    s_waitcnt vmcnt(16)
    s_barrier
    ds_read_b128 v[144:147], v8 offset:0
    ds_read_b128 v[148:151], v8 offset:8192
    ds_read_b128 v[152:155], v8 offset:16384
    ds_read_b128 v[156:159], v8 offset:24576
    ds_read_b128 v[160:163], v8 offset:1024
    ds_read_b128 v[164:167], v8 offset:9216
    ds_read_b128 v[168:171], v8 offset:17408
    ds_read_b128 v[172:175], v8 offset:25600
    s_waitcnt lgkmcnt(4)
    v_mfma_f32_16x16x32_bf16 v[128:131], v[144:147], v[80:83], v[128:131]
    v_mfma_f32_16x16x32_bf16 v[132:135], v[148:151], v[80:83], v[132:135]
    v_mfma_f32_16x16x32_bf16 v[136:139], v[152:155], v[80:83], v[136:139]
    v_mfma_f32_16x16x32_bf16 v[140:143], v[156:159], v[80:83], v[140:143]
    ds_read_b128 v[144:147], v8 offset:2048
    ds_read_b128 v[148:151], v8 offset:10240
    ds_read_b128 v[152:155], v8 offset:18432
    ds_read_b128 v[156:159], v8 offset:26624
    s_waitcnt lgkmcnt(4)
    v_mfma_f32_16x16x32_bf16 v[128:131], v[160:163], v[84:87], v[128:131]
    v_mfma_f32_16x16x32_bf16 v[132:135], v[164:167], v[84:87], v[132:135]
    v_mfma_f32_16x16x32_bf16 v[136:139], v[168:171], v[84:87], v[136:139]
    v_mfma_f32_16x16x32_bf16 v[140:143], v[172:175], v[84:87], v[140:143]
    ds_read_b128 v[160:163], v8 offset:3072
    ds_read_b128 v[164:167], v8 offset:11264
    ds_read_b128 v[168:171], v8 offset:19456
    ds_read_b128 v[172:175], v8 offset:27648
    s_waitcnt lgkmcnt(4)
    v_mfma_f32_16x16x32_bf16 v[128:131], v[144:147], v[88:91], v[128:131]
    v_mfma_f32_16x16x32_bf16 v[132:135], v[148:151], v[88:91], v[132:135]
    v_mfma_f32_16x16x32_bf16 v[136:139], v[152:155], v[88:91], v[136:139]
    v_mfma_f32_16x16x32_bf16 v[140:143], v[156:159], v[88:91], v[140:143]
    s_waitcnt lgkmcnt(0)
    v_mfma_f32_16x16x32_bf16 v[128:131], v[160:163], v[92:95], v[128:131]
    v_mfma_f32_16x16x32_bf16 v[132:135], v[164:167], v[92:95], v[132:135]
    v_mfma_f32_16x16x32_bf16 v[136:139], v[168:171], v[92:95], v[136:139]
    v_mfma_f32_16x16x32_bf16 v[140:143], v[172:175], v[92:95], v[140:143]
    s_waitcnt vmcnt(8)
    s_barrier
    ds_read_b128 v[144:147], v8 offset:32768
    ds_read_b128 v[148:151], v8 offset:40960
    ds_read_b128 v[152:155], v8 offset:49152
    ds_read_b128 v[156:159], v8 offset:57344
    ds_read_b128 v[160:163], v8 offset:33792
    ds_read_b128 v[164:167], v8 offset:41984
    ds_read_b128 v[168:171], v8 offset:50176
    ds_read_b128 v[172:175], v8 offset:58368
    s_waitcnt lgkmcnt(4)
    v_mfma_f32_16x16x32_bf16 v[128:131], v[144:147], v[96:99], v[128:131]
    v_mfma_f32_16x16x32_bf16 v[132:135], v[148:151], v[96:99], v[132:135]
    v_mfma_f32_16x16x32_bf16 v[136:139], v[152:155], v[96:99], v[136:139]
    v_mfma_f32_16x16x32_bf16 v[140:143], v[156:159], v[96:99], v[140:143]
    ds_read_b128 v[144:147], v8 offset:34816
    ds_read_b128 v[148:151], v8 offset:43008
    ds_read_b128 v[152:155], v8 offset:51200
    ds_read_b128 v[156:159], v8 offset:59392
    s_waitcnt lgkmcnt(4)
    v_mfma_f32_16x16x32_bf16 v[128:131], v[160:163], v[100:103], v[128:131]
    v_mfma_f32_16x16x32_bf16 v[132:135], v[164:167], v[100:103], v[132:135]
    v_mfma_f32_16x16x32_bf16 v[136:139], v[168:171], v[100:103], v[136:139]
    v_mfma_f32_16x16x32_bf16 v[140:143], v[172:175], v[100:103], v[140:143]
    ds_read_b128 v[160:163], v8 offset:35840
    ds_read_b128 v[164:167], v8 offset:44032
    ds_read_b128 v[168:171], v8 offset:52224
    ds_read_b128 v[172:175], v8 offset:60416
    s_waitcnt lgkmcnt(4)
    v_mfma_f32_16x16x32_bf16 v[128:131], v[144:147], v[104:107], v[128:131]
    v_mfma_f32_16x16x32_bf16 v[132:135], v[148:151], v[104:107], v[132:135]
    v_mfma_f32_16x16x32_bf16 v[136:139], v[152:155], v[104:107], v[136:139]
    v_mfma_f32_16x16x32_bf16 v[140:143], v[156:159], v[104:107], v[140:143]
    s_waitcnt lgkmcnt(0)
    v_mfma_f32_16x16x32_bf16 v[128:131], v[160:163], v[108:111], v[128:131]
    v_mfma_f32_16x16x32_bf16 v[132:135], v[164:167], v[108:111], v[132:135]
    v_mfma_f32_16x16x32_bf16 v[136:139], v[168:171], v[108:111], v[136:139]
    v_mfma_f32_16x16x32_bf16 v[140:143], v[172:175], v[108:111], v[140:143]
    s_waitcnt vmcnt(0)
    s_barrier
    ds_read_b128 v[144:147], v9 offset:0
    ds_read_b128 v[148:151], v9 offset:8192
    ds_read_b128 v[152:155], v9 offset:16384
    ds_read_b128 v[156:159], v9 offset:24576
    ds_read_b128 v[160:163], v9 offset:1024
    ds_read_b128 v[164:167], v9 offset:9216
    ds_read_b128 v[168:171], v9 offset:17408
    ds_read_b128 v[172:175], v9 offset:25600
    s_waitcnt lgkmcnt(4)
    v_mfma_f32_16x16x32_bf16 v[128:131], v[144:147], v[112:115], v[128:131]
    v_mfma_f32_16x16x32_bf16 v[132:135], v[148:151], v[112:115], v[132:135]
    v_mfma_f32_16x16x32_bf16 v[136:139], v[152:155], v[112:115], v[136:139]
    v_mfma_f32_16x16x32_bf16 v[140:143], v[156:159], v[112:115], v[140:143]
    ds_read_b128 v[144:147], v9 offset:2048
    ds_read_b128 v[148:151], v9 offset:10240
    ds_read_b128 v[152:155], v9 offset:18432
    ds_read_b128 v[156:159], v9 offset:26624
    s_waitcnt lgkmcnt(4)
    v_mfma_f32_16x16x32_bf16 v[128:131], v[160:163], v[116:119], v[128:131]
    v_mfma_f32_16x16x32_bf16 v[132:135], v[164:167], v[116:119], v[132:135]
    v_mfma_f32_16x16x32_bf16 v[136:139], v[168:171], v[116:119], v[136:139]
    v_mfma_f32_16x16x32_bf16 v[140:143], v[172:175], v[116:119], v[140:143]
    ds_read_b128 v[160:163], v9 offset:3072
    ds_read_b128 v[164:167], v9 offset:11264
    ds_read_b128 v[168:171], v9 offset:19456
    ds_read_b128 v[172:175], v9 offset:27648
    s_waitcnt lgkmcnt(4)
    v_mfma_f32_16x16x32_bf16 v[128:131], v[144:147], v[120:123], v[128:131]
    v_mfma_f32_16x16x32_bf16 v[132:135], v[148:151], v[120:123], v[132:135]
    v_mfma_f32_16x16x32_bf16 v[136:139], v[152:155], v[120:123], v[136:139]
    v_mfma_f32_16x16x32_bf16 v[140:143], v[156:159], v[120:123], v[140:143]
    s_waitcnt lgkmcnt(0)
    v_mfma_f32_16x16x32_bf16 v[128:131], v[160:163], v[124:127], v[128:131]
    v_mfma_f32_16x16x32_bf16 v[132:135], v[164:167], v[124:127], v[132:135]
    v_mfma_f32_16x16x32_bf16 v[136:139], v[168:171], v[124:127], v[136:139]
    v_mfma_f32_16x16x32_bf16 v[140:143], v[172:175], v[124:127], v[140:143]
    s_lshl_b32 s44, s88, 1
    s_add_u32 s44, s44, s89
    s_lshl_b32 s45, s44, 11
    s_xor_b32 s44, s44, 1
    s_lshl_b32 s44, s44, 11
    s_add_u32 s45, s45, 147456
    s_add_u32 s44, s44, 147456
    v_add_u32 v6, s45, v2
    v_add_u32 v7, s44, v2
    s_cmp_eq_u32 s89, 0
    s_nop 0
    s_cbranch_scc1 L_hx_lo_192
    ds_write_b128 v6, v[128:131]
    ds_write_b128 v6, v[132:135] offset:1024
    v_mov_b32 v16, v136
    v_mov_b32 v17, v137
    v_mov_b32 v18, v138
    v_mov_b32 v19, v139
    v_mov_b32 v20, v140
    v_mov_b32 v21, v141
    v_mov_b32 v22, v142
    v_mov_b32 v23, v143
    s_nop 1
    s_branch L_hx_j1_193
L_hx_lo_192:
    ds_write_b128 v6, v[136:139]
    ds_write_b128 v6, v[140:143] offset:1024
    v_mov_b32 v16, v128
    v_mov_b32 v17, v129
    v_mov_b32 v18, v130
    v_mov_b32 v19, v131
    v_mov_b32 v20, v132
    v_mov_b32 v21, v133
    v_mov_b32 v22, v134
    v_mov_b32 v23, v135
    s_nop 1
L_hx_j1_193:
    s_waitcnt lgkmcnt(0)
    s_barrier
    ds_read_b128 v[128:131], v7
    ds_read_b128 v[132:135], v7 offset:1024
    s_waitcnt lgkmcnt(0)
    v_add_f32 v16, v16, v128
    v_add_f32 v17, v17, v129
    v_add_f32 v18, v18, v130
    v_add_f32 v19, v19, v131
    v_add_f32 v20, v20, v132
    v_add_f32 v21, v21, v133
    v_add_f32 v22, v22, v134
    v_add_f32 v23, v23, v135
    v_cvt_pk_bf16_f32 v17, v16, v17
    v_lshlrev_b32 v16, 16, v17
    v_and_b32 v17, 0xffff0000, v17
    v_cvt_pk_bf16_f32 v19, v18, v19
    v_lshlrev_b32 v18, 16, v19
    v_and_b32 v19, 0xffff0000, v19
    v_cvt_pk_bf16_f32 v21, v20, v21
    v_lshlrev_b32 v20, 16, v21
    v_and_b32 v21, 0xffff0000, v21
    v_cvt_pk_bf16_f32 v23, v22, v23
    v_lshlrev_b32 v22, 16, v23
    v_and_b32 v23, 0xffff0000, v23
    v_lshlrev_b32 v8, 16, v176
    v_and_b32 v9, 0xffff0000, v176
    v_add_f32 v16, v16, v8
    v_add_f32 v17, v17, v9
    v_lshlrev_b32 v8, 16, v177
    v_and_b32 v9, 0xffff0000, v177
    v_add_f32 v18, v18, v8
    v_add_f32 v19, v19, v9
    v_lshlrev_b32 v8, 16, v178
    v_and_b32 v9, 0xffff0000, v178
    v_add_f32 v20, v20, v8
    v_add_f32 v21, v21, v9
    v_lshlrev_b32 v8, 16, v179
    v_and_b32 v9, 0xffff0000, v179
    v_add_f32 v22, v22, v8
    v_add_f32 v23, v23, v9
    v_cvt_pk_bf16_f32 v17, v16, v17
    v_lshlrev_b32 v16, 16, v17
    v_and_b32 v17, 0xffff0000, v17
    v_cvt_pk_bf16_f32 v19, v18, v19
    v_lshlrev_b32 v18, 16, v19
    v_and_b32 v19, 0xffff0000, v19
    v_cvt_pk_bf16_f32 v21, v20, v21
    v_lshlrev_b32 v20, 16, v21
    v_and_b32 v21, 0xffff0000, v21
    v_cvt_pk_bf16_f32 v23, v22, v23
    v_lshlrev_b32 v22, 16, v23
    v_and_b32 v23, 0xffff0000, v23
    v_lshlrev_b32 v8, 16, v180
    v_and_b32 v9, 0xffff0000, v180
    v_add_f32 v16, v16, v8
    v_add_f32 v17, v17, v9
    v_lshlrev_b32 v8, 16, v181
    v_and_b32 v9, 0xffff0000, v181
    v_add_f32 v18, v18, v8
    v_add_f32 v19, v19, v9
    v_lshlrev_b32 v8, 16, v182
    v_and_b32 v9, 0xffff0000, v182
    v_add_f32 v20, v20, v8
    v_add_f32 v21, v21, v9
    v_lshlrev_b32 v8, 16, v183
    v_and_b32 v9, 0xffff0000, v183
    v_add_f32 v22, v22, v8
    v_add_f32 v23, v23, v9
    v_cvt_pk_bf16_f32 v24, v16, v17
    v_cvt_pk_bf16_f32 v25, v18, v19
    v_cvt_pk_bf16_f32 v26, v20, v21
    v_cvt_pk_bf16_f32 v27, v22, v23
    s_lshl_b32 s44, s84, 6
    s_lshl_b32 s45, s88, 4
    s_add_u32 s44, s44, s45
    v_add_u32 v12, s44, v3
    v_mul_u32_u24 v12, 896, v12
    v_lshl_add_u32 v12, v4, 4, v12
    s_lshl_b32 s44, s85, 7
    s_lshl_b32 s45, s89, 6
    s_add_u32 s44, s44, s45
    buffer_store_dwordx4 v[24:27], v12, s[24:27], s44 offen
    s_nop 1
    s_branch L_done
L_idle_143:
    s_sub_u32 s40, s81, 224
    s_lshr_b32 s40, s40, 3
    s_lshl_b32 s40, s40, 3
    s_add_u32 s40, s40, s3
    s_add_u32 s12, s94, 1409024
    s_addc_u32 s13, s95, 0
    s_mov_b32 s14, 4415488
    s_mov_b32 s15, 0x00020000
    s_lshl_b32 s44, s40, 12
L_pf_194:
    s_cmp_ge_u32 s44, 4415488
    s_cbranch_scc1 L_pfd_195
    buffer_load_dwordx4 v[16:19], v2, s[12:15], s44 offen offset:0
    buffer_load_dwordx4 v[20:23], v2, s[12:15], s44 offen offset:1024
    buffer_load_dwordx4 v[24:27], v2, s[12:15], s44 offen offset:2048
    buffer_load_dwordx4 v[28:31], v2, s[12:15], s44 offen offset:3072
    s_add_u32 s44, s44, 131072
    buffer_load_dwordx4 v[32:35], v2, s[12:15], s44 offen offset:0
    buffer_load_dwordx4 v[36:39], v2, s[12:15], s44 offen offset:1024
    buffer_load_dwordx4 v[40:43], v2, s[12:15], s44 offen offset:2048
    buffer_load_dwordx4 v[44:47], v2, s[12:15], s44 offen offset:3072
    s_add_u32 s44, s44, 131072
    s_waitcnt vmcnt(4)
    s_branch L_pf_194
L_pfd_195:
    s_waitcnt vmcnt(0)
L_done:
    s_endpgm
.section .rodata,"a"
.p2align 6
.amdhsa_kernel interleave_layers__linear_kernel_hedgehog__mixer_s_mlp__prompt_kernel
  .amdhsa_next_free_vgpr 248
  .amdhsa_next_free_sgpr 102
  .amdhsa_accum_offset 248
  .amdhsa_group_segment_fixed_size 0
  .amdhsa_kernarg_size 96
  .amdhsa_user_sgpr_count 2
  .amdhsa_user_sgpr_kernarg_segment_ptr 1
  .amdhsa_system_sgpr_workgroup_id_x 1
.end_amdhsa_kernel
```
